```python
import torch

def _softmax(x, axis=-1):
    return torch.softmax(x, dim=axis)
def _gelu(x):
    return torch.nn.functional.gelu(x, approximate="tanh")
def _silu(x):
    return torch.nn.functional.silu(x)
def _sigmoid(x):
    return torch.sigmoid(x)
def _layernorm(x, axis=-1, eps=1e-5):
    m = x.mean(dim=axis, keepdim=True)
    v = x.var(dim=axis, keepdim=True, unbiased=False)
    return (x - m) / torch.sqrt(v + eps)
def _scatter_add(tgt, idx, src, axis=0):
    return tgt.clone().index_add_(axis, idx, src)
def _segment_sum(src, seg, n):
    out = torch.zeros((n,) + src.shape[1:], dtype=src.dtype)
    return out.index_add_(0, seg, src)
def _pad(x, pw):
    flat = tuple(v for pair in reversed(pw) for v in pair)
    return torch.nn.functional.pad(x, flat)

kernel_name = 'interleave_layers__linear_kernel_hedgehog__ssm_conv_s4d__prompt'

def setup_inputs():

    _w = (lambda a: (lambda t: t.to(torch.bfloat16) if t.is_floating_point() else t)(torch.as_tensor(a)))
    def _A_setup():
        B, S, D, H = 1, 2048, 512, 32
        Dh = D // H
        return {
            "x": _w((lambda *s: torch.randn(*s, dtype=torch.bfloat16) * 0.05)(B, S, D)),
            "wqkv": _w((lambda *s: torch.randn(*s, dtype=torch.bfloat16) * 0.4)(D, 3 * D)),
            "w_phi": _w((lambda *s: torch.randn(*s, dtype=torch.bfloat16) * 0.4)(H, Dh, Dh) * (Dh ** -0.5)),
            "wo": _w((lambda *s: torch.randn(*s, dtype=torch.bfloat16) * 0.05)(D, D)),
        }
    _A_in = _A_setup()

    def _B_setup():
        Bsz, L, D, N = 1, 2048, 512, 128
        return {
            "u": _w((lambda *s: torch.randn(*s, dtype=torch.bfloat16) * 0.05)(Bsz, L, D)),
            "log_A_real": _w((lambda *s: torch.randn(*s, dtype=torch.bfloat16) * 6.4)(D, N) * 0.5),
            "A_imag": _w((lambda *s: torch.randn(*s, dtype=torch.bfloat16) * 0.4)(D, N) * 3.14),
            "C_real": _w((lambda *s: torch.randn(*s, dtype=torch.bfloat16) * 0.4)(D, N) / N ** 0.5),
            "C_imag": _w((lambda *s: torch.randn(*s, dtype=torch.bfloat16) * 0.4)(D, N) / N ** 0.5),
            "log_dt": _w((lambda *s: torch.randn(*s, dtype=torch.bfloat16) * 0.4)(D) * 0.5 - 4.0),
            "D_skip": _w((lambda *s: torch.randn(*s, dtype=torch.bfloat16) * 0.4)(D)),
        }
    _B_in = _B_setup()

    return {
        "A_x": _A_in["x"],
        "A_wqkv": _A_in["wqkv"],
        "A_w_phi": _A_in["w_phi"],
        "A_wo": _A_in["wo"],
        "B_u": _B_in["u"],
        "B_log_A_real": _B_in["log_A_real"],
        "B_A_imag": _B_in["A_imag"],
        "B_C_real": _B_in["C_real"],
        "B_C_imag": _B_in["C_imag"],
        "B_log_dt": _B_in["log_dt"],
        "B_D_skip": _B_in["D_skip"],
    }

def reference(A_x, A_wqkv, A_w_phi, A_wo, B_u, B_log_A_real, B_A_imag, B_C_real, B_C_imag, B_log_dt, B_D_skip):
    def _A_ref(x, wqkv, w_phi, wo):
        B, S, D = x.shape
        H = 32; Dh = D // H
        qkv = (lambda x, *d: x.permute(*d))((x @ wqkv).reshape(B, S, 3, H, Dh), 2, 0, 3, 1, 4)
        q, k, v = qkv[0], qkv[1], qkv[2]
        pq = torch.einsum("bhsd,hdf->bhsf", q, w_phi)
        pk = torch.einsum("bhsd,hdf->bhsf", k, w_phi)
        phi_q = torch.concatenate([_softmax(pq, axis=-1), _softmax(-pq, axis=-1)], axis=-1)
        phi_k = torch.concatenate([_softmax(pk, axis=-1), _softmax(-pk, axis=-1)], axis=-1)
        kv = torch.einsum("bhsf,bhsd->bhfd", phi_k, v)
        z  = torch.einsum("bhsf->bhf", phi_k)
        num = torch.einsum("bhqf,bhfd->bhqd", phi_q, kv)
        den = torch.einsum("bhqf,bhf->bhq", phi_q, z)[..., None] + 1e-6
        o = num / den
        return (lambda x, *d: x.permute(*d))(o, 0, 2, 1, 3).reshape(B, S, D) @ wo

    def _B_ref(u, log_A_real, A_imag, C_real, C_imag, log_dt, D_skip):
        L = u.shape[1]
        dt = torch.exp(log_dt)
        A = -torch.exp(log_A_real) + 1j * A_imag
        C = (C_real + 1j * C_imag) * dt[:, None]
        pos = (lambda x, dt: x.to(dt))(torch.arange(L), log_dt.dtype)
        P = torch.exp((A * dt[:, None])[:, :, None] * pos[None, None, :])
        K = 2.0 * torch.einsum("dn,dnl->dl", C, P).real
        L2 = 2 * L
        u_t = (lambda x, *d: x.permute(*d))(u, 0, 2, 1)
        Kf = (lambda x, *a, **k: torch.fft.rfft(x.float(), *a, **k))(K, L2)
        Uf = (lambda x, *a, **k: torch.fft.rfft(x.float(), *a, **k))(u_t, L2)
        y = (lambda x, *a, **k: torch.fft.irfft(x, *a, **k).to(torch.bfloat16))(Uf * Kf[None, :, :], L2)[:, :, :L]
        y = (lambda x, *d: x.permute(*d))(y, 0, 2, 1)
        return y + u * D_skip[None, None, :]

    x = A_x
    x = x + _A_ref(_layernorm(x, axis=-1), A_wqkv, A_w_phi, A_wo)
    x = x + _B_ref(_layernorm(x, axis=-1), B_log_A_real, B_A_imag, B_C_real, B_C_imag, B_log_dt, B_D_skip)
    x = x + _A_ref(_layernorm(x, axis=-1), A_wqkv, A_w_phi, A_wo)
    x = x + _B_ref(_layernorm(x, axis=-1), B_log_A_real, B_A_imag, B_C_real, B_C_imag, B_log_dt, B_D_skip)
    return x
```

```asm
; @launch grid=(256,1,1) block=(256,1,1) lds=163840
.amdgcn_target "amdgcn-amd-amdhsa--gfx950"
.text
.globl interleave_layers__linear_kernel_hedgehog__ssm_conv_s4d__prompt_kernel
.p2align 8
.type interleave_layers__linear_kernel_hedgehog__ssm_conv_s4d__prompt_kernel,@function
interleave_layers__linear_kernel_hedgehog__ssm_conv_s4d__prompt_kernel:
    s_cmp_ge_u32 s2, 256
    s_cbranch_scc1 Lend
    s_load_dwordx16 s[36:51], s[0:1], 0
    s_load_dwordx8 s[52:59], s[0:1], 64
    s_load_dwordx4 s[60:63], s[0:1], 96
    s_memrealtime s[70:71]
    v_and_b32 v1, 63, v0
    v_lshrrev_b32 v2, 6, v0
    s_and_b32 s4, s2, 7
    s_lshr_b32 s5, s2, 3
    v_readfirstlane_b32 s3, v2
    s_lshr_b32 s72, s4, 1
    s_lshl_b32 s72, s72, 2
    s_and_b32 s73, s5, 3
    s_add_u32 s6, s72, s73
    s_and_b32 s72, s4, 1
    s_lshl_b32 s72, s72, 3
    s_lshr_b32 s73, s5, 2
    s_add_u32 s7, s72, s73
    s_lshl_b32 s67, s4, 3
    s_lshr_b32 s72, s5, 2
    s_add_u32 s67, s67, s72
    s_and_b32 s68, s5, 3
    s_lshl_b32 s69, s4, 4
    s_lshr_b32 s72, s5, 1
    s_add_u32 s69, s69, s72
    s_and_b32 s96, s5, 1
    s_mov_b32 s65, 0x3f803f80
    s_mov_b32 s66, 0x3fb8aa3b
    v_mov_b32 v4, 0
    v_mov_b32 v5, 0
    v_mov_b32 v6, 0
    v_mov_b32 v7, 0
    v_lshlrev_b32 v3, 4, v1
    s_waitcnt lgkmcnt(0)
    s_mov_b32 s44, 0xffff0000
    s_mov_b32 s32, s42
    s_mov_b32 s33, s43
    s_mov_b32 s34, 524288
    s_mov_b32 s35, 0x20000
    s_mov_b32 s43, s70
    s_mov_b32 s8, s62
    s_mov_b32 s9, s63
    s_mov_b32 s10, 268435456
    s_mov_b32 s11, 0x20000
    s_mov_b32 s12, s36
    s_mov_b32 s13, s37
    s_mov_b32 s14, 2097152
    s_mov_b32 s15, 0x20000
    s_mov_b32 s16, s38
    s_mov_b32 s17, s39
    s_mov_b32 s18, 1572864
    s_mov_b32 s19, 0x20000
    s_mov_b32 s24, s58
    s_mov_b32 s25, s59
    s_mov_b32 s26, 2097152
    s_mov_b32 s27, 0x20000
    s_mov_b32 s28, s60
    s_mov_b32 s29, s61
    s_mov_b32 s30, 256
    s_mov_b32 s31, 0x20000
    s_cmp_lg_u32 s6, 0
    s_cbranch_scc1 Lz2_2
    s_lshl_b32 s72, s7, 12
    s_lshl_b32 s73, s3, 10
    s_add_u32 s72, s72, s73
    s_add_u32 s72, s72, 65536
    buffer_store_dwordx4 v[4:7], v3, s[8:11], s72 offen sc1
    s_lshl_b32 s72, s7, 8
    s_add_u32 s72, s72, 131072
    s_mov_b32 exec_lo, 0xffff
    s_mov_b32 exec_hi, 0
    buffer_store_dwordx4 v[4:7], v3, s[8:11], s72 offen sc1
    s_mov_b64 exec, -1
Lz2_2:
    s_cmp_lg_u32 s3, 0
    s_cbranch_scc1 Lz_1
    s_lshl_b32 s72, s2, 9
    s_add_u32 s72, s72, 196608
    s_mov_b32 exec_lo, -1
    s_mov_b32 exec_hi, 0
    buffer_store_dwordx4 v[4:7], v3, s[8:11], s72 offen sc1
    s_mov_b64 exec, -1
    s_cmp_lg_u32 s2, 0
    s_cbranch_scc1 Lz3_3
    s_or_b32 s70, s70, 0x80000000
    s_and_b32 s70, s70, 0xfffffff8
    v_mov_b32 v8, s70
    v_mov_b32 v9, 0
    s_mov_b64 exec, 1
    buffer_store_dword v8, v9, s[28:31], 0 offen sc0 sc1
    s_mov_b64 exec, -1
Lz3_3:
Lz_1:
    v_add_u32 v2, 0, v1
    v_mul_u32_u24 v3, 5462, v2
    v_lshrrev_b32 v3, 16, v3
    v_mul_u32_u24 v6, 12, v3
    v_sub_u32 v6, v2, v6
    v_mul_u32_u24 v3, 3072, v3
    v_lshrrev_b32 v7, 2, v6
    v_lshl_add_u32 v3, v7, 10, v3
    v_and_b32 v6, 3, v6
    v_lshl_add_u32 v14, v6, 4, v3
    v_add_u32 v2, 64, v1
    v_mul_u32_u24 v3, 5462, v2
    v_lshrrev_b32 v3, 16, v3
    v_mul_u32_u24 v6, 12, v3
    v_sub_u32 v6, v2, v6
    v_mul_u32_u24 v3, 3072, v3
    v_lshrrev_b32 v7, 2, v6
    v_lshl_add_u32 v3, v7, 10, v3
    v_and_b32 v6, 3, v6
    v_lshl_add_u32 v15, v6, 4, v3
    v_add_u32 v2, 128, v1
    v_mul_u32_u24 v3, 5462, v2
    v_lshrrev_b32 v3, 16, v3
    v_mul_u32_u24 v6, 12, v3
    v_sub_u32 v6, v2, v6
    v_mul_u32_u24 v3, 3072, v3
    v_lshrrev_b32 v7, 2, v6
    v_lshl_add_u32 v3, v7, 10, v3
    v_and_b32 v6, 3, v6
    v_lshl_add_u32 v16, v6, 4, v3
    s_mul_i32 s36, s3, 393216
    s_lshl_b32 s73, s7, 6
    s_add_u32 s36, s36, s73
    s_mul_i32 s37, s3, 24576
    s_lshl_b32 s72, s69, 2
    s_lshl_b32 s73, s96, 1
    s_add_u32 s72, s72, s73
    s_lshr_b32 s73, s3, 1
    s_add_u32 s72, s72, s73
    s_lshl_b32 s74, s72, 1
    s_lshl_b32 s73, s72, 8
    s_and_b32 s75, s3, 1
    s_lshl_b32 s75, s75, 7
    s_add_u32 s73, s73, s75
    v_lshlrev_b32 v2, 1, v1
    v_mov_b32 v3, 0
    s_mov_b32 s20, s46
    s_mov_b32 s21, s47
    s_mov_b32 s22, 131072
    s_mov_b32 s23, 0x20000
    buffer_load_ushort v80, v2, s[20:23], s73 offen
    s_mov_b32 s20, s48
    s_mov_b32 s21, s49
    s_mov_b32 s22, 131072
    s_mov_b32 s23, 0x20000
    buffer_load_ushort v81, v2, s[20:23], s73 offen
    s_mov_b32 s20, s50
    s_mov_b32 s21, s51
    s_mov_b32 s22, 131072
    s_mov_b32 s23, 0x20000
    buffer_load_ushort v82, v2, s[20:23], s73 offen
    s_mov_b32 s20, s52
    s_mov_b32 s21, s53
    s_mov_b32 s22, 131072
    s_mov_b32 s23, 0x20000
    buffer_load_ushort v83, v2, s[20:23], s73 offen
    s_mov_b32 s20, s54
    s_mov_b32 s21, s55
    s_mov_b32 s22, 1024
    s_mov_b32 s23, 0x20000
    buffer_load_ushort v84, v3, s[20:23], s74 offen
    s_mov_b32 s20, s56
    s_mov_b32 s21, s57
    s_mov_b32 s22, 1024
    s_mov_b32 s23, 0x20000
    s_lshl_b32 s74, s69, 3
    v_and_b32 v4, 3, v1
    v_lshlrev_b32 v4, 1, v4
    buffer_load_ushort v85, v4, s[20:23], s74 offen
    s_mov_b32 s20, s40
    s_mov_b32 s21, s41
    s_mov_b32 s22, 16384
    s_mov_b32 s23, 0x20000
    s_lshl_b32 s72, s7, 10
    v_lshlrev_b32 v2, 4, v1
    buffer_load_dwordx4 v[36:39], v2, s[20:23], s72 offen
    v_lshrrev_b32 v2, 5, v0
    v_lshlrev_b32 v2, 10, v2
    v_and_b32 v3, 31, v0
    v_lshl_add_u32 v2, v3, 5, v2
    s_lshl_b32 s72, s6, 17
    s_lshl_b32 s73, s7, 13
    s_add_u32 s72, s72, s73
    buffer_load_dwordx4 v[24:27], v2, s[12:15], s72 offen
    buffer_load_dwordx4 v[28:31], v2, s[12:15], s72 offen offset:16
    v_mov_b32 v33, 0
    buffer_load_dword v32, v33, s[28:31], 0 offen sc1
    s_lshl_b32 s72, s5, 2
    s_add_u32 s72, s72, s3
    v_lshlrev_b32 v2, 7, v1
    v_add_u32 v2, s72, v2
    v_mul_u32_u24 v3, 21846, v2
    v_lshrrev_b32 v3, 16, v3
    v_mul_u32_u24 v4, 3, v3
    v_sub_u32 v4, v2, v4
    v_mul_u32_u24 v3, 3072, v3
    v_lshl_add_u32 v3, v4, 10, v3
    s_and_b32 s73, s4, 1
    s_lshl_b32 s73, s73, 9
    s_add_u32 s73, s73, 384
    v_cmp_gt_u32 vcc, 12, v1
    v_mov_b32 v4, 0x7fffff00
    s_nop 0
    v_cndmask_b32 v3, v4, v3, vcc
    buffer_load_dword v21, v3, s[16:19], s73 offen
    s_add_u32 m0, s37, 0
    s_add_u32 s38, s36, 0
    buffer_load_dwordx4 v14, s[16:19], s38 offen lds
    s_add_u32 m0, s37, 1024
    s_add_u32 s38, s36, 0
    buffer_load_dwordx4 v15, s[16:19], s38 offen lds
    s_add_u32 m0, s37, 2048
    s_add_u32 s38, s36, 0
    buffer_load_dwordx4 v16, s[16:19], s38 offen lds
    s_add_u32 m0, s37, 3072
    s_add_u32 s38, s36, 49152
    buffer_load_dwordx4 v14, s[16:19], s38 offen lds
    s_add_u32 m0, s37, 4096
    s_add_u32 s38, s36, 49152
    buffer_load_dwordx4 v15, s[16:19], s38 offen lds
    s_add_u32 m0, s37, 5120
    s_add_u32 s38, s36, 49152
    buffer_load_dwordx4 v16, s[16:19], s38 offen lds
    s_add_u32 m0, s37, 6144
    s_add_u32 s38, s36, 98304
    buffer_load_dwordx4 v14, s[16:19], s38 offen lds
    s_add_u32 m0, s37, 7168
    s_add_u32 s38, s36, 98304
    buffer_load_dwordx4 v15, s[16:19], s38 offen lds
    v_lshrrev_b32 v2, 5, v1
    v_and_b32 v3, 31, v1
    v_lshlrev_b32 v3, 4, v3
    v_lshl_add_u32 v17, v2, 10, v3
    v_lshrrev_b32 v2, 4, v1
    v_bfe_u32 v3, v1, 2, 2
    v_and_b32 v4, 3, v1
    v_lshrrev_b32 v5, 1, v2
    v_lshl_add_u32 v6, v5, 3, v3
    v_mul_u32_u24 v6, 192, v6
    v_and_b32 v2, 1, v2
    v_and_b32 v7, 1, v4
    v_lshrrev_b32 v4, 1, v4
    v_lshlrev_b32 v8, 4, v2
    v_lshl_add_u32 v8, v7, 3, v8
    v_lshl_add_u32 v8, v4, 2, v8
    v_lshl_add_u32 v44, v8, 1, v6
    v_lshlrev_b32 v8, 4, v7
    v_lshl_add_u32 v8, v2, 3, v8
    v_lshl_add_u32 v8, v4, 2, v8
    v_lshl_add_u32 v46, v8, 1, v6
    v_add_u32 v46, 128, v46
    v_add_u32 v45, 49152, v44
    v_add_u32 v47, 49152, v46
    v_and_b32 v2, 15, v1
    v_bfe_u32 v3, v1, 4, 1
    v_lshl_add_u32 v3, v2, 1, v3
    v_lshlrev_b32 v3, 9, v3
    v_lshrrev_b32 v4, 5, v1
    v_xor_b32 v4, v4, v2
    v_lshl_add_u32 v3, v4, 4, v3
    s_lshl_b32 s72, s3, 14
    s_add_u32 s72, s72, 98304
    v_add_u32 v20, s72, v3
    s_waitcnt vmcnt(9)
    s_mov_b32 s75, 0x40000000
    v_subrev_u32 v33, s43, v32
    v_add_u32 v33, 3008, v33
    v_and_b32 v33, 0x7fffffff, v33
    v_cmp_le_u32 vcc, s75, v33
    v_cmp_eq_u32 s[76:77], 0, v32
    v_mov_b32 v33, 0
    s_nop 0
    s_nop 1
    s_or_b64 vcc, vcc, s[76:77]
    s_cbranch_vccz Lnx_5
    s_mov_b32 s73, 0
Lnw_4:
    buffer_load_dword v32, v33, s[28:31], 0 offen sc1
    s_add_u32 s73, s73, 1
    s_cmp_gt_u32 s73, 0x40000
    s_cbranch_scc1 Lnx_5
    s_waitcnt vmcnt(0)
    v_subrev_u32 v33, s43, v32
    v_add_u32 v33, 3008, v33
    v_and_b32 v33, 0x7fffffff, v33
    v_cmp_le_u32 vcc, s75, v33
    v_cmp_eq_u32 s[76:77], 0, v32
    v_mov_b32 v33, 0
    s_nop 0
    s_nop 1
    s_or_b64 vcc, vcc, s[76:77]
    s_cbranch_vccnz Lnw_4
Lnx_5:
    s_waitcnt vmcnt(9)
    v_readfirstlane_b32 s64, v32
    v_lshlrev_b32 v8, 16, v24
    v_and_b32 v9, s44, v24
    v_pk_mul_f32 v[12:13], v[8:9], v[8:9]
    v_mov_b32 v34, v8
    v_mov_b32 v35, v9
    v_lshlrev_b32 v10, 16, v25
    v_and_b32 v11, s44, v25
    v_pk_fma_f32 v[12:13], v[10:11], v[10:11], v[12:13]
    v_pk_add_f32 v[34:35], v[34:35], v[10:11]
    v_lshlrev_b32 v8, 16, v26
    v_and_b32 v9, s44, v26
    v_pk_fma_f32 v[12:13], v[8:9], v[8:9], v[12:13]
    v_pk_add_f32 v[34:35], v[34:35], v[8:9]
    v_lshlrev_b32 v10, 16, v27
    v_and_b32 v11, s44, v27
    v_pk_fma_f32 v[12:13], v[10:11], v[10:11], v[12:13]
    v_pk_add_f32 v[34:35], v[34:35], v[10:11]
    v_lshlrev_b32 v8, 16, v28
    v_and_b32 v9, s44, v28
    v_pk_fma_f32 v[12:13], v[8:9], v[8:9], v[12:13]
    v_pk_add_f32 v[34:35], v[34:35], v[8:9]
    v_lshlrev_b32 v10, 16, v29
    v_and_b32 v11, s44, v29
    v_pk_fma_f32 v[12:13], v[10:11], v[10:11], v[12:13]
    v_pk_add_f32 v[34:35], v[34:35], v[10:11]
    v_lshlrev_b32 v8, 16, v30
    v_and_b32 v9, s44, v30
    v_pk_fma_f32 v[12:13], v[8:9], v[8:9], v[12:13]
    v_pk_add_f32 v[34:35], v[34:35], v[8:9]
    v_lshlrev_b32 v10, 16, v31
    v_and_b32 v11, s44, v31
    v_pk_fma_f32 v[12:13], v[10:11], v[10:11], v[12:13]
    v_pk_add_f32 v[34:35], v[34:35], v[10:11]
    v_add_f32 v34, v34, v35
    v_add_f32 v12, v12, v13
    s_nop 0
    s_nop 0
    v_permlane16_swap_b32 v34, v12
    v_add_f32 v34, v34, v12
    s_nop 1
    v_add_f32_dpp v34, v34, v34 row_ror:8 row_mask:0xf bank_mask:0xf
    s_nop 1
    v_add_f32_dpp v34, v34, v34 row_ror:4 row_mask:0xf bank_mask:0xf
    s_nop 1
    v_add_f32_dpp v34, v34, v34 row_ror:2 row_mask:0xf bank_mask:0xf
    s_nop 1
    v_add_f32_dpp v34, v34, v34 row_ror:1 row_mask:0xf bank_mask:0xf
    v_mov_b32 v12, v34
    s_nop 0
    s_nop 0
    v_permlane16_swap_b32 v34, v12
    v_mul_f32 v8, 0x3b000000, v34
    v_mul_f32 v12, 0x3b000000, v12
    v_fma_f32 v12, -v8, v8, v12
    v_add_f32 v12, 0x3727c5ac, v12
    v_rsq_f32 v9, v12
    v_mov_b32 v10, s64
    v_mov_b32 v11, 0
    v_lshrrev_b32 v12, 5, v0
    v_lshlrev_b32 v12, 4, v12
    s_lshl_b32 s72, s6, 11
    s_lshl_b32 s73, s7, 7
    s_add_u32 s72, s72, s73
    s_add_u32 s72, s72, 327680
    s_mov_b32 exec_lo, 1
    s_mov_b32 exec_hi, 1
    buffer_store_dwordx4 v[8:11], v12, s[8:11], s72 offen sc1
    s_mov_b64 exec, -1
    v_lshlrev_b32 v80, 16, v80
    s_add_u32 m0, s37, 8192
    s_add_u32 s38, s36, 98304
    buffer_load_dwordx4 v16, s[16:19], s38 offen lds
    v_lshlrev_b32 v81, 16, v81
    v_lshlrev_b32 v82, 16, v82
    v_lshlrev_b32 v83, 16, v83
    v_lshlrev_b32 v84, 16, v84
    v_lshlrev_b32 v85, 16, v85
    s_nop 0
    v_readlane_b32 s97, v85, 0
    v_readlane_b32 s98, v85, 1
    v_readlane_b32 s99, v85, 2
    v_readlane_b32 s100, v85, 3
    v_mul_f32 v92, s66, v84
    v_fma_f32 v93, v84, s66, -v92
    s_add_u32 m0, s37, 9216
    s_add_u32 s38, s36, 147456
    buffer_load_dwordx4 v14, s[16:19], s38 offen lds
    v_mov_b32 v90, 0x32a57060
    v_fma_f32 v93, v84, v90, v93
    v_exp_f32 v92, v92
    v_mul_f32 v93, 0x3f317218, v93
    v_fma_f32 v92, v92, v93, v92
    v_cvt_pk_bf16_f32 v90, v92, v92
    v_and_b32 v90, 0xffff0000, v90
    v_mul_f32 v92, s66, v80
    v_fma_f32 v93, v80, s66, -v92
    v_mov_b32 v91, 0x32a57060
    v_fma_f32 v93, v80, v91, v93
    s_add_u32 m0, s37, 10240
    s_add_u32 s38, s36, 147456
    buffer_load_dwordx4 v15, s[16:19], s38 offen lds
    v_exp_f32 v92, v92
    v_mul_f32 v93, 0x3f317218, v93
    v_fma_f32 v92, v92, v93, v92
    v_cvt_pk_bf16_f32 v91, v92, v92
    v_and_b32 v91, 0xffff0000, v91
    v_mul_f32 v91, v91, v90
    v_mul_f32 v114, s66, v91
    v_sub_f32 v114, 0, v114
    v_mul_f32 v115, v81, v90
    v_mul_f32 v115, 0.15915494, v115
    v_mul_f32 v112, v82, v90
    s_add_u32 m0, s37, 11264
    s_add_u32 s38, s36, 147456
    buffer_load_dwordx4 v16, s[16:19], s38 offen lds
    v_mul_f32 v113, v83, v90
    v_pk_add_f32 v[112:113], v[112:113], v[112:113]
    v_mul_f32 v108, 0x3f800000, v114
    v_mul_f32 v109, 0x3f800000, v115
    v_exp_f32 v108, v108
    v_fract_f32 v109, v109
    v_cos_f32 v94, v109
    v_sin_f32 v95, v109
    s_nop 0
    v_pk_mul_f32 v[94:95], v[94:95], v[108:109] op_sel_hi:[1,0]
    v_mul_f32 v108, 0x41000000, v114
    s_add_u32 m0, s37, 12288
    s_add_u32 s38, s36, 196608
    buffer_load_dwordx4 v14, s[16:19], s38 offen lds
    v_mul_f32 v109, 0x41000000, v115
    v_exp_f32 v108, v108
    v_fract_f32 v109, v109
    v_cos_f32 v96, v109
    v_sin_f32 v97, v109
    s_nop 0
    v_pk_mul_f32 v[96:97], v[96:97], v[108:109] op_sel_hi:[1,0]
    v_mul_f32 v108, 0x43800000, v114
    v_mul_f32 v109, 0x43800000, v115
    v_exp_f32 v108, v108
    v_fract_f32 v109, v109
    s_add_u32 m0, s37, 13312
    s_add_u32 s38, s36, 196608
    buffer_load_dwordx4 v15, s[16:19], s38 offen lds
    v_cos_f32 v98, v109
    v_sin_f32 v99, v109
    s_nop 0
    v_pk_mul_f32 v[98:99], v[98:99], v[108:109] op_sel_hi:[1,0]
    v_pk_mul_f32 v[108:109], v[94:95], v[94:95] op_sel_hi:[1,0]
    v_pk_fma_f32 v[100:101], v[94:95], v[94:95], v[108:109] op_sel:[1,1,0] op_sel_hi:[0,1,1] neg_lo:[1,0,0]
    v_pk_mul_f32 v[108:109], v[100:101], v[100:101] op_sel_hi:[1,0]
    v_pk_fma_f32 v[102:103], v[100:101], v[100:101], v[108:109] op_sel:[1,1,0] op_sel_hi:[0,1,1] neg_lo:[1,0,0]
    v_mov_b32 v106, 1.0
    v_mov_b32 v104, v112
    v_mov_b32 v107, 0
    s_add_u32 m0, s37, 14336
    s_add_u32 s38, s36, 196608
    buffer_load_dwordx4 v16, s[16:19], s38 offen lds
    v_mov_b32 v105, v113
    v_cvt_pk_bf16_f32 v116, v106, -v107
    v_cvt_pk_bf16_f32 v117, v104, v105
    v_accvgpr_write_b32 a149, v116
    v_accvgpr_write_b32 a128, v117
    v_pk_mul_f32 v[108:109], v[106:107], v[96:97] op_sel_hi:[1,0]
    v_pk_mul_f32 v[118:119], v[104:105], v[94:95] op_sel_hi:[1,0]
    v_pk_fma_f32 v[106:107], v[106:107], v[96:97], v[108:109] op_sel:[1,1,0] op_sel_hi:[0,1,1] neg_lo:[1,0,0]
    v_pk_fma_f32 v[104:105], v[104:105], v[94:95], v[118:119] op_sel:[1,1,0] op_sel_hi:[0,1,1] neg_lo:[1,0,0]
    v_cvt_pk_bf16_f32 v116, v106, -v107
    v_cvt_pk_bf16_f32 v117, v104, v105
    s_add_u32 m0, s37, 15360
    s_add_u32 s38, s36, 245760
    buffer_load_dwordx4 v14, s[16:19], s38 offen lds
    v_accvgpr_write_b32 a150, v116
    v_accvgpr_write_b32 a129, v117
    v_pk_mul_f32 v[108:109], v[106:107], v[96:97] op_sel_hi:[1,0]
    v_pk_mul_f32 v[118:119], v[104:105], v[94:95] op_sel_hi:[1,0]
    v_pk_fma_f32 v[106:107], v[106:107], v[96:97], v[108:109] op_sel:[1,1,0] op_sel_hi:[0,1,1] neg_lo:[1,0,0]
    v_pk_fma_f32 v[104:105], v[104:105], v[94:95], v[118:119] op_sel:[1,1,0] op_sel_hi:[0,1,1] neg_lo:[1,0,0]
    v_cvt_pk_bf16_f32 v116, v106, -v107
    v_cvt_pk_bf16_f32 v117, v104, v105
    v_accvgpr_write_b32 a151, v116
    v_accvgpr_write_b32 a130, v117
    v_pk_mul_f32 v[108:109], v[106:107], v[96:97] op_sel_hi:[1,0]
    s_add_u32 m0, s37, 16384
    s_add_u32 s38, s36, 245760
    buffer_load_dwordx4 v15, s[16:19], s38 offen lds
    v_pk_mul_f32 v[118:119], v[104:105], v[94:95] op_sel_hi:[1,0]
    v_pk_fma_f32 v[106:107], v[106:107], v[96:97], v[108:109] op_sel:[1,1,0] op_sel_hi:[0,1,1] neg_lo:[1,0,0]
    v_pk_fma_f32 v[104:105], v[104:105], v[94:95], v[118:119] op_sel:[1,1,0] op_sel_hi:[0,1,1] neg_lo:[1,0,0]
    v_cvt_pk_bf16_f32 v116, v106, -v107
    v_cvt_pk_bf16_f32 v117, v104, v105
    v_accvgpr_write_b32 a152, v116
    v_accvgpr_write_b32 a131, v117
    v_pk_mul_f32 v[108:109], v[106:107], v[96:97] op_sel_hi:[1,0]
    v_pk_mul_f32 v[118:119], v[104:105], v[94:95] op_sel_hi:[1,0]
    v_pk_fma_f32 v[106:107], v[106:107], v[96:97], v[108:109] op_sel:[1,1,0] op_sel_hi:[0,1,1] neg_lo:[1,0,0]
    v_pk_fma_f32 v[104:105], v[104:105], v[94:95], v[118:119] op_sel:[1,1,0] op_sel_hi:[0,1,1] neg_lo:[1,0,0]
    s_add_u32 m0, s37, 17408
    s_add_u32 s38, s36, 245760
    buffer_load_dwordx4 v16, s[16:19], s38 offen lds
    v_cvt_pk_bf16_f32 v116, v106, -v107
    v_cvt_pk_bf16_f32 v117, v104, v105
    v_accvgpr_write_b32 a153, v116
    v_accvgpr_write_b32 a132, v117
    v_pk_mul_f32 v[108:109], v[106:107], v[96:97] op_sel_hi:[1,0]
    v_pk_mul_f32 v[118:119], v[104:105], v[94:95] op_sel_hi:[1,0]
    v_pk_fma_f32 v[106:107], v[106:107], v[96:97], v[108:109] op_sel:[1,1,0] op_sel_hi:[0,1,1] neg_lo:[1,0,0]
    v_pk_fma_f32 v[104:105], v[104:105], v[94:95], v[118:119] op_sel:[1,1,0] op_sel_hi:[0,1,1] neg_lo:[1,0,0]
    v_cvt_pk_bf16_f32 v116, v106, -v107
    v_cvt_pk_bf16_f32 v117, v104, v105
    v_accvgpr_write_b32 a154, v116
    s_add_u32 m0, s37, 18432
    s_add_u32 s38, s36, 294912
    buffer_load_dwordx4 v14, s[16:19], s38 offen lds
    v_accvgpr_write_b32 a133, v117
    v_pk_mul_f32 v[108:109], v[106:107], v[96:97] op_sel_hi:[1,0]
    v_pk_mul_f32 v[118:119], v[104:105], v[94:95] op_sel_hi:[1,0]
    v_pk_fma_f32 v[106:107], v[106:107], v[96:97], v[108:109] op_sel:[1,1,0] op_sel_hi:[0,1,1] neg_lo:[1,0,0]
    v_pk_fma_f32 v[104:105], v[104:105], v[94:95], v[118:119] op_sel:[1,1,0] op_sel_hi:[0,1,1] neg_lo:[1,0,0]
    v_cvt_pk_bf16_f32 v116, v106, -v107
    v_cvt_pk_bf16_f32 v117, v104, v105
    v_accvgpr_write_b32 a155, v116
    v_accvgpr_write_b32 a134, v117
    v_pk_mul_f32 v[108:109], v[106:107], v[96:97] op_sel_hi:[1,0]
    v_pk_mul_f32 v[118:119], v[104:105], v[94:95] op_sel_hi:[1,0]
    s_add_u32 m0, s37, 19456
    s_add_u32 s38, s36, 294912
    buffer_load_dwordx4 v15, s[16:19], s38 offen lds
    v_pk_fma_f32 v[106:107], v[106:107], v[96:97], v[108:109] op_sel:[1,1,0] op_sel_hi:[0,1,1] neg_lo:[1,0,0]
    v_pk_fma_f32 v[104:105], v[104:105], v[94:95], v[118:119] op_sel:[1,1,0] op_sel_hi:[0,1,1] neg_lo:[1,0,0]
    v_cvt_pk_bf16_f32 v116, v106, -v107
    v_cvt_pk_bf16_f32 v117, v104, v105
    v_accvgpr_write_b32 a156, v116
    v_accvgpr_write_b32 a135, v117
    v_pk_mul_f32 v[108:109], v[106:107], v[96:97] op_sel_hi:[1,0]
    v_pk_mul_f32 v[118:119], v[112:113], v[98:99] op_sel_hi:[1,0]
    v_pk_fma_f32 v[106:107], v[106:107], v[96:97], v[108:109] op_sel:[1,1,0] op_sel_hi:[0,1,1] neg_lo:[1,0,0]
    v_pk_fma_f32 v[104:105], v[112:113], v[98:99], v[118:119] op_sel:[1,1,0] op_sel_hi:[0,1,1] neg_lo:[1,0,0]
    v_cvt_pk_bf16_f32 v116, v106, -v107
    s_add_u32 m0, s37, 20480
    s_add_u32 s38, s36, 294912
    buffer_load_dwordx4 v16, s[16:19], s38 offen lds
    v_cvt_pk_bf16_f32 v117, v104, v105
    v_accvgpr_write_b32 a157, v116
    v_accvgpr_write_b32 a136, v117
    v_pk_mul_f32 v[108:109], v[106:107], v[96:97] op_sel_hi:[1,0]
    v_pk_mul_f32 v[118:119], v[104:105], v[100:101] op_sel_hi:[1,0]
    v_pk_fma_f32 v[106:107], v[106:107], v[96:97], v[108:109] op_sel:[1,1,0] op_sel_hi:[0,1,1] neg_lo:[1,0,0]
    v_pk_fma_f32 v[104:105], v[104:105], v[100:101], v[118:119] op_sel:[1,1,0] op_sel_hi:[0,1,1] neg_lo:[1,0,0]
    v_cvt_pk_bf16_f32 v116, v106, -v107
    v_cvt_pk_bf16_f32 v117, v104, v105
    v_accvgpr_write_b32 a158, v116
    v_accvgpr_write_b32 a137, v117
    s_add_u32 m0, s37, 21504
    s_add_u32 s38, s36, 344064
    buffer_load_dwordx4 v14, s[16:19], s38 offen lds
    v_pk_mul_f32 v[108:109], v[106:107], v[96:97] op_sel_hi:[1,0]
    v_pk_mul_f32 v[118:119], v[104:105], v[100:101] op_sel_hi:[1,0]
    v_pk_fma_f32 v[106:107], v[106:107], v[96:97], v[108:109] op_sel:[1,1,0] op_sel_hi:[0,1,1] neg_lo:[1,0,0]
    v_pk_fma_f32 v[104:105], v[104:105], v[100:101], v[118:119] op_sel:[1,1,0] op_sel_hi:[0,1,1] neg_lo:[1,0,0]
    v_cvt_pk_bf16_f32 v116, v106, -v107
    v_cvt_pk_bf16_f32 v117, v104, v105
    v_accvgpr_write_b32 a159, v116
    v_accvgpr_write_b32 a138, v117
    v_pk_mul_f32 v[108:109], v[106:107], v[96:97] op_sel_hi:[1,0]
    v_pk_mul_f32 v[118:119], v[104:105], v[100:101] op_sel_hi:[1,0]
    v_pk_fma_f32 v[106:107], v[106:107], v[96:97], v[108:109] op_sel:[1,1,0] op_sel_hi:[0,1,1] neg_lo:[1,0,0]
    s_add_u32 m0, s37, 22528
    s_add_u32 s38, s36, 344064
    buffer_load_dwordx4 v15, s[16:19], s38 offen lds
    v_pk_fma_f32 v[104:105], v[104:105], v[100:101], v[118:119] op_sel:[1,1,0] op_sel_hi:[0,1,1] neg_lo:[1,0,0]
    v_cvt_pk_bf16_f32 v116, v106, -v107
    v_cvt_pk_bf16_f32 v117, v104, v105
    v_accvgpr_write_b32 a160, v116
    v_accvgpr_write_b32 a139, v117
    v_pk_mul_f32 v[108:109], v[106:107], v[96:97] op_sel_hi:[1,0]
    v_pk_mul_f32 v[118:119], v[98:99], v[98:99] op_sel_hi:[1,0]
    v_pk_fma_f32 v[106:107], v[106:107], v[96:97], v[108:109] op_sel:[1,1,0] op_sel_hi:[0,1,1] neg_lo:[1,0,0]
    v_pk_fma_f32 v[110:111], v[98:99], v[98:99], v[118:119] op_sel:[1,1,0] op_sel_hi:[0,1,1] neg_lo:[1,0,0]
    v_cvt_pk_bf16_f32 v116, v106, -v107
    v_pk_mul_f32 v[118:119], v[112:113], v[110:111] op_sel_hi:[1,0]
    s_add_u32 m0, s37, 23552
    s_add_u32 s38, s36, 344064
    buffer_load_dwordx4 v16, s[16:19], s38 offen lds
    v_accvgpr_write_b32 a161, v116
    v_pk_fma_f32 v[104:105], v[112:113], v[110:111], v[118:119] op_sel:[1,1,0] op_sel_hi:[0,1,1] neg_lo:[1,0,0]
    v_pk_mul_f32 v[108:109], v[106:107], v[96:97] op_sel_hi:[1,0]
    v_cvt_pk_bf16_f32 v117, v104, v105
    v_pk_fma_f32 v[106:107], v[106:107], v[96:97], v[108:109] op_sel:[1,1,0] op_sel_hi:[0,1,1] neg_lo:[1,0,0]
    v_accvgpr_write_b32 a140, v117
    v_cvt_pk_bf16_f32 v116, v106, -v107
    v_pk_mul_f32 v[118:119], v[104:105], v[102:103] op_sel_hi:[1,0]
    v_accvgpr_write_b32 a162, v116
    v_pk_fma_f32 v[120:121], v[104:105], v[102:103], v[118:119] op_sel:[1,1,0] op_sel_hi:[0,1,1] neg_lo:[1,0,0]
    v_pk_mul_f32 v[108:109], v[106:107], v[96:97] op_sel_hi:[1,0]
    s_lshl_b32 s36, s6, 17
    s_lshl_b32 s73, s3, 15
    s_add_u32 s36, s36, s73
    s_add_u32 s36, s36, 0
    s_lshl_b32 s37, s3, 14
    s_add_u32 s37, s37, 98304
    v_cvt_pk_bf16_f32 v117, v120, v121
    v_xor_b32 v18, 0, v17
    s_add_u32 m0, s37, 0
    s_add_u32 s38, s36, 0
    buffer_load_dwordx4 v18, s[12:15], s38 offen lds
    v_pk_fma_f32 v[106:107], v[106:107], v[96:97], v[108:109] op_sel:[1,1,0] op_sel_hi:[0,1,1] neg_lo:[1,0,0]
    v_accvgpr_write_b32 a141, v117
    v_cvt_pk_bf16_f32 v116, v106, -v107
    v_pk_mul_f32 v[118:119], v[104:105], v[98:99] op_sel_hi:[1,0]
    v_accvgpr_write_b32 a163, v116
    v_pk_fma_f32 v[104:105], v[104:105], v[98:99], v[118:119] op_sel:[1,1,0] op_sel_hi:[0,1,1] neg_lo:[1,0,0]
    v_pk_mul_f32 v[108:109], v[106:107], v[96:97] op_sel_hi:[1,0]
    v_cvt_pk_bf16_f32 v117, v104, v105
    v_pk_fma_f32 v[106:107], v[106:107], v[96:97], v[108:109] op_sel:[1,1,0] op_sel_hi:[0,1,1] neg_lo:[1,0,0]
    v_accvgpr_write_b32 a142, v117
    v_cvt_pk_bf16_f32 v116, v106, -v107
    v_xor_b32 v19, 16, v17
    s_add_u32 m0, s37, 1024
    s_add_u32 s38, s36, 2048
    buffer_load_dwordx4 v19, s[12:15], s38 offen lds
    v_pk_mul_f32 v[118:119], v[104:105], v[102:103] op_sel_hi:[1,0]
    v_accvgpr_write_b32 a164, v116
    v_pk_fma_f32 v[120:121], v[104:105], v[102:103], v[118:119] op_sel:[1,1,0] op_sel_hi:[0,1,1] neg_lo:[1,0,0]
    v_pk_mul_f32 v[108:109], v[106:107], v[96:97] op_sel_hi:[1,0]
    v_cvt_pk_bf16_f32 v117, v120, v121
    v_pk_fma_f32 v[106:107], v[106:107], v[96:97], v[108:109] op_sel:[1,1,0] op_sel_hi:[0,1,1] neg_lo:[1,0,0]
    v_accvgpr_write_b32 a143, v117
    v_cvt_pk_bf16_f32 v116, v106, -v107
    v_pk_mul_f32 v[118:119], v[110:111], v[110:111] op_sel_hi:[1,0]
    v_accvgpr_write_b32 a165, v116
    v_pk_fma_f32 v[110:111], v[110:111], v[110:111], v[118:119] op_sel:[1,1,0] op_sel_hi:[0,1,1] neg_lo:[1,0,0]
    v_xor_b32 v18, 32, v17
    s_add_u32 m0, s37, 2048
    s_add_u32 s38, s36, 4096
    buffer_load_dwordx4 v18, s[12:15], s38 offen lds
    v_pk_mul_f32 v[108:109], v[106:107], v[96:97] op_sel_hi:[1,0]
    v_pk_mul_f32 v[118:119], v[112:113], v[110:111] op_sel_hi:[1,0]
    v_pk_fma_f32 v[106:107], v[106:107], v[96:97], v[108:109] op_sel:[1,1,0] op_sel_hi:[0,1,1] neg_lo:[1,0,0]
    v_pk_fma_f32 v[104:105], v[112:113], v[110:111], v[118:119] op_sel:[1,1,0] op_sel_hi:[0,1,1] neg_lo:[1,0,0]
    v_cvt_pk_bf16_f32 v116, v106, -v107
    v_cvt_pk_bf16_f32 v117, v104, v105
    v_accvgpr_write_b32 a166, v116
    v_accvgpr_write_b32 a144, v117
    v_pk_mul_f32 v[108:109], v[106:107], v[96:97] op_sel_hi:[1,0]
    v_pk_mul_f32 v[118:119], v[104:105], v[98:99] op_sel_hi:[1,0]
    v_pk_fma_f32 v[106:107], v[106:107], v[96:97], v[108:109] op_sel:[1,1,0] op_sel_hi:[0,1,1] neg_lo:[1,0,0]
    v_xor_b32 v19, 48, v17
    s_add_u32 m0, s37, 3072
    s_add_u32 s38, s36, 6144
    buffer_load_dwordx4 v19, s[12:15], s38 offen lds
    v_pk_fma_f32 v[104:105], v[104:105], v[98:99], v[118:119] op_sel:[1,1,0] op_sel_hi:[0,1,1] neg_lo:[1,0,0]
    v_cvt_pk_bf16_f32 v116, v106, -v107
    v_cvt_pk_bf16_f32 v117, v104, v105
    v_accvgpr_write_b32 a167, v116
    v_accvgpr_write_b32 a145, v117
    v_pk_mul_f32 v[108:109], v[106:107], v[96:97] op_sel_hi:[1,0]
    v_pk_mul_f32 v[118:119], v[104:105], v[98:99] op_sel_hi:[1,0]
    v_pk_fma_f32 v[106:107], v[106:107], v[96:97], v[108:109] op_sel:[1,1,0] op_sel_hi:[0,1,1] neg_lo:[1,0,0]
    v_pk_fma_f32 v[104:105], v[104:105], v[98:99], v[118:119] op_sel:[1,1,0] op_sel_hi:[0,1,1] neg_lo:[1,0,0]
    v_cvt_pk_bf16_f32 v116, v106, -v107
    v_cvt_pk_bf16_f32 v117, v104, v105
    v_xor_b32 v18, 64, v17
    s_add_u32 m0, s37, 4096
    s_add_u32 s38, s36, 8192
    buffer_load_dwordx4 v18, s[12:15], s38 offen lds
    v_accvgpr_write_b32 a168, v116
    v_accvgpr_write_b32 a146, v117
    v_pk_mul_f32 v[108:109], v[106:107], v[96:97] op_sel_hi:[1,0]
    v_pk_mul_f32 v[118:119], v[104:105], v[98:99] op_sel_hi:[1,0]
    v_pk_fma_f32 v[106:107], v[106:107], v[96:97], v[108:109] op_sel:[1,1,0] op_sel_hi:[0,1,1] neg_lo:[1,0,0]
    v_pk_fma_f32 v[104:105], v[104:105], v[98:99], v[118:119] op_sel:[1,1,0] op_sel_hi:[0,1,1] neg_lo:[1,0,0]
    v_cvt_pk_bf16_f32 v116, v106, -v107
    v_cvt_pk_bf16_f32 v117, v104, v105
    v_accvgpr_write_b32 a169, v116
    v_accvgpr_write_b32 a147, v117
    v_pk_mul_f32 v[108:109], v[106:107], v[96:97] op_sel_hi:[1,0]
    v_xor_b32 v19, 80, v17
    s_add_u32 m0, s37, 5120
    s_add_u32 s38, s36, 10240
    buffer_load_dwordx4 v19, s[12:15], s38 offen lds
    v_pk_mul_f32 v[118:119], v[104:105], v[98:99] op_sel_hi:[1,0]
    v_pk_fma_f32 v[106:107], v[106:107], v[96:97], v[108:109] op_sel:[1,1,0] op_sel_hi:[0,1,1] neg_lo:[1,0,0]
    v_pk_fma_f32 v[104:105], v[104:105], v[98:99], v[118:119] op_sel:[1,1,0] op_sel_hi:[0,1,1] neg_lo:[1,0,0]
    v_cvt_pk_bf16_f32 v116, v106, -v107
    v_cvt_pk_bf16_f32 v117, v104, v105
    v_accvgpr_write_b32 a170, v116
    v_accvgpr_write_b32 a148, v117
    v_pk_mul_f32 v[108:109], v[106:107], v[96:97] op_sel_hi:[1,0]
    v_pk_fma_f32 v[106:107], v[106:107], v[96:97], v[108:109] op_sel:[1,1,0] op_sel_hi:[0,1,1] neg_lo:[1,0,0]
    v_cvt_pk_bf16_f32 v116, v106, -v107
    v_accvgpr_write_b32 a171, v116
    v_xor_b32 v18, 96, v17
    s_add_u32 m0, s37, 6144
    s_add_u32 s38, s36, 12288
    buffer_load_dwordx4 v18, s[12:15], s38 offen lds
    v_pk_mul_f32 v[108:109], v[106:107], v[96:97] op_sel_hi:[1,0]
    v_pk_fma_f32 v[106:107], v[106:107], v[96:97], v[108:109] op_sel:[1,1,0] op_sel_hi:[0,1,1] neg_lo:[1,0,0]
    v_cvt_pk_bf16_f32 v116, v106, -v107
    v_accvgpr_write_b32 a172, v116
    v_pk_mul_f32 v[108:109], v[106:107], v[96:97] op_sel_hi:[1,0]
    v_pk_fma_f32 v[106:107], v[106:107], v[96:97], v[108:109] op_sel:[1,1,0] op_sel_hi:[0,1,1] neg_lo:[1,0,0]
    v_cvt_pk_bf16_f32 v116, v106, -v107
    v_accvgpr_write_b32 a173, v116
    v_pk_mul_f32 v[108:109], v[106:107], v[96:97] op_sel_hi:[1,0]
    v_pk_fma_f32 v[106:107], v[106:107], v[96:97], v[108:109] op_sel:[1,1,0] op_sel_hi:[0,1,1] neg_lo:[1,0,0]
    v_cvt_pk_bf16_f32 v116, v106, -v107
    v_xor_b32 v19, 112, v17
    s_add_u32 m0, s37, 7168
    s_add_u32 s38, s36, 14336
    buffer_load_dwordx4 v19, s[12:15], s38 offen lds
    v_accvgpr_write_b32 a174, v116
    v_pk_mul_f32 v[108:109], v[106:107], v[96:97] op_sel_hi:[1,0]
    v_pk_fma_f32 v[106:107], v[106:107], v[96:97], v[108:109] op_sel:[1,1,0] op_sel_hi:[0,1,1] neg_lo:[1,0,0]
    v_cvt_pk_bf16_f32 v116, v106, -v107
    v_accvgpr_write_b32 a175, v116
    v_pk_mul_f32 v[108:109], v[106:107], v[96:97] op_sel_hi:[1,0]
    v_pk_fma_f32 v[106:107], v[106:107], v[96:97], v[108:109] op_sel:[1,1,0] op_sel_hi:[0,1,1] neg_lo:[1,0,0]
    v_cvt_pk_bf16_f32 v116, v106, -v107
    v_accvgpr_write_b32 a176, v116
    v_pk_mul_f32 v[108:109], v[106:107], v[96:97] op_sel_hi:[1,0]
    v_pk_fma_f32 v[106:107], v[106:107], v[96:97], v[108:109] op_sel:[1,1,0] op_sel_hi:[0,1,1] neg_lo:[1,0,0]
    v_xor_b32 v18, 128, v17
    s_add_u32 m0, s37, 8192
    s_add_u32 s38, s36, 16384
    buffer_load_dwordx4 v18, s[12:15], s38 offen lds
    v_cvt_pk_bf16_f32 v116, v106, -v107
    v_accvgpr_write_b32 a177, v116
    v_pk_mul_f32 v[108:109], v[106:107], v[96:97] op_sel_hi:[1,0]
    v_pk_fma_f32 v[106:107], v[106:107], v[96:97], v[108:109] op_sel:[1,1,0] op_sel_hi:[0,1,1] neg_lo:[1,0,0]
    v_cvt_pk_bf16_f32 v116, v106, -v107
    v_accvgpr_write_b32 a178, v116
    v_pk_mul_f32 v[108:109], v[106:107], v[96:97] op_sel_hi:[1,0]
    v_pk_fma_f32 v[106:107], v[106:107], v[96:97], v[108:109] op_sel:[1,1,0] op_sel_hi:[0,1,1] neg_lo:[1,0,0]
    v_cvt_pk_bf16_f32 v116, v106, -v107
    v_accvgpr_write_b32 a179, v116
    v_pk_mul_f32 v[108:109], v[106:107], v[96:97] op_sel_hi:[1,0]
    v_xor_b32 v19, 144, v17
    s_add_u32 m0, s37, 9216
    s_add_u32 s38, s36, 18432
    buffer_load_dwordx4 v19, s[12:15], s38 offen lds
    v_pk_fma_f32 v[106:107], v[106:107], v[96:97], v[108:109] op_sel:[1,1,0] op_sel_hi:[0,1,1] neg_lo:[1,0,0]
    v_cvt_pk_bf16_f32 v116, v106, -v107
    v_accvgpr_write_b32 a180, v116
    v_lshlrev_b32 v80, 3, v0
    v_sub_u32 v80, 2047, v80
    s_mov_b32 s76, 128
    v_subrev_u32 v84, 0, v80
    v_subrev_u32 v85, 1, v80
    v_subrev_u32 v86, 2, v80
    v_subrev_u32 v87, 3, v80
    v_subrev_u32 v88, 4, v80
    v_xor_b32 v18, 160, v17
    s_add_u32 m0, s37, 10240
    s_add_u32 s38, s36, 20480
    buffer_load_dwordx4 v18, s[12:15], s38 offen lds
    v_subrev_u32 v89, 5, v80
    v_subrev_u32 v90, 6, v80
    v_subrev_u32 v91, 7, v80
    v_cvt_f32_i32 v92, v84
    v_cvt_f32_i32 v93, v85
    v_cvt_f32_i32 v94, v86
    v_cvt_f32_i32 v95, v87
    v_cvt_f32_i32 v96, v88
    v_cvt_f32_i32 v97, v89
    v_cvt_f32_i32 v98, v90
    v_cvt_f32_i32 v99, v91
    v_xor_b32 v19, 176, v17
    s_add_u32 m0, s37, 11264
    s_add_u32 s38, s36, 22528
    buffer_load_dwordx4 v19, s[12:15], s38 offen lds
    v_cvt_pk_bf16_f32 v92, v92, v92
    v_cvt_pk_bf16_f32 v93, v93, v93
    v_cvt_pk_bf16_f32 v94, v94, v94
    v_cvt_pk_bf16_f32 v95, v95, v95
    v_cvt_pk_bf16_f32 v96, v96, v96
    v_cvt_pk_bf16_f32 v97, v97, v97
    v_cvt_pk_bf16_f32 v98, v98, v98
    v_cvt_pk_bf16_f32 v99, v99, v99
    v_and_b32 v92, 0xffff, v92
    v_and_b32 v93, 0xffff, v93
    v_and_b32 v94, 0xffff, v94
    v_xor_b32 v18, 192, v17
    s_add_u32 m0, s37, 12288
    s_add_u32 s38, s36, 24576
    buffer_load_dwordx4 v18, s[12:15], s38 offen lds
    v_and_b32 v95, 0xffff, v95
    v_and_b32 v96, 0xffff, v96
    v_and_b32 v97, 0xffff, v97
    v_and_b32 v98, 0xffff, v98
    v_and_b32 v99, 0xffff, v99
    v_subrev_u32 v92, 17024, v92
    v_subrev_u32 v93, 17024, v93
    v_subrev_u32 v94, 17024, v94
    v_subrev_u32 v95, 17024, v95
    v_subrev_u32 v96, 17024, v96
    v_subrev_u32 v97, 17024, v97
    v_xor_b32 v19, 208, v17
    s_add_u32 m0, s37, 13312
    s_add_u32 s38, s36, 26624
    buffer_load_dwordx4 v19, s[12:15], s38 offen lds
    v_subrev_u32 v98, 17024, v98
    v_subrev_u32 v99, 17024, v99
    v_cmp_gt_i32 vcc, s76, v84
    v_lshlrev_b32 v100, 1, v84
    v_lshlrev_b32 v92, 1, v92
    v_cndmask_b32 v92, v92, v100, vcc
    v_cmp_gt_i32 vcc, s76, v85
    v_lshlrev_b32 v101, 1, v85
    v_lshlrev_b32 v93, 1, v93
    v_cndmask_b32 v93, v93, v101, vcc
    v_cmp_gt_i32 vcc, s76, v86
    v_xor_b32 v18, 224, v17
    s_add_u32 m0, s37, 14336
    s_add_u32 s38, s36, 28672
    buffer_load_dwordx4 v18, s[12:15], s38 offen lds
    v_lshlrev_b32 v100, 1, v86
    v_lshlrev_b32 v94, 1, v94
    v_cndmask_b32 v94, v94, v100, vcc
    v_cmp_gt_i32 vcc, s76, v87
    v_lshlrev_b32 v101, 1, v87
    v_lshlrev_b32 v95, 1, v95
    v_cndmask_b32 v95, v95, v101, vcc
    v_cmp_gt_i32 vcc, s76, v88
    v_lshlrev_b32 v100, 1, v88
    v_lshlrev_b32 v96, 1, v96
    v_cndmask_b32 v96, v96, v100, vcc
    v_xor_b32 v19, 240, v17
    s_add_u32 m0, s37, 15360
    s_add_u32 s38, s36, 30720
    buffer_load_dwordx4 v19, s[12:15], s38 offen lds
    v_cmp_gt_i32 vcc, s76, v89
    v_lshlrev_b32 v101, 1, v89
    v_lshlrev_b32 v97, 1, v97
    v_cndmask_b32 v97, v97, v101, vcc
    v_cmp_gt_i32 vcc, s76, v90
    v_lshlrev_b32 v100, 1, v90
    v_lshlrev_b32 v98, 1, v98
    v_cndmask_b32 v98, v98, v100, vcc
    v_cmp_gt_i32 vcc, s76, v91
    v_lshlrev_b32 v101, 1, v91
    v_lshlrev_b32 v99, 1, v99
    v_cndmask_b32 v99, v99, v101, vcc
    v_accvgpr_write_b32 a184, v92
    v_accvgpr_write_b32 a185, v93
    v_accvgpr_write_b32 a186, v94
    v_accvgpr_write_b32 a187, v95
    v_accvgpr_write_b32 a188, v96
    v_accvgpr_write_b32 a189, v97
    v_accvgpr_write_b32 a190, v98
    v_accvgpr_write_b32 a191, v99
    s_waitcnt vmcnt(16)
    s_mul_i32 s72, s3, 24576
    v_add_u32 v2, s72, v44
    v_add_u32 v3, s72, v46
    v_mov_b32 v48, 0
    v_mov_b32 v49, 0
    v_mov_b32 v50, 0
    ds_read_b64_tr_b16 v[56:57], v2 offset:0
    ds_read_b64_tr_b16 v[58:59], v2 offset:768
    ds_read_b64_tr_b16 v[60:61], v2 offset:64
    ds_read_b64_tr_b16 v[62:63], v2 offset:832
    ds_read_b64_tr_b16 v[64:65], v3 offset:0
    ds_read_b64_tr_b16 v[66:67], v3 offset:768
    ds_read_b64_tr_b16 v[68:69], v2 offset:3072
    ds_read_b64_tr_b16 v[70:71], v2 offset:3840
    ds_read_b64_tr_b16 v[72:73], v2 offset:3136
    ds_read_b64_tr_b16 v[74:75], v2 offset:3904
    ds_read_b64_tr_b16 v[76:77], v3 offset:3072
    ds_read_b64_tr_b16 v[78:79], v3 offset:3840
    s_waitcnt lgkmcnt(6)
    v_dot2_f32_bf16 v48, v56, s65, v48
    v_dot2_f32_bf16 v49, v60, s65, v49
    v_dot2_f32_bf16 v50, v64, s65, v50
    v_dot2_f32_bf16 v48, v57, s65, v48
    v_dot2_f32_bf16 v49, v61, s65, v49
    v_dot2_f32_bf16 v50, v65, s65, v50
    v_dot2_f32_bf16 v48, v58, s65, v48
    v_dot2_f32_bf16 v49, v62, s65, v49
    v_dot2_f32_bf16 v50, v66, s65, v50
    v_dot2_f32_bf16 v48, v59, s65, v48
    v_dot2_f32_bf16 v49, v63, s65, v49
    v_dot2_f32_bf16 v50, v67, s65, v50
    ds_read_b64_tr_b16 v[56:57], v2 offset:6144
    ds_read_b64_tr_b16 v[58:59], v2 offset:6912
    ds_read_b64_tr_b16 v[60:61], v2 offset:6208
    ds_read_b64_tr_b16 v[62:63], v2 offset:6976
    ds_read_b64_tr_b16 v[64:65], v3 offset:6144
    ds_read_b64_tr_b16 v[66:67], v3 offset:6912
    s_waitcnt lgkmcnt(6)
    v_dot2_f32_bf16 v48, v68, s65, v48
    v_dot2_f32_bf16 v49, v72, s65, v49
    v_dot2_f32_bf16 v50, v76, s65, v50
    v_dot2_f32_bf16 v48, v69, s65, v48
    v_dot2_f32_bf16 v49, v73, s65, v49
    v_dot2_f32_bf16 v50, v77, s65, v50
    v_dot2_f32_bf16 v48, v70, s65, v48
    v_dot2_f32_bf16 v49, v74, s65, v49
    v_dot2_f32_bf16 v50, v78, s65, v50
    v_dot2_f32_bf16 v48, v71, s65, v48
    v_dot2_f32_bf16 v49, v75, s65, v49
    v_dot2_f32_bf16 v50, v79, s65, v50
    ds_read_b64_tr_b16 v[68:69], v2 offset:9216
    ds_read_b64_tr_b16 v[70:71], v2 offset:9984
    ds_read_b64_tr_b16 v[72:73], v2 offset:9280
    ds_read_b64_tr_b16 v[74:75], v2 offset:10048
    ds_read_b64_tr_b16 v[76:77], v3 offset:9216
    ds_read_b64_tr_b16 v[78:79], v3 offset:9984
    s_waitcnt lgkmcnt(6)
    v_dot2_f32_bf16 v48, v56, s65, v48
    v_dot2_f32_bf16 v49, v60, s65, v49
    v_dot2_f32_bf16 v50, v64, s65, v50
    v_dot2_f32_bf16 v48, v57, s65, v48
    v_dot2_f32_bf16 v49, v61, s65, v49
    v_dot2_f32_bf16 v50, v65, s65, v50
    v_dot2_f32_bf16 v48, v58, s65, v48
    v_dot2_f32_bf16 v49, v62, s65, v49
    v_dot2_f32_bf16 v50, v66, s65, v50
    v_dot2_f32_bf16 v48, v59, s65, v48
    v_dot2_f32_bf16 v49, v63, s65, v49
    v_dot2_f32_bf16 v50, v67, s65, v50
    ds_read_b64_tr_b16 v[56:57], v2 offset:12288
    ds_read_b64_tr_b16 v[58:59], v2 offset:13056
    ds_read_b64_tr_b16 v[60:61], v2 offset:12352
    ds_read_b64_tr_b16 v[62:63], v2 offset:13120
    ds_read_b64_tr_b16 v[64:65], v3 offset:12288
    ds_read_b64_tr_b16 v[66:67], v3 offset:13056
    s_waitcnt lgkmcnt(6)
    v_dot2_f32_bf16 v48, v68, s65, v48
    v_dot2_f32_bf16 v49, v72, s65, v49
    v_dot2_f32_bf16 v50, v76, s65, v50
    v_dot2_f32_bf16 v48, v69, s65, v48
    v_dot2_f32_bf16 v49, v73, s65, v49
    v_dot2_f32_bf16 v50, v77, s65, v50
    v_dot2_f32_bf16 v48, v70, s65, v48
    v_dot2_f32_bf16 v49, v74, s65, v49
    v_dot2_f32_bf16 v50, v78, s65, v50
    v_dot2_f32_bf16 v48, v71, s65, v48
    v_dot2_f32_bf16 v49, v75, s65, v49
    v_dot2_f32_bf16 v50, v79, s65, v50
    ds_read_b64_tr_b16 v[68:69], v2 offset:15360
    ds_read_b64_tr_b16 v[70:71], v2 offset:16128
    ds_read_b64_tr_b16 v[72:73], v2 offset:15424
    ds_read_b64_tr_b16 v[74:75], v2 offset:16192
    ds_read_b64_tr_b16 v[76:77], v3 offset:15360
    ds_read_b64_tr_b16 v[78:79], v3 offset:16128
    s_waitcnt lgkmcnt(6)
    v_dot2_f32_bf16 v48, v56, s65, v48
    v_dot2_f32_bf16 v49, v60, s65, v49
    v_dot2_f32_bf16 v50, v64, s65, v50
    v_dot2_f32_bf16 v48, v57, s65, v48
    v_dot2_f32_bf16 v49, v61, s65, v49
    v_dot2_f32_bf16 v50, v65, s65, v50
    v_dot2_f32_bf16 v48, v58, s65, v48
    v_dot2_f32_bf16 v49, v62, s65, v49
    v_dot2_f32_bf16 v50, v66, s65, v50
    v_dot2_f32_bf16 v48, v59, s65, v48
    v_dot2_f32_bf16 v49, v63, s65, v49
    v_dot2_f32_bf16 v50, v67, s65, v50
    ds_read_b64_tr_b16 v[56:57], v2 offset:18432
    ds_read_b64_tr_b16 v[58:59], v2 offset:19200
    ds_read_b64_tr_b16 v[60:61], v2 offset:18496
    ds_read_b64_tr_b16 v[62:63], v2 offset:19264
    ds_read_b64_tr_b16 v[64:65], v3 offset:18432
    ds_read_b64_tr_b16 v[66:67], v3 offset:19200
    s_waitcnt lgkmcnt(6)
    v_dot2_f32_bf16 v48, v68, s65, v48
    v_dot2_f32_bf16 v49, v72, s65, v49
    v_dot2_f32_bf16 v50, v76, s65, v50
    v_dot2_f32_bf16 v48, v69, s65, v48
    v_dot2_f32_bf16 v49, v73, s65, v49
    v_dot2_f32_bf16 v50, v77, s65, v50
    v_dot2_f32_bf16 v48, v70, s65, v48
    v_dot2_f32_bf16 v49, v74, s65, v49
    v_dot2_f32_bf16 v50, v78, s65, v50
    v_dot2_f32_bf16 v48, v71, s65, v48
    v_dot2_f32_bf16 v49, v75, s65, v49
    v_dot2_f32_bf16 v50, v79, s65, v50
    ds_read_b64_tr_b16 v[68:69], v2 offset:21504
    ds_read_b64_tr_b16 v[70:71], v2 offset:22272
    ds_read_b64_tr_b16 v[72:73], v2 offset:21568
    ds_read_b64_tr_b16 v[74:75], v2 offset:22336
    ds_read_b64_tr_b16 v[76:77], v3 offset:21504
    ds_read_b64_tr_b16 v[78:79], v3 offset:22272
    s_waitcnt lgkmcnt(6)
    v_dot2_f32_bf16 v48, v56, s65, v48
    v_dot2_f32_bf16 v49, v60, s65, v49
    v_dot2_f32_bf16 v50, v64, s65, v50
    v_dot2_f32_bf16 v48, v57, s65, v48
    v_dot2_f32_bf16 v49, v61, s65, v49
    v_dot2_f32_bf16 v50, v65, s65, v50
    v_dot2_f32_bf16 v48, v58, s65, v48
    v_dot2_f32_bf16 v49, v62, s65, v49
    v_dot2_f32_bf16 v50, v66, s65, v50
    v_dot2_f32_bf16 v48, v59, s65, v48
    v_dot2_f32_bf16 v49, v63, s65, v49
    v_dot2_f32_bf16 v50, v67, s65, v50
    s_waitcnt lgkmcnt(0)
    v_dot2_f32_bf16 v48, v68, s65, v48
    v_dot2_f32_bf16 v49, v72, s65, v49
    v_dot2_f32_bf16 v50, v76, s65, v50
    v_dot2_f32_bf16 v48, v69, s65, v48
    v_dot2_f32_bf16 v49, v73, s65, v49
    v_dot2_f32_bf16 v50, v77, s65, v50
    v_dot2_f32_bf16 v48, v70, s65, v48
    v_dot2_f32_bf16 v49, v74, s65, v49
    v_dot2_f32_bf16 v50, v78, s65, v50
    v_dot2_f32_bf16 v48, v71, s65, v48
    v_dot2_f32_bf16 v49, v75, s65, v49
    v_dot2_f32_bf16 v50, v79, s65, v50
    s_waitcnt vmcnt(0)
    v_xor_b32 v22, 0, v20
    ds_read_b128 v[128:131], v22
    v_xor_b32 v23, 32, v20
    ds_read_b128 v[132:135], v23
    v_xor_b32 v22, 64, v20
    ds_read_b128 v[136:139], v22
    v_xor_b32 v23, 96, v20
    ds_read_b128 v[140:143], v23
    v_xor_b32 v22, 128, v20
    ds_read_b128 v[144:147], v22
    v_xor_b32 v23, 160, v20
    ds_read_b128 v[148:151], v23
    v_xor_b32 v22, 192, v20
    ds_read_b128 v[152:155], v22
    v_xor_b32 v23, 224, v20
    ds_read_b128 v[156:159], v23
    v_xor_b32 v22, 256, v20
    ds_read_b128 v[160:163], v22
    v_xor_b32 v23, 288, v20
    ds_read_b128 v[164:167], v23
    v_xor_b32 v22, 320, v20
    ds_read_b128 v[168:171], v22
    v_xor_b32 v23, 352, v20
    ds_read_b128 v[172:175], v23
    s_waitcnt lgkmcnt(6)
    v_xor_b32 v22, 384, v20
    ds_read_b128 v[176:179], v22
    v_xor_b32 v23, 416, v20
    ds_read_b128 v[180:183], v23
    v_xor_b32 v22, 448, v20
    ds_read_b128 v[184:187], v22
    v_xor_b32 v23, 480, v20
    ds_read_b128 v[188:191], v23
    s_waitcnt lgkmcnt(0)
    s_lshl_b32 s36, s6, 17
    s_lshl_b32 s73, s3, 15
    s_add_u32 s36, s36, s73
    s_add_u32 s36, s36, 512
    s_lshl_b32 s37, s3, 14
    s_add_u32 s37, s37, 98304
    s_barrier
    s_cmp_lg_u32 s6, 0
    s_cbranch_scc1 Lkz_6
    s_cmp_lg_u32 s3, 0
    s_cbranch_scc1 Lkz_6
    s_lshl_b32 s72, s7, 2
    s_add_u32 s72, s72, 64
    v_mov_b32 v2, s72
    v_mov_b32 v3, s64
    s_mov_b64 exec, 1
    buffer_store_dword v3, v2, s[28:31], 0 offen sc0 sc1
    s_mov_b64 exec, -1
Lkz_6:
    ds_read_b64_tr_b16 v[56:57], v44 offset:0
    ds_read_b64_tr_b16 v[58:59], v44 offset:768
    ds_read_b64_tr_b16 v[60:61], v44 offset:64
    ds_read_b64_tr_b16 v[62:63], v44 offset:832
    ds_read_b64_tr_b16 v[64:65], v46 offset:0
    ds_read_b64_tr_b16 v[66:67], v46 offset:768
    ds_read_b64_tr_b16 v[68:69], v44 offset:3072
    ds_read_b64_tr_b16 v[70:71], v44 offset:3840
    ds_read_b64_tr_b16 v[72:73], v44 offset:3136
    ds_read_b64_tr_b16 v[74:75], v44 offset:3904
    ds_read_b64_tr_b16 v[76:77], v46 offset:3072
    ds_read_b64_tr_b16 v[78:79], v46 offset:3840
    s_waitcnt lgkmcnt(6)
    v_mfma_f32_32x32x16_bf16 v[80:95], v[56:59], v[128:131], 0
    v_mfma_f32_32x32x16_bf16 v[96:111], v[60:63], v[128:131], 0
    v_xor_b32 v18, 0, v17
    s_add_u32 m0, s37, 0
    s_add_u32 s38, s36, 0
    buffer_load_dwordx4 v18, s[12:15], s38 offen lds
    v_mfma_f32_32x32x16_bf16 v[112:127], v[64:67], v[128:131], 0
    ds_read_b64_tr_b16 v[56:57], v44 offset:6144
    ds_read_b64_tr_b16 v[58:59], v44 offset:6912
    ds_read_b64_tr_b16 v[60:61], v44 offset:6208
    ds_read_b64_tr_b16 v[62:63], v44 offset:6976
    ds_read_b64_tr_b16 v[64:65], v46 offset:6144
    ds_read_b64_tr_b16 v[66:67], v46 offset:6912
    s_waitcnt lgkmcnt(6)
    v_mfma_f32_32x32x16_bf16 v[80:95], v[68:71], v[132:135], v[80:95]
    v_mfma_f32_32x32x16_bf16 v[96:111], v[72:75], v[132:135], v[96:111]
    v_xor_b32 v19, 16, v17
    s_add_u32 m0, s37, 1024
    s_add_u32 s38, s36, 2048
    buffer_load_dwordx4 v19, s[12:15], s38 offen lds
    v_mfma_f32_32x32x16_bf16 v[112:127], v[76:79], v[132:135], v[112:127]
    ds_read_b64_tr_b16 v[68:69], v44 offset:9216
    ds_read_b64_tr_b16 v[70:71], v44 offset:9984
    ds_read_b64_tr_b16 v[72:73], v44 offset:9280
    ds_read_b64_tr_b16 v[74:75], v44 offset:10048
    ds_read_b64_tr_b16 v[76:77], v46 offset:9216
    ds_read_b64_tr_b16 v[78:79], v46 offset:9984
    s_waitcnt lgkmcnt(6)
    v_mfma_f32_32x32x16_bf16 v[80:95], v[56:59], v[136:139], v[80:95]
    v_mfma_f32_32x32x16_bf16 v[96:111], v[60:63], v[136:139], v[96:111]
    v_xor_b32 v18, 32, v17
    s_add_u32 m0, s37, 2048
    s_add_u32 s38, s36, 4096
    buffer_load_dwordx4 v18, s[12:15], s38 offen lds
    v_mfma_f32_32x32x16_bf16 v[112:127], v[64:67], v[136:139], v[112:127]
    ds_read_b64_tr_b16 v[56:57], v44 offset:12288
    ds_read_b64_tr_b16 v[58:59], v44 offset:13056
    ds_read_b64_tr_b16 v[60:61], v44 offset:12352
    ds_read_b64_tr_b16 v[62:63], v44 offset:13120
    ds_read_b64_tr_b16 v[64:65], v46 offset:12288
    ds_read_b64_tr_b16 v[66:67], v46 offset:13056
    s_waitcnt lgkmcnt(6)
    v_mfma_f32_32x32x16_bf16 v[80:95], v[68:71], v[140:143], v[80:95]
    v_mfma_f32_32x32x16_bf16 v[96:111], v[72:75], v[140:143], v[96:111]
    v_xor_b32 v19, 48, v17
    s_add_u32 m0, s37, 3072
    s_add_u32 s38, s36, 6144
    buffer_load_dwordx4 v19, s[12:15], s38 offen lds
    v_mfma_f32_32x32x16_bf16 v[112:127], v[76:79], v[140:143], v[112:127]
    ds_read_b64_tr_b16 v[68:69], v44 offset:15360
    ds_read_b64_tr_b16 v[70:71], v44 offset:16128
    ds_read_b64_tr_b16 v[72:73], v44 offset:15424
    ds_read_b64_tr_b16 v[74:75], v44 offset:16192
    ds_read_b64_tr_b16 v[76:77], v46 offset:15360
    ds_read_b64_tr_b16 v[78:79], v46 offset:16128
    s_waitcnt lgkmcnt(6)
    v_mfma_f32_32x32x16_bf16 v[80:95], v[56:59], v[144:147], v[80:95]
    v_mfma_f32_32x32x16_bf16 v[96:111], v[60:63], v[144:147], v[96:111]
    v_xor_b32 v18, 64, v17
    s_add_u32 m0, s37, 4096
    s_add_u32 s38, s36, 8192
    buffer_load_dwordx4 v18, s[12:15], s38 offen lds
    v_mfma_f32_32x32x16_bf16 v[112:127], v[64:67], v[144:147], v[112:127]
    ds_read_b64_tr_b16 v[56:57], v44 offset:18432
    ds_read_b64_tr_b16 v[58:59], v44 offset:19200
    ds_read_b64_tr_b16 v[60:61], v44 offset:18496
    ds_read_b64_tr_b16 v[62:63], v44 offset:19264
    ds_read_b64_tr_b16 v[64:65], v46 offset:18432
    ds_read_b64_tr_b16 v[66:67], v46 offset:19200
    s_waitcnt lgkmcnt(6)
    v_mfma_f32_32x32x16_bf16 v[80:95], v[68:71], v[148:151], v[80:95]
    v_mfma_f32_32x32x16_bf16 v[96:111], v[72:75], v[148:151], v[96:111]
    v_xor_b32 v19, 80, v17
    s_add_u32 m0, s37, 5120
    s_add_u32 s38, s36, 10240
    buffer_load_dwordx4 v19, s[12:15], s38 offen lds
    v_mfma_f32_32x32x16_bf16 v[112:127], v[76:79], v[148:151], v[112:127]
    ds_read_b64_tr_b16 v[68:69], v44 offset:21504
    ds_read_b64_tr_b16 v[70:71], v44 offset:22272
    ds_read_b64_tr_b16 v[72:73], v44 offset:21568
    ds_read_b64_tr_b16 v[74:75], v44 offset:22336
    ds_read_b64_tr_b16 v[76:77], v46 offset:21504
    ds_read_b64_tr_b16 v[78:79], v46 offset:22272
    s_waitcnt lgkmcnt(6)
    v_mfma_f32_32x32x16_bf16 v[80:95], v[56:59], v[152:155], v[80:95]
    v_mfma_f32_32x32x16_bf16 v[96:111], v[60:63], v[152:155], v[96:111]
    v_xor_b32 v18, 96, v17
    s_add_u32 m0, s37, 6144
    s_add_u32 s38, s36, 12288
    buffer_load_dwordx4 v18, s[12:15], s38 offen lds
    v_mfma_f32_32x32x16_bf16 v[112:127], v[64:67], v[152:155], v[112:127]
    ds_read_b64_tr_b16 v[56:57], v44 offset:24576
    ds_read_b64_tr_b16 v[58:59], v44 offset:25344
    ds_read_b64_tr_b16 v[60:61], v44 offset:24640
    ds_read_b64_tr_b16 v[62:63], v44 offset:25408
    ds_read_b64_tr_b16 v[64:65], v46 offset:24576
    ds_read_b64_tr_b16 v[66:67], v46 offset:25344
    s_waitcnt lgkmcnt(6)
    v_mfma_f32_32x32x16_bf16 v[80:95], v[68:71], v[156:159], v[80:95]
    v_mfma_f32_32x32x16_bf16 v[96:111], v[72:75], v[156:159], v[96:111]
    v_xor_b32 v19, 112, v17
    s_add_u32 m0, s37, 7168
    s_add_u32 s38, s36, 14336
    buffer_load_dwordx4 v19, s[12:15], s38 offen lds
    v_mfma_f32_32x32x16_bf16 v[112:127], v[76:79], v[156:159], v[112:127]
    ds_read_b64_tr_b16 v[68:69], v44 offset:27648
    ds_read_b64_tr_b16 v[70:71], v44 offset:28416
    ds_read_b64_tr_b16 v[72:73], v44 offset:27712
    ds_read_b64_tr_b16 v[74:75], v44 offset:28480
    ds_read_b64_tr_b16 v[76:77], v46 offset:27648
    ds_read_b64_tr_b16 v[78:79], v46 offset:28416
    s_waitcnt lgkmcnt(6)
    v_mfma_f32_32x32x16_bf16 v[80:95], v[56:59], v[160:163], v[80:95]
    v_mfma_f32_32x32x16_bf16 v[96:111], v[60:63], v[160:163], v[96:111]
    v_xor_b32 v18, 128, v17
    s_add_u32 m0, s37, 8192
    s_add_u32 s38, s36, 16384
    buffer_load_dwordx4 v18, s[12:15], s38 offen lds
    v_mfma_f32_32x32x16_bf16 v[112:127], v[64:67], v[160:163], v[112:127]
    ds_read_b64_tr_b16 v[56:57], v44 offset:30720
    ds_read_b64_tr_b16 v[58:59], v44 offset:31488
    ds_read_b64_tr_b16 v[60:61], v44 offset:30784
    ds_read_b64_tr_b16 v[62:63], v44 offset:31552
    ds_read_b64_tr_b16 v[64:65], v46 offset:30720
    ds_read_b64_tr_b16 v[66:67], v46 offset:31488
    s_waitcnt lgkmcnt(6)
    v_mfma_f32_32x32x16_bf16 v[80:95], v[68:71], v[164:167], v[80:95]
    v_mfma_f32_32x32x16_bf16 v[96:111], v[72:75], v[164:167], v[96:111]
    v_xor_b32 v19, 144, v17
    s_add_u32 m0, s37, 9216
    s_add_u32 s38, s36, 18432
    buffer_load_dwordx4 v19, s[12:15], s38 offen lds
    v_mfma_f32_32x32x16_bf16 v[112:127], v[76:79], v[164:167], v[112:127]
    ds_read_b64_tr_b16 v[68:69], v44 offset:33792
    ds_read_b64_tr_b16 v[70:71], v44 offset:34560
    ds_read_b64_tr_b16 v[72:73], v44 offset:33856
    ds_read_b64_tr_b16 v[74:75], v44 offset:34624
    ds_read_b64_tr_b16 v[76:77], v46 offset:33792
    ds_read_b64_tr_b16 v[78:79], v46 offset:34560
    s_waitcnt lgkmcnt(6)
    v_mfma_f32_32x32x16_bf16 v[80:95], v[56:59], v[168:171], v[80:95]
    v_mfma_f32_32x32x16_bf16 v[96:111], v[60:63], v[168:171], v[96:111]
    v_xor_b32 v18, 160, v17
    s_add_u32 m0, s37, 10240
    s_add_u32 s38, s36, 20480
    buffer_load_dwordx4 v18, s[12:15], s38 offen lds
    v_mfma_f32_32x32x16_bf16 v[112:127], v[64:67], v[168:171], v[112:127]
    ds_read_b64_tr_b16 v[56:57], v44 offset:36864
    ds_read_b64_tr_b16 v[58:59], v44 offset:37632
    ds_read_b64_tr_b16 v[60:61], v44 offset:36928
    ds_read_b64_tr_b16 v[62:63], v44 offset:37696
    ds_read_b64_tr_b16 v[64:65], v46 offset:36864
    ds_read_b64_tr_b16 v[66:67], v46 offset:37632
    s_waitcnt lgkmcnt(6)
    v_mfma_f32_32x32x16_bf16 v[80:95], v[68:71], v[172:175], v[80:95]
    v_mfma_f32_32x32x16_bf16 v[96:111], v[72:75], v[172:175], v[96:111]
    v_xor_b32 v19, 176, v17
    s_add_u32 m0, s37, 11264
    s_add_u32 s38, s36, 22528
    buffer_load_dwordx4 v19, s[12:15], s38 offen lds
    v_mfma_f32_32x32x16_bf16 v[112:127], v[76:79], v[172:175], v[112:127]
    ds_read_b64_tr_b16 v[68:69], v44 offset:39936
    ds_read_b64_tr_b16 v[70:71], v44 offset:40704
    ds_read_b64_tr_b16 v[72:73], v44 offset:40000
    ds_read_b64_tr_b16 v[74:75], v44 offset:40768
    ds_read_b64_tr_b16 v[76:77], v46 offset:39936
    ds_read_b64_tr_b16 v[78:79], v46 offset:40704
    s_waitcnt lgkmcnt(6)
    v_mfma_f32_32x32x16_bf16 v[80:95], v[56:59], v[176:179], v[80:95]
    v_mfma_f32_32x32x16_bf16 v[96:111], v[60:63], v[176:179], v[96:111]
    v_xor_b32 v18, 192, v17
    s_add_u32 m0, s37, 12288
    s_add_u32 s38, s36, 24576
    buffer_load_dwordx4 v18, s[12:15], s38 offen lds
    v_mfma_f32_32x32x16_bf16 v[112:127], v[64:67], v[176:179], v[112:127]
    ds_read_b64_tr_b16 v[56:57], v44 offset:43008
    ds_read_b64_tr_b16 v[58:59], v44 offset:43776
    ds_read_b64_tr_b16 v[60:61], v44 offset:43072
    ds_read_b64_tr_b16 v[62:63], v44 offset:43840
    ds_read_b64_tr_b16 v[64:65], v46 offset:43008
    ds_read_b64_tr_b16 v[66:67], v46 offset:43776
    s_waitcnt lgkmcnt(6)
    v_mfma_f32_32x32x16_bf16 v[80:95], v[68:71], v[180:183], v[80:95]
    v_mfma_f32_32x32x16_bf16 v[96:111], v[72:75], v[180:183], v[96:111]
    v_xor_b32 v19, 208, v17
    s_add_u32 m0, s37, 13312
    s_add_u32 s38, s36, 26624
    buffer_load_dwordx4 v19, s[12:15], s38 offen lds
    v_mfma_f32_32x32x16_bf16 v[112:127], v[76:79], v[180:183], v[112:127]
    ds_read_b64_tr_b16 v[68:69], v44 offset:46080
    ds_read_b64_tr_b16 v[70:71], v44 offset:46848
    ds_read_b64_tr_b16 v[72:73], v44 offset:46144
    ds_read_b64_tr_b16 v[74:75], v44 offset:46912
    ds_read_b64_tr_b16 v[76:77], v46 offset:46080
    ds_read_b64_tr_b16 v[78:79], v46 offset:46848
    s_waitcnt lgkmcnt(6)
    v_mfma_f32_32x32x16_bf16 v[80:95], v[56:59], v[184:187], v[80:95]
    v_mfma_f32_32x32x16_bf16 v[96:111], v[60:63], v[184:187], v[96:111]
    v_xor_b32 v18, 224, v17
    s_add_u32 m0, s37, 14336
    s_add_u32 s38, s36, 28672
    buffer_load_dwordx4 v18, s[12:15], s38 offen lds
    v_mfma_f32_32x32x16_bf16 v[112:127], v[64:67], v[184:187], v[112:127]
    s_waitcnt lgkmcnt(0)
    v_mfma_f32_32x32x16_bf16 v[80:95], v[68:71], v[188:191], v[80:95]
    v_mfma_f32_32x32x16_bf16 v[96:111], v[72:75], v[188:191], v[96:111]
    v_xor_b32 v19, 240, v17
    s_add_u32 m0, s37, 15360
    s_add_u32 s38, s36, 30720
    buffer_load_dwordx4 v19, s[12:15], s38 offen lds
    v_mfma_f32_32x32x16_bf16 v[112:127], v[76:79], v[188:191], v[112:127]
    s_waitcnt vmcnt(0)
    v_xor_b32 v22, 0, v20
    ds_read_b128 v[192:195], v22
    v_xor_b32 v23, 32, v20
    ds_read_b128 v[196:199], v23
    v_xor_b32 v22, 64, v20
    ds_read_b128 v[200:203], v22
    v_xor_b32 v23, 96, v20
    ds_read_b128 v[204:207], v23
    v_xor_b32 v22, 128, v20
    ds_read_b128 v[208:211], v22
    v_xor_b32 v23, 160, v20
    ds_read_b128 v[212:215], v23
    v_xor_b32 v22, 192, v20
    ds_read_b128 v[216:219], v22
    v_xor_b32 v23, 224, v20
    ds_read_b128 v[220:223], v23
    v_xor_b32 v22, 256, v20
    ds_read_b128 v[224:227], v22
    v_xor_b32 v23, 288, v20
    ds_read_b128 v[228:231], v23
    v_xor_b32 v22, 320, v20
    ds_read_b128 v[232:235], v22
    v_xor_b32 v23, 352, v20
    ds_read_b128 v[236:239], v23
    s_waitcnt lgkmcnt(6)
    v_xor_b32 v22, 384, v20
    ds_read_b128 v[240:243], v22
    v_xor_b32 v23, 416, v20
    ds_read_b128 v[244:247], v23
    v_xor_b32 v22, 448, v20
    ds_read_b128 v[248:251], v22
    v_xor_b32 v23, 480, v20
    ds_read_b128 v[252:255], v23
    s_lshl_b32 s74, s7, 2
    s_add_u32 s74, s74, 64
    v_mov_b32 v42, s74
    buffer_load_dword v43, v42, s[28:31], 0 offen sc1
    v_and_b32 v40, 15, v1
    v_bfe_u32 v52, v1, 4, 1
    v_lshl_add_u32 v40, v40, 1, v52
    v_lshlrev_b32 v40, 4, v40
    s_lshl_b32 s72, s6, 11
    s_lshl_b32 s73, s3, 9
    s_add_u32 s72, s72, s73
    s_add_u32 s39, s72, 327680
    buffer_load_dwordx4 v[52:55], v40, s[8:11], s39 offen sc1
    v_mov_b32 v8, v48
    v_mov_b32 v9, v49
    v_mov_b32 v10, v50
    v_permlane32_swap_b32 v48, v8
    v_permlane32_swap_b32 v49, v9
    v_permlane32_swap_b32 v50, v10
    v_add_f32 v48, v48, v8
    v_add_f32 v49, v49, v9
    v_add_f32 v50, v50, v10
    v_and_b32 v8, 31, v1
    v_lshlrev_b32 v8, 4, v8
    s_lshl_b32 s72, s3, 2
    s_add_u32 s72, s72, 159744
    v_add_u32 v9, s72, v8
    s_waitcnt lgkmcnt(0)
    s_barrier
    ds_write_b32 v9, v48 offset:0
    ds_write_b32 v9, v49 offset:512
    ds_write_b32 v9, v50 offset:1024
    s_waitcnt lgkmcnt(0)
    s_barrier
    v_add_u32 v8, 159744, v8
    ds_read_b128 v[24:27], v8 offset:0
    ds_read_b128 v[28:31], v8 offset:512
    ds_read_b128 v[32:35], v8 offset:1024
    s_min_u32 s74, s3, 2
    s_mul_i32 s72, s6, 6144
    s_lshl_b32 s73, s74, 6
    s_cmp_eq_u32 s74, 2
    s_cselect_b32 s73, 0, s73
    s_cselect_b64 vcc, -1, 0
    s_add_u32 s72, s72, s73
    v_cndmask_b32 v2, v44, v46, vcc
    v_add_u32 v2, s72, v2
    ds_read_b64_tr_b16 v[4:5], v2
    ds_read_b64_tr_b16 v[6:7], v2 offset:768
    ds_read_b64_tr_b16 v[8:9], v2 offset:3072
    ds_read_b64_tr_b16 v[10:11], v2 offset:3840
    s_mul_i32 s72, s7, 98304
    s_mul_i32 s73, s6, 6144
    s_add_u32 s72, s72, s73
    s_lshl_b32 s73, s74, 10
    s_add_u32 s72, s72, s73
    s_add_u32 s72, s72, 1048576
    v_lshlrev_b32 v3, 4, v1
    s_waitcnt lgkmcnt(0)
    buffer_store_dwordx4 v[4:7], v3, s[8:11], s72 offen sc1
    s_add_u32 s72, s72, 3072
    buffer_store_dwordx4 v[8:11], v3, s[8:11], s72 offen sc1
    ds_read_b64_tr_b16 v[56:57], v45 offset:0
    ds_read_b64_tr_b16 v[58:59], v45 offset:768
    ds_read_b64_tr_b16 v[60:61], v45 offset:64
    ds_read_b64_tr_b16 v[62:63], v45 offset:832
    ds_read_b64_tr_b16 v[64:65], v47 offset:0
    ds_read_b64_tr_b16 v[66:67], v47 offset:768
    v_lshrrev_b32 v41, 2, v1
    v_and_b32 v21, 3, v1
    v_bfe_u32 v22, v1, 4, 1
    v_lshlrev_b32 v22, 1, v22
    v_xor_b32 v21, v21, v22
    v_lshlrev_b32 v41, 10, v41
    v_lshl_add_u32 v41, v21, 4, v41
    s_lshl_b32 s36, s68, 8
    s_lshl_b32 s73, s3, 6
    s_add_u32 s36, s36, s73
    s_add_u32 s36, s36, 0
    s_lshl_b32 s37, s3, 14
    s_add_u32 s37, s37, 98304
    ds_read_b64_tr_b16 v[68:69], v45 offset:3072
    ds_read_b64_tr_b16 v[70:71], v45 offset:3840
    ds_read_b64_tr_b16 v[72:73], v45 offset:3136
    ds_read_b64_tr_b16 v[74:75], v45 offset:3904
    ds_read_b64_tr_b16 v[76:77], v47 offset:3072
    ds_read_b64_tr_b16 v[78:79], v47 offset:3840
    s_waitcnt lgkmcnt(6)
    v_mfma_f32_32x32x16_bf16 v[80:95], v[56:59], v[192:195], v[80:95]
    v_mfma_f32_32x32x16_bf16 v[96:111], v[60:63], v[192:195], v[96:111]
    s_add_u32 m0, s37, 0
    s_add_u32 s38, s36, 0
    buffer_load_dwordx4 v41, s[32:35], s38 offen lds
    v_mfma_f32_32x32x16_bf16 v[112:127], v[64:67], v[192:195], v[112:127]
    ds_read_b64_tr_b16 v[56:57], v45 offset:6144
    ds_read_b64_tr_b16 v[58:59], v45 offset:6912
    ds_read_b64_tr_b16 v[60:61], v45 offset:6208
    ds_read_b64_tr_b16 v[62:63], v45 offset:6976
    ds_read_b64_tr_b16 v[64:65], v47 offset:6144
    ds_read_b64_tr_b16 v[66:67], v47 offset:6912
    s_waitcnt lgkmcnt(6)
    v_mfma_f32_32x32x16_bf16 v[80:95], v[68:71], v[196:199], v[80:95]
    v_mfma_f32_32x32x16_bf16 v[96:111], v[72:75], v[196:199], v[96:111]
    s_add_u32 m0, s37, 1024
    s_add_u32 s38, s36, 16384
    buffer_load_dwordx4 v41, s[32:35], s38 offen lds
    v_mfma_f32_32x32x16_bf16 v[112:127], v[76:79], v[196:199], v[112:127]
    ds_read_b64_tr_b16 v[68:69], v45 offset:9216
    ds_read_b64_tr_b16 v[70:71], v45 offset:9984
    ds_read_b64_tr_b16 v[72:73], v45 offset:9280
    ds_read_b64_tr_b16 v[74:75], v45 offset:10048
    ds_read_b64_tr_b16 v[76:77], v47 offset:9216
    ds_read_b64_tr_b16 v[78:79], v47 offset:9984
    s_waitcnt lgkmcnt(6)
    v_mfma_f32_32x32x16_bf16 v[80:95], v[56:59], v[200:203], v[80:95]
    v_mfma_f32_32x32x16_bf16 v[96:111], v[60:63], v[200:203], v[96:111]
    s_add_u32 m0, s37, 2048
    s_add_u32 s38, s36, 32768
    buffer_load_dwordx4 v41, s[32:35], s38 offen lds
    v_mfma_f32_32x32x16_bf16 v[112:127], v[64:67], v[200:203], v[112:127]
    ds_read_b64_tr_b16 v[56:57], v45 offset:12288
    ds_read_b64_tr_b16 v[58:59], v45 offset:13056
    ds_read_b64_tr_b16 v[60:61], v45 offset:12352
    ds_read_b64_tr_b16 v[62:63], v45 offset:13120
    ds_read_b64_tr_b16 v[64:65], v47 offset:12288
    ds_read_b64_tr_b16 v[66:67], v47 offset:13056
    s_waitcnt lgkmcnt(6)
    v_mfma_f32_32x32x16_bf16 v[80:95], v[68:71], v[204:207], v[80:95]
    v_mfma_f32_32x32x16_bf16 v[96:111], v[72:75], v[204:207], v[96:111]
    s_add_u32 m0, s37, 3072
    s_add_u32 s38, s36, 49152
    buffer_load_dwordx4 v41, s[32:35], s38 offen lds
    v_mfma_f32_32x32x16_bf16 v[112:127], v[76:79], v[204:207], v[112:127]
    ds_read_b64_tr_b16 v[68:69], v45 offset:15360
    ds_read_b64_tr_b16 v[70:71], v45 offset:16128
    ds_read_b64_tr_b16 v[72:73], v45 offset:15424
    ds_read_b64_tr_b16 v[74:75], v45 offset:16192
    ds_read_b64_tr_b16 v[76:77], v47 offset:15360
    ds_read_b64_tr_b16 v[78:79], v47 offset:16128
    s_waitcnt lgkmcnt(6)
    v_mfma_f32_32x32x16_bf16 v[80:95], v[56:59], v[208:211], v[80:95]
    v_mfma_f32_32x32x16_bf16 v[96:111], v[60:63], v[208:211], v[96:111]
    s_add_u32 m0, s37, 4096
    s_add_u32 s38, s36, 65536
    buffer_load_dwordx4 v41, s[32:35], s38 offen lds
    v_mfma_f32_32x32x16_bf16 v[112:127], v[64:67], v[208:211], v[112:127]
    ds_read_b64_tr_b16 v[56:57], v45 offset:18432
    ds_read_b64_tr_b16 v[58:59], v45 offset:19200
    ds_read_b64_tr_b16 v[60:61], v45 offset:18496
    ds_read_b64_tr_b16 v[62:63], v45 offset:19264
    ds_read_b64_tr_b16 v[64:65], v47 offset:18432
    ds_read_b64_tr_b16 v[66:67], v47 offset:19200
    s_waitcnt lgkmcnt(6)
    v_mfma_f32_32x32x16_bf16 v[80:95], v[68:71], v[212:215], v[80:95]
    v_mfma_f32_32x32x16_bf16 v[96:111], v[72:75], v[212:215], v[96:111]
    s_add_u32 m0, s37, 5120
    s_add_u32 s38, s36, 81920
    buffer_load_dwordx4 v41, s[32:35], s38 offen lds
    v_mfma_f32_32x32x16_bf16 v[112:127], v[76:79], v[212:215], v[112:127]
    s_barrier
    ds_read_b64_tr_b16 v[68:69], v45 offset:21504
    ds_read_b64_tr_b16 v[70:71], v45 offset:22272
    ds_read_b64_tr_b16 v[72:73], v45 offset:21568
    ds_read_b64_tr_b16 v[74:75], v45 offset:22336
    ds_read_b64_tr_b16 v[76:77], v47 offset:21504
    ds_read_b64_tr_b16 v[78:79], v47 offset:22272
    s_waitcnt lgkmcnt(6)
    v_mfma_f32_32x32x16_bf16 v[80:95], v[56:59], v[216:219], v[80:95]
    v_mfma_f32_32x32x16_bf16 v[96:111], v[60:63], v[216:219], v[96:111]
    s_add_u32 m0, s37, 6144
    s_add_u32 s38, s36, 98304
    buffer_load_dwordx4 v41, s[32:35], s38 offen lds
    v_mfma_f32_32x32x16_bf16 v[112:127], v[64:67], v[216:219], v[112:127]
    ds_read_b64_tr_b16 v[56:57], v45 offset:24576
    ds_read_b64_tr_b16 v[58:59], v45 offset:25344
    ds_read_b64_tr_b16 v[60:61], v45 offset:24640
    ds_read_b64_tr_b16 v[62:63], v45 offset:25408
    ds_read_b64_tr_b16 v[64:65], v47 offset:24576
    ds_read_b64_tr_b16 v[66:67], v47 offset:25344
    s_waitcnt lgkmcnt(6)
    v_mfma_f32_32x32x16_bf16 v[80:95], v[68:71], v[220:223], v[80:95]
    v_mfma_f32_32x32x16_bf16 v[96:111], v[72:75], v[220:223], v[96:111]
    s_add_u32 m0, s37, 7168
    s_add_u32 s38, s36, 114688
    buffer_load_dwordx4 v41, s[32:35], s38 offen lds
    v_mfma_f32_32x32x16_bf16 v[112:127], v[76:79], v[220:223], v[112:127]
    ds_read_b64_tr_b16 v[68:69], v45 offset:27648
    ds_read_b64_tr_b16 v[70:71], v45 offset:28416
    ds_read_b64_tr_b16 v[72:73], v45 offset:27712
    ds_read_b64_tr_b16 v[74:75], v45 offset:28480
    ds_read_b64_tr_b16 v[76:77], v47 offset:27648
    ds_read_b64_tr_b16 v[78:79], v47 offset:28416
    s_waitcnt lgkmcnt(6)
    v_mfma_f32_32x32x16_bf16 v[80:95], v[56:59], v[224:227], v[80:95]
    v_mfma_f32_32x32x16_bf16 v[96:111], v[60:63], v[224:227], v[96:111]
    s_add_u32 m0, s37, 8192
    s_add_u32 s38, s36, 131072
    buffer_load_dwordx4 v41, s[32:35], s38 offen lds
    v_mfma_f32_32x32x16_bf16 v[112:127], v[64:67], v[224:227], v[112:127]
    ds_read_b64_tr_b16 v[56:57], v45 offset:30720
    ds_read_b64_tr_b16 v[58:59], v45 offset:31488
    ds_read_b64_tr_b16 v[60:61], v45 offset:30784
    ds_read_b64_tr_b16 v[62:63], v45 offset:31552
    ds_read_b64_tr_b16 v[64:65], v47 offset:30720
    ds_read_b64_tr_b16 v[66:67], v47 offset:31488
    s_waitcnt lgkmcnt(6)
    v_mfma_f32_32x32x16_bf16 v[80:95], v[68:71], v[228:231], v[80:95]
    v_mfma_f32_32x32x16_bf16 v[96:111], v[72:75], v[228:231], v[96:111]
    s_add_u32 m0, s37, 9216
    s_add_u32 s38, s36, 147456
    buffer_load_dwordx4 v41, s[32:35], s38 offen lds
    v_mfma_f32_32x32x16_bf16 v[112:127], v[76:79], v[228:231], v[112:127]
    ds_read_b64_tr_b16 v[68:69], v45 offset:33792
    ds_read_b64_tr_b16 v[70:71], v45 offset:34560
    ds_read_b64_tr_b16 v[72:73], v45 offset:33856
    ds_read_b64_tr_b16 v[74:75], v45 offset:34624
    ds_read_b64_tr_b16 v[76:77], v47 offset:33792
    ds_read_b64_tr_b16 v[78:79], v47 offset:34560
    s_waitcnt lgkmcnt(6)
    v_mfma_f32_32x32x16_bf16 v[80:95], v[56:59], v[232:235], v[80:95]
    v_mfma_f32_32x32x16_bf16 v[96:111], v[60:63], v[232:235], v[96:111]
    s_add_u32 m0, s37, 10240
    s_add_u32 s38, s36, 163840
    buffer_load_dwordx4 v41, s[32:35], s38 offen lds
    v_mfma_f32_32x32x16_bf16 v[112:127], v[64:67], v[232:235], v[112:127]
    ds_read_b64_tr_b16 v[56:57], v45 offset:36864
    ds_read_b64_tr_b16 v[58:59], v45 offset:37632
    ds_read_b64_tr_b16 v[60:61], v45 offset:36928
    ds_read_b64_tr_b16 v[62:63], v45 offset:37696
    ds_read_b64_tr_b16 v[64:65], v47 offset:36864
    ds_read_b64_tr_b16 v[66:67], v47 offset:37632
    s_waitcnt lgkmcnt(6)
    v_mfma_f32_32x32x16_bf16 v[80:95], v[68:71], v[236:239], v[80:95]
    v_mfma_f32_32x32x16_bf16 v[96:111], v[72:75], v[236:239], v[96:111]
    s_add_u32 m0, s37, 11264
    s_add_u32 s38, s36, 180224
    buffer_load_dwordx4 v41, s[32:35], s38 offen lds
    v_mfma_f32_32x32x16_bf16 v[112:127], v[76:79], v[236:239], v[112:127]
    ds_read_b64_tr_b16 v[68:69], v45 offset:39936
    ds_read_b64_tr_b16 v[70:71], v45 offset:40704
    ds_read_b64_tr_b16 v[72:73], v45 offset:40000
    ds_read_b64_tr_b16 v[74:75], v45 offset:40768
    ds_read_b64_tr_b16 v[76:77], v47 offset:39936
    ds_read_b64_tr_b16 v[78:79], v47 offset:40704
    s_waitcnt lgkmcnt(6)
    v_mfma_f32_32x32x16_bf16 v[80:95], v[56:59], v[240:243], v[80:95]
    v_mfma_f32_32x32x16_bf16 v[96:111], v[60:63], v[240:243], v[96:111]
    s_add_u32 m0, s37, 12288
    s_add_u32 s38, s36, 196608
    buffer_load_dwordx4 v41, s[32:35], s38 offen lds
    v_mfma_f32_32x32x16_bf16 v[112:127], v[64:67], v[240:243], v[112:127]
    ds_read_b64_tr_b16 v[56:57], v45 offset:43008
    ds_read_b64_tr_b16 v[58:59], v45 offset:43776
    ds_read_b64_tr_b16 v[60:61], v45 offset:43072
    ds_read_b64_tr_b16 v[62:63], v45 offset:43840
    ds_read_b64_tr_b16 v[64:65], v47 offset:43008
    ds_read_b64_tr_b16 v[66:67], v47 offset:43776
    s_waitcnt lgkmcnt(6)
    v_mfma_f32_32x32x16_bf16 v[80:95], v[68:71], v[244:247], v[80:95]
    v_mfma_f32_32x32x16_bf16 v[96:111], v[72:75], v[244:247], v[96:111]
    s_add_u32 m0, s37, 13312
    s_add_u32 s38, s36, 212992
    buffer_load_dwordx4 v41, s[32:35], s38 offen lds
    v_mfma_f32_32x32x16_bf16 v[112:127], v[76:79], v[244:247], v[112:127]
    ds_read_b64_tr_b16 v[68:69], v45 offset:46080
    ds_read_b64_tr_b16 v[70:71], v45 offset:46848
    ds_read_b64_tr_b16 v[72:73], v45 offset:46144
    ds_read_b64_tr_b16 v[74:75], v45 offset:46912
    ds_read_b64_tr_b16 v[76:77], v47 offset:46080
    ds_read_b64_tr_b16 v[78:79], v47 offset:46848
    s_waitcnt lgkmcnt(6)
    v_mfma_f32_32x32x16_bf16 v[80:95], v[56:59], v[248:251], v[80:95]
    v_mfma_f32_32x32x16_bf16 v[96:111], v[60:63], v[248:251], v[96:111]
    s_add_u32 m0, s37, 14336
    s_add_u32 s38, s36, 229376
    buffer_load_dwordx4 v41, s[32:35], s38 offen lds
    v_mfma_f32_32x32x16_bf16 v[112:127], v[64:67], v[248:251], v[112:127]
    s_waitcnt lgkmcnt(0)
    v_mfma_f32_32x32x16_bf16 v[80:95], v[68:71], v[252:255], v[80:95]
    v_mfma_f32_32x32x16_bf16 v[96:111], v[72:75], v[252:255], v[96:111]
    s_add_u32 m0, s37, 15360
    s_add_u32 s38, s36, 245760
    buffer_load_dwordx4 v41, s[32:35], s38 offen lds
    v_mfma_f32_32x32x16_bf16 v[112:127], v[76:79], v[252:255], v[112:127]
    s_waitcnt vmcnt(18)
    v_cmp_ne_u32 vcc, s64, v43
    v_cmp_ne_u32 s[72:73], s64, v54
    s_nop 1
    s_nop 1
    s_or_b64 vcc, vcc, s[72:73]
    s_cbranch_vccz Lkzx_8
    s_mov_b32 s74, 0
Lkzp_7:
    buffer_load_dword v43, v42, s[28:31], 0 offen sc1
    buffer_load_dwordx4 v[52:55], v40, s[8:11], s39 offen sc1
    s_add_u32 s74, s74, 1
    s_cmp_gt_u32 s74, 0x40000
    s_cbranch_scc1 Lkzx_8
    s_waitcnt vmcnt(0)
    v_cmp_ne_u32 vcc, s64, v43
    v_cmp_ne_u32 s[72:73], s64, v54
    s_nop 1
    s_nop 1
    s_or_b64 vcc, vcc, s[72:73]
    s_cbranch_vccnz Lkzp_7
Lkzx_8:
    s_waitcnt vmcnt(18)
    v_add_f32 v24, v24, v25
    v_add_f32 v26, v26, v27
    v_add_f32 v24, v24, v26
    v_cvt_pk_bf16_f32 v27, v24, v24
    v_and_b32 v25, 0xffff0000, v27
    v_sub_f32 v26, v24, v25
    v_cvt_pk_bf16_f32 v26, v26, 0
    v_accvgpr_write_b32 a248, v27
    v_accvgpr_write_b32 a249, v26
    v_add_f32 v28, v28, v29
    v_add_f32 v30, v30, v31
    v_add_f32 v28, v28, v30
    v_cvt_pk_bf16_f32 v31, v28, v28
    v_and_b32 v29, 0xffff0000, v31
    v_sub_f32 v30, v28, v29
    v_cvt_pk_bf16_f32 v30, v30, 0
    v_accvgpr_write_b32 a250, v31
    v_accvgpr_write_b32 a251, v30
    v_add_f32 v32, v32, v33
    v_add_f32 v34, v34, v35
    v_add_f32 v32, v32, v34
    v_cvt_pk_bf16_f32 v35, v32, v32
    v_and_b32 v33, 0xffff0000, v35
    v_sub_f32 v34, v32, v33
    v_cvt_pk_bf16_f32 v34, v34, 0
    v_accvgpr_write_b32 a252, v35
    v_accvgpr_write_b32 a253, v34
    v_accvgpr_write_b32 a254, 0
    v_accvgpr_write_b32 a255, 0
    v_mov_b32 v4, v52
    v_mov_b32 v6, v53
    s_barrier
    v_lshrrev_b32 v41, 2, v1
    v_and_b32 v21, 3, v1
    v_bfe_u32 v22, v1, 4, 1
    v_lshlrev_b32 v22, 1, v22
    v_xor_b32 v21, v21, v22
    v_lshlrev_b32 v41, 10, v41
    v_lshl_add_u32 v41, v21, 4, v41
    s_lshl_b32 s36, s68, 8
    s_lshl_b32 s73, s3, 6
    s_add_u32 s36, s36, s73
    s_add_u32 s36, s36, 262144
    s_lshl_b32 s37, s3, 14
    s_add_u32 s37, s37, 32768
    v_lshrrev_b32 v26, 4, v1
    v_bfe_u32 v27, v1, 2, 2
    v_lshl_add_u32 v27, v26, 2, v27
    v_lshlrev_b32 v27, 6, v27
    v_and_b32 v26, 1, v26
    v_lshlrev_b32 v26, 1, v26
    v_bfe_u32 v28, v1, 1, 1
    v_xor_b32 v28, v28, v26
    v_lshl_add_u32 v26, v28, 4, v27
    v_and_b32 v27, 1, v1
    v_lshl_add_u32 v26, v27, 3, v26
    s_lshl_b32 s74, s3, 14
    s_add_u32 s74, s74, 98304
    v_add_u32 v26, s74, v26
    v_xor_b32 v27, 32, v26
    s_lshl_b32 s75, s3, 14
    s_add_u32 s75, s75, 98304
    v_lshlrev_b32 v42, 2, v1
    v_add_u32 v42, s75, v42
    v_lshlrev_b32 v8, 4, v1
    v_add_u32 v8, 28672, v8
    ds_write_b128 v8, v[36:39]
    v_lshrrev_b32 v8, 4, v1
    v_bfe_u32 v9, v1, 2, 2
    v_and_b32 v10, 3, v1
    v_lshrrev_b32 v11, 1, v8
    v_lshl_add_u32 v9, v11, 3, v9
    s_add_u32 m0, s37, 0
    s_add_u32 s38, s36, 0
    buffer_load_dwordx4 v41, s[32:35], s38 offen lds
    v_lshlrev_b32 v9, 5, v9
    v_and_b32 v11, 1, v10
    v_lshl_add_u32 v9, v11, 9, v9
    v_and_b32 v8, 1, v8
    v_lshrrev_b32 v10, 1, v10
    v_lshl_add_u32 v8, v8, 1, v10
    v_lshl_add_u32 v9, v8, 3, v9
    v_add_u32 v9, 28672, v9
    v_sub_f32 v7, 0, v4
    s_waitcnt lgkmcnt(0)
    ds_read_b64_tr_b16 v[36:37], v9
    ds_read_b64_tr_b16 v[38:39], v9 offset:128
    v_cvt_pk_bf16_f32 v10, v7, v7
    v_and_b32 v8, 0xffff0000, v10
    v_sub_f32 v9, v7, v8
    v_cvt_pk_bf16_f32 v12, v8, v9
    v_cvt_pk_bf16_f32 v13, v8, 0
    v_mov_b32 v14, 0
    s_add_u32 m0, s37, 1024
    s_add_u32 s38, s36, 16384
    buffer_load_dwordx4 v41, s[32:35], s38 offen lds
    v_mov_b32 v15, 0
    v_cmp_gt_u32 vcc, 32, v1
    v_mul_f32 v16, s66, v6
    s_nop 0
    v_cndmask_b32 v12, 0, v12, vcc
    v_cndmask_b32 v13, 0, v13, vcc
    v_and_b32 v2, 31, v1
    s_lshl_b32 s72, s3, 5
    v_add_u32 v2, s72, v2
    v_lshlrev_b32 v2, 5, v2
    v_mfma_f32_32x32x16_bf16 v[96:111], a[250:253], v[12:15], v[96:111]
    v_lshrrev_b32 v3, 5, v1
    v_lshl_add_u32 v18, v3, 13, v2
    v_add_u32 v18, 0, v18
    v_mfma_f32_32x32x16_bf16 v[112:127], a[252:255], v[12:15], v[112:127]
    v_lshl_add_u32 v19, v3, 12, v2
    v_add_u32 v19, 16384, v19
    v_mfma_f32_32x32x16_bf16 v[80:95], a[248:251], v[12:15], v[80:95]
    s_add_u32 m0, s37, 2048
    s_add_u32 s38, s36, 32768
    buffer_load_dwordx4 v41, s[32:35], s38 offen lds
    v_bfe_u32 v40, v1, 2, 1
    v_cmp_eq_u32 vcc, 0, v40
    s_waitcnt lgkmcnt(0)
    s_nop 0
    v_cndmask_b32 v2, 0, v36, vcc
    v_sub_u32 v3, v36, v2
    v_accvgpr_write_b32 a240, v2
    v_accvgpr_write_b32 a244, v3
    v_cndmask_b32 v2, 0, v37, vcc
    v_sub_u32 v3, v37, v2
    v_accvgpr_write_b32 a241, v2
    v_accvgpr_write_b32 a245, v3
    v_cndmask_b32 v2, 0, v38, vcc
    v_sub_u32 v3, v38, v2
    v_accvgpr_write_b32 a242, v2
    v_accvgpr_write_b32 a246, v3
    v_cndmask_b32 v2, 0, v39, vcc
    v_sub_u32 v3, v39, v2
    s_add_u32 m0, s37, 3072
    s_add_u32 s38, s36, 49152
    buffer_load_dwordx4 v41, s[32:35], s38 offen lds
    v_accvgpr_write_b32 a243, v2
    v_accvgpr_write_b32 a247, v3
    v_cvt_pk_bf16_f32 v128, v96, v97
    v_cvt_pk_bf16_f32 v129, v98, v99
    v_cvt_pk_bf16_f32 v130, v100, v101
    v_cvt_pk_bf16_f32 v131, v102, v103
    v_cvt_pk_bf16_f32 v132, v104, v105
    v_cvt_pk_bf16_f32 v133, v106, v107
    v_cvt_pk_bf16_f32 v134, v108, v109
    v_cvt_pk_bf16_f32 v135, v110, v111
    v_mfma_f32_32x32x16_bf16 v[144:159], a[240:243], v[128:131], 0
    s_nop 0
    v_mfma_f32_32x32x16_bf16 v[144:159], a[244:247], v[132:135], v[144:159]
    v_mul_f32 v112, v112, v6
    v_mul_f32 v113, v113, v6
    v_mul_f32 v114, v114, v6
    v_mul_f32 v115, v115, v6
    v_mul_f32 v116, v116, v6
    v_mul_f32 v117, v117, v6
    s_add_u32 m0, s37, 4096
    s_add_u32 s38, s36, 65536
    buffer_load_dwordx4 v41, s[32:35], s38 offen lds
    v_mul_f32 v118, v118, v6
    v_mul_f32 v119, v119, v6
    v_mul_f32 v120, v120, v6
    v_mul_f32 v121, v121, v6
    v_mul_f32 v122, v122, v6
    v_mul_f32 v123, v123, v6
    v_mul_f32 v124, v124, v6
    v_mul_f32 v125, v125, v6
    v_mul_f32 v126, v126, v6
    v_mul_f32 v127, v127, v6
    v_cvt_pk_bf16_f32 v192, v112, v113
    v_cvt_pk_bf16_f32 v193, v114, v115
    v_cvt_pk_bf16_f32 v194, v116, v117
    v_cvt_pk_bf16_f32 v195, v118, v119
    v_cvt_pk_bf16_f32 v196, v120, v121
    v_cvt_pk_bf16_f32 v197, v122, v123
    v_cvt_pk_bf16_f32 v198, v124, v125
    v_cvt_pk_bf16_f32 v199, v126, v127
    ds_write_b128 v19, v[192:195]
    ds_write_b128 v19, v[196:199] offset:16
    v_cvt_pk_bf16_f32 v136, v80, v81
    v_cvt_pk_bf16_f32 v137, v82, v83
    v_cvt_pk_bf16_f32 v138, v84, v85
    v_cvt_pk_bf16_f32 v139, v86, v87
    v_cvt_pk_bf16_f32 v140, v88, v89
    v_cvt_pk_bf16_f32 v141, v90, v91
    v_cvt_pk_bf16_f32 v142, v92, v93
    v_cvt_pk_bf16_f32 v143, v94, v95
    v_mfma_f32_32x32x16_bf16 v[208:223], a[240:243], v[136:139], 0
    s_nop 0
    v_mfma_f32_32x32x16_bf16 v[208:223], a[244:247], v[140:143], v[208:223]
    s_waitcnt vmcnt(5)
    v_max3_f32 v20, v144, v145, v146
    v_min3_f32 v21, v144, v145, v146
    ds_read_b64_tr_b16 a[0:1], v26 offset:0
    ds_read_b64_tr_b16 a[2:3], v26 offset:1024
    s_add_u32 m0, s37, 5120
    s_add_u32 s38, s36, 81920
    buffer_load_dwordx4 v41, s[32:35], s38 offen lds
    v_max3_f32 v20, v20, v147, v148
    v_min3_f32 v21, v21, v147, v148
    v_max3_f32 v20, v20, v149, v150
    v_min3_f32 v21, v21, v149, v150
    v_max3_f32 v20, v20, v151, v152
    v_min3_f32 v21, v21, v151, v152
    v_max3_f32 v20, v20, v153, v154
    ds_read_b64_tr_b16 a[4:5], v27 offset:0
    ds_read_b64_tr_b16 a[6:7], v27 offset:1024
    s_add_u32 m0, s37, 6144
    s_add_u32 s38, s36, 98304
    buffer_load_dwordx4 v41, s[32:35], s38 offen lds
    v_min3_f32 v21, v21, v153, v154
    v_max3_f32 v20, v20, v155, v156
    v_min3_f32 v21, v21, v155, v156
    v_max3_f32 v20, v20, v157, v158
    v_min3_f32 v21, v21, v157, v158
    v_max_f32 v20, v20, v159
    v_min_f32 v21, v21, v159
    ds_read_b64_tr_b16 a[8:9], v26 offset:2048
    ds_read_b64_tr_b16 a[10:11], v26 offset:3072
    s_add_u32 m0, s37, 7168
    s_add_u32 s38, s36, 114688
    buffer_load_dwordx4 v41, s[32:35], s38 offen lds
    v_mov_b32 v22, v16
    v_mov_b32 v24, v16
    v_mul_f32 v23, v20, v16
    v_mul_f32 v25, v21, v16
    v_pk_fma_f32 v[160:161], v[144:145], v[22:23], v[22:23] op_sel:[0,0,1] op_sel_hi:[1,0,1] neg_lo:[0,0,1] neg_hi:[0,0,1]
    v_pk_fma_f32 v[176:177], v[144:145], v[24:25], v[24:25] op_sel:[0,0,1] op_sel_hi:[1,0,1] neg_lo:[1,0,0] neg_hi:[1,0,0]
    v_pk_fma_f32 v[162:163], v[146:147], v[22:23], v[22:23] op_sel:[0,0,1] op_sel_hi:[1,0,1] neg_lo:[0,0,1] neg_hi:[0,0,1]
    ds_read_b64_tr_b16 a[12:13], v27 offset:2048
    ds_read_b64_tr_b16 a[14:15], v27 offset:3072
    s_add_u32 m0, s37, 8192
    s_add_u32 s38, s36, 131072
    buffer_load_dwordx4 v41, s[32:35], s38 offen lds
    v_pk_fma_f32 v[178:179], v[146:147], v[24:25], v[24:25] op_sel:[0,0,1] op_sel_hi:[1,0,1] neg_lo:[1,0,0] neg_hi:[1,0,0]
    v_pk_fma_f32 v[164:165], v[148:149], v[22:23], v[22:23] op_sel:[0,0,1] op_sel_hi:[1,0,1] neg_lo:[0,0,1] neg_hi:[0,0,1]
    v_pk_fma_f32 v[180:181], v[148:149], v[24:25], v[24:25] op_sel:[0,0,1] op_sel_hi:[1,0,1] neg_lo:[1,0,0] neg_hi:[1,0,0]
    v_pk_fma_f32 v[166:167], v[150:151], v[22:23], v[22:23] op_sel:[0,0,1] op_sel_hi:[1,0,1] neg_lo:[0,0,1] neg_hi:[0,0,1]
    v_pk_fma_f32 v[182:183], v[150:151], v[24:25], v[24:25] op_sel:[0,0,1] op_sel_hi:[1,0,1] neg_lo:[1,0,0] neg_hi:[1,0,0]
    v_pk_fma_f32 v[168:169], v[152:153], v[22:23], v[22:23] op_sel:[0,0,1] op_sel_hi:[1,0,1] neg_lo:[0,0,1] neg_hi:[0,0,1]
    v_pk_fma_f32 v[184:185], v[152:153], v[24:25], v[24:25] op_sel:[0,0,1] op_sel_hi:[1,0,1] neg_lo:[1,0,0] neg_hi:[1,0,0]
    ds_read_b64_tr_b16 a[16:17], v26 offset:4096
    ds_read_b64_tr_b16 a[18:19], v26 offset:5120
    s_add_u32 m0, s37, 9216
    s_add_u32 s38, s36, 147456
    buffer_load_dwordx4 v41, s[32:35], s38 offen lds
    v_pk_fma_f32 v[170:171], v[154:155], v[22:23], v[22:23] op_sel:[0,0,1] op_sel_hi:[1,0,1] neg_lo:[0,0,1] neg_hi:[0,0,1]
    v_pk_fma_f32 v[186:187], v[154:155], v[24:25], v[24:25] op_sel:[0,0,1] op_sel_hi:[1,0,1] neg_lo:[1,0,0] neg_hi:[1,0,0]
    v_pk_fma_f32 v[172:173], v[156:157], v[22:23], v[22:23] op_sel:[0,0,1] op_sel_hi:[1,0,1] neg_lo:[0,0,1] neg_hi:[0,0,1]
    v_pk_fma_f32 v[188:189], v[156:157], v[24:25], v[24:25] op_sel:[0,0,1] op_sel_hi:[1,0,1] neg_lo:[1,0,0] neg_hi:[1,0,0]
    v_pk_fma_f32 v[174:175], v[158:159], v[22:23], v[22:23] op_sel:[0,0,1] op_sel_hi:[1,0,1] neg_lo:[0,0,1] neg_hi:[0,0,1]
    v_pk_fma_f32 v[190:191], v[158:159], v[24:25], v[24:25] op_sel:[0,0,1] op_sel_hi:[1,0,1] neg_lo:[1,0,0] neg_hi:[1,0,0]
    v_exp_f32 v160, v160
    ds_read_b64_tr_b16 a[20:21], v27 offset:4096
    ds_read_b64_tr_b16 a[22:23], v27 offset:5120
    s_add_u32 m0, s37, 10240
    s_add_u32 s38, s36, 163840
    buffer_load_dwordx4 v41, s[32:35], s38 offen lds
    v_exp_f32 v161, v161
    v_exp_f32 v162, v162
    v_exp_f32 v163, v163
    v_exp_f32 v164, v164
    v_exp_f32 v165, v165
    v_exp_f32 v166, v166
    v_exp_f32 v167, v167
    ds_read_b64_tr_b16 a[24:25], v26 offset:6144
    ds_read_b64_tr_b16 a[26:27], v26 offset:7168
    s_add_u32 m0, s37, 11264
    s_add_u32 s38, s36, 180224
    buffer_load_dwordx4 v41, s[32:35], s38 offen lds
    v_exp_f32 v168, v168
    v_exp_f32 v169, v169
    v_exp_f32 v170, v170
    v_exp_f32 v171, v171
    v_exp_f32 v172, v172
    v_exp_f32 v173, v173
    v_exp_f32 v174, v174
    ds_read_b64_tr_b16 a[28:29], v27 offset:6144
    ds_read_b64_tr_b16 a[30:31], v27 offset:7168
    s_add_u32 m0, s37, 12288
    s_add_u32 s38, s36, 196608
    buffer_load_dwordx4 v41, s[32:35], s38 offen lds
    v_exp_f32 v175, v175
    v_exp_f32 v176, v176
    v_exp_f32 v177, v177
    v_exp_f32 v178, v178
    v_exp_f32 v179, v179
    v_exp_f32 v180, v180
    v_exp_f32 v181, v181
    ds_read_b64_tr_b16 a[32:33], v26 offset:8192
    ds_read_b64_tr_b16 a[34:35], v26 offset:9216
    s_add_u32 m0, s37, 13312
    s_add_u32 s38, s36, 212992
    buffer_load_dwordx4 v41, s[32:35], s38 offen lds
    v_exp_f32 v182, v182
    v_exp_f32 v183, v183
    v_exp_f32 v184, v184
    v_exp_f32 v185, v185
    v_exp_f32 v186, v186
    v_exp_f32 v187, v187
    v_exp_f32 v188, v188
    ds_read_b64_tr_b16 a[36:37], v27 offset:8192
    ds_read_b64_tr_b16 a[38:39], v27 offset:9216
    s_add_u32 m0, s37, 14336
    s_add_u32 s38, s36, 229376
    buffer_load_dwordx4 v41, s[32:35], s38 offen lds
    v_exp_f32 v189, v189
    v_exp_f32 v190, v190
    v_exp_f32 v191, v191
    v_pk_add_f32 v[224:225], v[160:161], v[162:163]
    v_pk_add_f32 v[226:227], v[164:165], v[166:167]
    v_pk_add_f32 v[228:229], v[168:169], v[170:171]
    v_pk_add_f32 v[230:231], v[172:173], v[174:175]
    ds_read_b64_tr_b16 a[40:41], v26 offset:10240
    ds_read_b64_tr_b16 a[42:43], v26 offset:11264
    s_add_u32 m0, s37, 15360
    s_add_u32 s38, s36, 245760
    buffer_load_dwordx4 v41, s[32:35], s38 offen lds
    v_pk_add_f32 v[232:233], v[176:177], v[178:179]
    v_pk_add_f32 v[234:235], v[180:181], v[182:183]
    v_pk_add_f32 v[236:237], v[184:185], v[186:187]
    v_pk_add_f32 v[238:239], v[188:189], v[190:191]
    v_pk_add_f32 v[224:225], v[224:225], v[226:227]
    v_pk_add_f32 v[228:229], v[228:229], v[230:231]
    v_pk_add_f32 v[232:233], v[232:233], v[234:235]
    ds_read_b64_tr_b16 a[44:45], v27 offset:10240
    ds_read_b64_tr_b16 a[46:47], v27 offset:11264
    v_pk_add_f32 v[236:237], v[236:237], v[238:239]
    v_pk_add_f32 v[224:225], v[224:225], v[228:229]
    v_pk_add_f32 v[232:233], v[232:233], v[236:237]
    v_add_f32 v224, v224, v225
    v_add_f32 v232, v232, v233
    v_rcp_f32 v20, v224
    v_rcp_f32 v22, v232
    ds_read_b64_tr_b16 a[48:49], v26 offset:12288
    ds_read_b64_tr_b16 a[50:51], v26 offset:13312
    s_nop 0
    v_pk_mul_f32 v[160:161], v[160:161], v[20:21] op_sel_hi:[1,0]
    v_pk_mul_f32 v[162:163], v[162:163], v[20:21] op_sel_hi:[1,0]
    v_pk_mul_f32 v[164:165], v[164:165], v[20:21] op_sel_hi:[1,0]
    v_pk_mul_f32 v[166:167], v[166:167], v[20:21] op_sel_hi:[1,0]
    v_pk_mul_f32 v[168:169], v[168:169], v[20:21] op_sel_hi:[1,0]
    v_pk_mul_f32 v[170:171], v[170:171], v[20:21] op_sel_hi:[1,0]
    ds_read_b64_tr_b16 a[52:53], v27 offset:12288
    ds_read_b64_tr_b16 a[54:55], v27 offset:13312
    v_pk_mul_f32 v[172:173], v[172:173], v[20:21] op_sel_hi:[1,0]
    v_pk_mul_f32 v[174:175], v[174:175], v[20:21] op_sel_hi:[1,0]
    v_pk_mul_f32 v[176:177], v[176:177], v[22:23] op_sel_hi:[1,0]
    v_pk_mul_f32 v[178:179], v[178:179], v[22:23] op_sel_hi:[1,0]
    v_pk_mul_f32 v[180:181], v[180:181], v[22:23] op_sel_hi:[1,0]
    v_pk_mul_f32 v[182:183], v[182:183], v[22:23] op_sel_hi:[1,0]
    v_pk_mul_f32 v[184:185], v[184:185], v[22:23] op_sel_hi:[1,0]
    ds_read_b64_tr_b16 a[56:57], v26 offset:14336
    ds_read_b64_tr_b16 a[58:59], v26 offset:15360
    v_pk_mul_f32 v[186:187], v[186:187], v[22:23] op_sel_hi:[1,0]
    v_pk_mul_f32 v[188:189], v[188:189], v[22:23] op_sel_hi:[1,0]
    v_pk_mul_f32 v[190:191], v[190:191], v[22:23] op_sel_hi:[1,0]
    v_cvt_pk_bf16_f32 v224, v160, v161
    v_cvt_pk_bf16_f32 v225, v162, v163
    v_cvt_pk_bf16_f32 v226, v164, v165
    v_cvt_pk_bf16_f32 v227, v166, v167
    ds_read_b64_tr_b16 a[60:61], v27 offset:14336
    ds_read_b64_tr_b16 a[62:63], v27 offset:15360
    v_cvt_pk_bf16_f32 v228, v168, v169
    v_cvt_pk_bf16_f32 v229, v170, v171
    v_cvt_pk_bf16_f32 v230, v172, v173
    v_cvt_pk_bf16_f32 v231, v174, v175
    v_cvt_pk_bf16_f32 v232, v176, v177
    v_cvt_pk_bf16_f32 v233, v178, v179
    v_cvt_pk_bf16_f32 v234, v180, v181
    v_cvt_pk_bf16_f32 v235, v182, v183
    v_cvt_pk_bf16_f32 v236, v184, v185
    v_cvt_pk_bf16_f32 v237, v186, v187
    v_cvt_pk_bf16_f32 v238, v188, v189
    v_cvt_pk_bf16_f32 v239, v190, v191
    s_waitcnt lgkmcnt(0)
    ds_write_b128 v18, v[224:227]
    ds_write_b128 v18, v[228:231] offset:16
    ds_write_b128 v18, v[232:235] offset:4096
    ds_write_b128 v18, v[236:239] offset:4112
    v_lshrrev_b32 v2, 4, v1
    v_bfe_u32 v3, v1, 2, 2
    v_lshl_add_u32 v3, v2, 2, v3
    v_lshlrev_b32 v3, 5, v3
    v_and_b32 v4, 3, v1
    v_lshl_add_u32 v3, v4, 3, v3
    ds_write_b32 v42, a128 offset:0
    s_lshr_b32 s72, s3, 1
    s_lshl_b32 s73, s72, 12
    s_add_u32 s73, s73, 16384
    v_add_u32 v19, s73, v3
    ds_write_b32 v42, a129 offset:272
    s_lshl_b32 s73, s3, 12
    s_add_u32 s73, s73, 0
    v_add_u32 v18, s73, v3
    s_waitcnt lgkmcnt(0)
    ds_write_b32 v42, a130 offset:544
    s_barrier
    ds_read_b64_tr_b16 v[96:97], v18 offset:0
    ds_read_b64_tr_b16 v[98:99], v18 offset:512
    ds_read_b64_tr_b16 v[100:101], v19 offset:0
    ds_write_b32 v42, a131 offset:816
    ds_read_b64_tr_b16 v[102:103], v19 offset:512
    ds_read_b64_tr_b16 v[104:105], v18 offset:1024
    ds_read_b64_tr_b16 v[106:107], v18 offset:1536
    ds_read_b64_tr_b16 v[108:109], v19 offset:1024
    ds_write_b32 v42, a132 offset:1088
    ds_read_b64_tr_b16 v[110:111], v19 offset:1536
    ds_read_b64_tr_b16 v[112:113], v18 offset:2048
    ds_read_b64_tr_b16 v[114:115], v18 offset:2560
    ds_read_b64_tr_b16 v[116:117], v19 offset:2048
    ds_write_b32 v42, a133 offset:1360
    ds_read_b64_tr_b16 v[118:119], v19 offset:2560
    s_waitcnt lgkmcnt(8)
    ds_read_b64_tr_b16 v[120:121], v18 offset:3072
    ds_read_b64_tr_b16 v[122:123], v18 offset:3584
    ds_write_b32 v42, a134 offset:1632
    ds_read_b64_tr_b16 v[124:125], v19 offset:3072
    ds_read_b64_tr_b16 v[126:127], v19 offset:3584
    v_mov_b32 v136, s65
    v_mov_b32 v137, s65
    ds_write_b32 v42, a135 offset:1904
    v_mov_b32 v138, s65
    v_mov_b32 v139, s65
    v_and_b32 v2, 15, v1
    v_lshrrev_b32 v3, 5, v1
    ds_write_b32 v42, a136 offset:2176
    v_lshl_add_u32 v2, v3, 4, v2
    v_lshlrev_b32 v2, 4, v2
    v_bfe_u32 v3, v1, 4, 1
    v_lshl_add_u32 v2, v3, 9, v2
    ds_write_b32 v42, a137 offset:2448
    s_lshl_b32 s73, s3, 10
    s_add_u32 s73, s73, 24576
    v_add_u32 v2, s73, v2
    v_lshlrev_b32 v3, 2, v1
    ds_write_b32 v42, a138 offset:2720
    v_add_u32 v4, s73, v3
    s_waitcnt lgkmcnt(8)
    v_mfma_f32_16x16x32_bf16 v[128:131], v[96:99], v[100:103], 0
    v_mfma_f32_16x16x32_bf16 v[132:135], v[136:139], v[96:99], 0
    ds_write_b32 v42, a139 offset:2992
    s_waitcnt lgkmcnt(8)
    v_mfma_f32_16x16x32_bf16 v[128:131], v[104:107], v[108:111], v[128:131]
    v_mfma_f32_16x16x32_bf16 v[132:135], v[136:139], v[104:107], v[132:135]
    s_waitcnt lgkmcnt(4)
    ds_write_b32 v42, a140 offset:3264
    v_mfma_f32_16x16x32_bf16 v[128:131], v[112:115], v[116:119], v[128:131]
    v_mfma_f32_16x16x32_bf16 v[132:135], v[136:139], v[112:115], v[132:135]
    s_waitcnt lgkmcnt(0)
    v_mfma_f32_16x16x32_bf16 v[128:131], v[120:123], v[124:127], v[128:131]
    ds_write_b32 v42, a141 offset:3536
    v_mfma_f32_16x16x32_bf16 v[132:135], v[136:139], v[120:123], v[132:135]
    v_max3_f32 v20, v208, v209, v210
    v_min3_f32 v21, v208, v209, v210
    v_max3_f32 v20, v20, v211, v212
    ds_write_b32 v42, a142 offset:3808
    v_min3_f32 v21, v21, v211, v212
    v_max3_f32 v20, v20, v213, v214
    v_min3_f32 v21, v21, v213, v214
    v_max3_f32 v20, v20, v215, v216
    ds_write_b32 v42, a143 offset:4080
    v_min3_f32 v21, v21, v215, v216
    v_max3_f32 v20, v20, v217, v218
    v_min3_f32 v21, v21, v217, v218
    v_max3_f32 v20, v20, v219, v220
    ds_write_b32 v42, a144 offset:4352
    v_min3_f32 v21, v21, v219, v220
    v_max3_f32 v20, v20, v221, v222
    v_min3_f32 v21, v21, v221, v222
    v_max_f32 v20, v20, v223
    ds_write_b32 v42, a145 offset:4624
    v_min_f32 v21, v21, v223
    v_mov_b32 v22, v16
    v_mov_b32 v24, v16
    ds_write_b128 v2, v[128:131]
    ds_write_b32 v42, a146 offset:4896
    v_mul_f32 v23, v20, v16
    v_mul_f32 v25, v21, v16
    v_pk_fma_f32 v[160:161], v[208:209], v[22:23], v[22:23] op_sel:[0,0,1] op_sel_hi:[1,0,1] neg_lo:[0,0,1] neg_hi:[0,0,1]
    v_pk_fma_f32 v[176:177], v[208:209], v[24:25], v[24:25] op_sel:[0,0,1] op_sel_hi:[1,0,1] neg_lo:[1,0,0] neg_hi:[1,0,0]
    ds_write_b32 v42, a147 offset:5168
    v_pk_fma_f32 v[162:163], v[210:211], v[22:23], v[22:23] op_sel:[0,0,1] op_sel_hi:[1,0,1] neg_lo:[0,0,1] neg_hi:[0,0,1]
    v_pk_fma_f32 v[178:179], v[210:211], v[24:25], v[24:25] op_sel:[0,0,1] op_sel_hi:[1,0,1] neg_lo:[1,0,0] neg_hi:[1,0,0]
    v_pk_fma_f32 v[164:165], v[212:213], v[22:23], v[22:23] op_sel:[0,0,1] op_sel_hi:[1,0,1] neg_lo:[0,0,1] neg_hi:[0,0,1]
    v_pk_fma_f32 v[180:181], v[212:213], v[24:25], v[24:25] op_sel:[0,0,1] op_sel_hi:[1,0,1] neg_lo:[1,0,0] neg_hi:[1,0,0]
    ds_write_b32 v42, a148 offset:5440
    v_pk_fma_f32 v[166:167], v[214:215], v[22:23], v[22:23] op_sel:[0,0,1] op_sel_hi:[1,0,1] neg_lo:[0,0,1] neg_hi:[0,0,1]
    v_pk_fma_f32 v[182:183], v[214:215], v[24:25], v[24:25] op_sel:[0,0,1] op_sel_hi:[1,0,1] neg_lo:[1,0,0] neg_hi:[1,0,0]
    v_pk_fma_f32 v[168:169], v[216:217], v[22:23], v[22:23] op_sel:[0,0,1] op_sel_hi:[1,0,1] neg_lo:[0,0,1] neg_hi:[0,0,1]
    v_pk_fma_f32 v[184:185], v[216:217], v[24:25], v[24:25] op_sel:[0,0,1] op_sel_hi:[1,0,1] neg_lo:[1,0,0] neg_hi:[1,0,0]
    ds_write_b32 v42, a149 offset:5712
    v_pk_fma_f32 v[170:171], v[218:219], v[22:23], v[22:23] op_sel:[0,0,1] op_sel_hi:[1,0,1] neg_lo:[0,0,1] neg_hi:[0,0,1]
    v_pk_fma_f32 v[186:187], v[218:219], v[24:25], v[24:25] op_sel:[0,0,1] op_sel_hi:[1,0,1] neg_lo:[1,0,0] neg_hi:[1,0,0]
    v_pk_fma_f32 v[172:173], v[220:221], v[22:23], v[22:23] op_sel:[0,0,1] op_sel_hi:[1,0,1] neg_lo:[0,0,1] neg_hi:[0,0,1]
    v_pk_fma_f32 v[188:189], v[220:221], v[24:25], v[24:25] op_sel:[0,0,1] op_sel_hi:[1,0,1] neg_lo:[1,0,0] neg_hi:[1,0,0]
    ds_write_b32 v42, a150 offset:5984
    v_pk_fma_f32 v[174:175], v[222:223], v[22:23], v[22:23] op_sel:[0,0,1] op_sel_hi:[1,0,1] neg_lo:[0,0,1] neg_hi:[0,0,1]
    v_pk_fma_f32 v[190:191], v[222:223], v[24:25], v[24:25] op_sel:[0,0,1] op_sel_hi:[1,0,1] neg_lo:[1,0,0] neg_hi:[1,0,0]
    s_waitcnt lgkmcnt(0)
    ds_read_b32 v140, v4 offset:0
    ds_write_b32 v42, a151 offset:6256
    ds_read_b32 v141, v4 offset:256
    ds_read_b32 v142, v4 offset:512
    ds_read_b32 v143, v4 offset:768
    s_lshl_b32 s74, s7, 1
    ds_write_b32 v42, a152 offset:6528
    s_lshr_b32 s75, s3, 1
    s_add_u32 s74, s74, s75
    s_lshl_b32 s76, s74, 11
    s_and_b32 s75, s3, 1
    ds_write_b32 v42, a153 offset:6800
    s_lshl_b32 s77, s75, 9
    s_add_u32 s76, s76, s77
    s_add_u32 s76, s76, 65536
    v_exp_f32 v160, v160
    v_exp_f32 v161, v161
    v_exp_f32 v162, v162
    v_exp_f32 v163, v163
    v_exp_f32 v164, v164
    v_exp_f32 v165, v165
    v_exp_f32 v166, v166
    v_exp_f32 v167, v167
    v_exp_f32 v168, v168
    v_exp_f32 v169, v169
    v_exp_f32 v170, v170
    v_exp_f32 v171, v171
    v_exp_f32 v172, v172
    v_exp_f32 v173, v173
    v_exp_f32 v174, v174
    v_exp_f32 v175, v175
    s_waitcnt lgkmcnt(0)
    v_lshlrev_b32 v3, 2, v1
    buffer_atomic_add_f32 v140, v3, s[8:11], s76 offen offset:0
    buffer_atomic_add_f32 v141, v3, s[8:11], s76 offen offset:256
    buffer_atomic_add_f32 v142, v3, s[8:11], s76 offen offset:1024
    buffer_atomic_add_f32 v143, v3, s[8:11], s76 offen offset:1280
    s_lshl_b32 s76, s74, 7
    s_lshl_b32 s77, s75, 6
    s_add_u32 s76, s76, s77
    s_add_u32 s76, s76, 131072
    s_mov_b32 exec_lo, 0xffff
    s_mov_b32 exec_hi, 0
    buffer_atomic_add_f32 v132, v3, s[8:11], s76 offen
    s_mov_b64 exec, -1
    v_exp_f32 v176, v176
    ds_write_b32 v42, a154 offset:7072
    v_exp_f32 v177, v177
    v_exp_f32 v178, v178
    ds_write_b32 v42, a155 offset:7344
    v_exp_f32 v179, v179
    v_exp_f32 v180, v180
    ds_write_b32 v42, a156 offset:7616
    v_exp_f32 v181, v181
    v_exp_f32 v182, v182
    ds_write_b32 v42, a157 offset:7888
    v_exp_f32 v183, v183
    v_exp_f32 v184, v184
    ds_write_b32 v42, a158 offset:8160
    v_exp_f32 v185, v185
    v_exp_f32 v186, v186
    ds_write_b32 v42, a159 offset:8432
    v_exp_f32 v187, v187
    v_exp_f32 v188, v188
    ds_write_b32 v42, a160 offset:8704
    v_exp_f32 v189, v189
    v_exp_f32 v190, v190
    ds_write_b32 v42, a161 offset:8976
    v_exp_f32 v191, v191
    v_pk_add_f32 v[224:225], v[160:161], v[162:163]
    ds_write_b32 v42, a162 offset:9248
    v_pk_add_f32 v[226:227], v[164:165], v[166:167]
    v_pk_add_f32 v[228:229], v[168:169], v[170:171]
    ds_write_b32 v42, a163 offset:9520
    v_pk_add_f32 v[230:231], v[172:173], v[174:175]
    v_pk_add_f32 v[232:233], v[176:177], v[178:179]
    ds_write_b32 v42, a164 offset:9792
    v_pk_add_f32 v[234:235], v[180:181], v[182:183]
    v_pk_add_f32 v[236:237], v[184:185], v[186:187]
    ds_write_b32 v42, a165 offset:10064
    v_pk_add_f32 v[238:239], v[188:189], v[190:191]
    v_pk_add_f32 v[224:225], v[224:225], v[226:227]
    ds_write_b32 v42, a166 offset:10336
    v_pk_add_f32 v[228:229], v[228:229], v[230:231]
    v_pk_add_f32 v[232:233], v[232:233], v[234:235]
    ds_write_b32 v42, a167 offset:10608
    v_pk_add_f32 v[236:237], v[236:237], v[238:239]
    v_pk_add_f32 v[224:225], v[224:225], v[228:229]
    ds_write_b32 v42, a168 offset:10880
    v_pk_add_f32 v[232:233], v[232:233], v[236:237]
    v_add_f32 v224, v224, v225
    ds_write_b32 v42, a169 offset:11152
    v_add_f32 v232, v232, v233
    v_rcp_f32 v20, v224
    ds_write_b32 v42, a170 offset:11424
    v_rcp_f32 v22, v232
    s_nop 0
    ds_write_b32 v42, a171 offset:11696
    v_pk_mul_f32 v[160:161], v[160:161], v[20:21] op_sel_hi:[1,0]
    v_pk_mul_f32 v[162:163], v[162:163], v[20:21] op_sel_hi:[1,0]
    ds_write_b32 v42, a172 offset:11968
    v_pk_mul_f32 v[164:165], v[164:165], v[20:21] op_sel_hi:[1,0]
    v_pk_mul_f32 v[166:167], v[166:167], v[20:21] op_sel_hi:[1,0]
    ds_write_b32 v42, a173 offset:12240
    v_pk_mul_f32 v[168:169], v[168:169], v[20:21] op_sel_hi:[1,0]
    v_pk_mul_f32 v[170:171], v[170:171], v[20:21] op_sel_hi:[1,0]
    ds_write_b32 v42, a174 offset:12512
    v_pk_mul_f32 v[172:173], v[172:173], v[20:21] op_sel_hi:[1,0]
    v_pk_mul_f32 v[174:175], v[174:175], v[20:21] op_sel_hi:[1,0]
    ds_write_b32 v42, a175 offset:12784
    v_pk_mul_f32 v[176:177], v[176:177], v[22:23] op_sel_hi:[1,0]
    v_pk_mul_f32 v[178:179], v[178:179], v[22:23] op_sel_hi:[1,0]
    ds_write_b32 v42, a176 offset:13056
    v_pk_mul_f32 v[180:181], v[180:181], v[22:23] op_sel_hi:[1,0]
    v_pk_mul_f32 v[182:183], v[182:183], v[22:23] op_sel_hi:[1,0]
    ds_write_b32 v42, a177 offset:13328
    v_pk_mul_f32 v[184:185], v[184:185], v[22:23] op_sel_hi:[1,0]
    v_pk_mul_f32 v[186:187], v[186:187], v[22:23] op_sel_hi:[1,0]
    ds_write_b32 v42, a178 offset:13600
    v_pk_mul_f32 v[188:189], v[188:189], v[22:23] op_sel_hi:[1,0]
    v_pk_mul_f32 v[190:191], v[190:191], v[22:23] op_sel_hi:[1,0]
    ds_write_b32 v42, a179 offset:13872
    v_cvt_pk_bf16_f32 v224, v160, v161
    v_cvt_pk_bf16_f32 v225, v162, v163
    ds_write_b32 v42, a180 offset:14144
    v_cvt_pk_bf16_f32 v226, v164, v165
    v_cvt_pk_bf16_f32 v227, v166, v167
    v_cvt_pk_bf16_f32 v228, v168, v169
    v_cvt_pk_bf16_f32 v229, v170, v171
    v_cvt_pk_bf16_f32 v230, v172, v173
    v_cvt_pk_bf16_f32 v231, v174, v175
    v_cvt_pk_bf16_f32 v232, v176, v177
    v_cvt_pk_bf16_f32 v233, v178, v179
    v_cvt_pk_bf16_f32 v234, v180, v181
    v_cvt_pk_bf16_f32 v235, v182, v183
    v_cvt_pk_bf16_f32 v236, v184, v185
    v_cvt_pk_bf16_f32 v237, v186, v187
    v_cvt_pk_bf16_f32 v238, v188, v189
    v_cvt_pk_bf16_f32 v239, v190, v191
    v_and_b32 v2, 15, v1
    v_lshlrev_b32 v2, 4, v2
    v_lshrrev_b32 v3, 4, v1
    v_lshl_add_u32 v2, v3, 10, v2
    s_lshl_b32 s74, s6, 2
    s_add_u32 s74, s74, s3
    s_lshl_b32 s74, s74, 16
    s_lshl_b32 s75, s7, 12
    s_add_u32 s74, s74, s75
    s_add_u32 s74, s74, 4194304
    buffer_store_dwordx4 v[224:227], v2, s[8:11], s74 offen offset:0 sc1
    buffer_store_dwordx4 v[228:231], v2, s[8:11], s74 offen offset:256 sc1
    buffer_store_dwordx4 v[232:235], v2, s[8:11], s74 offen offset:512 sc1
    buffer_store_dwordx4 v[236:239], v2, s[8:11], s74 offen offset:768 sc1
    s_waitcnt vmcnt(9)
    v_lshrrev_b32 v26, 4, v1
    v_bfe_u32 v27, v1, 2, 2
    v_lshl_add_u32 v27, v26, 2, v27
    v_lshlrev_b32 v27, 6, v27
    v_and_b32 v26, 1, v26
    v_lshlrev_b32 v26, 1, v26
    v_bfe_u32 v28, v1, 1, 1
    v_xor_b32 v28, v28, v26
    v_lshl_add_u32 v26, v28, 4, v27
    v_and_b32 v27, 1, v1
    v_lshl_add_u32 v26, v27, 3, v26
    s_lshl_b32 s74, s3, 14
    s_add_u32 s74, s74, 32768
    v_add_u32 v26, s74, v26
    v_xor_b32 v27, 32, v26
    ds_read_b64_tr_b16 a[64:65], v26 offset:0
    ds_read_b64_tr_b16 a[66:67], v26 offset:1024
    ds_read_b64_tr_b16 a[68:69], v27 offset:0
    ds_read_b64_tr_b16 a[70:71], v27 offset:1024
    ds_read_b64_tr_b16 a[72:73], v26 offset:2048
    ds_read_b64_tr_b16 a[74:75], v26 offset:3072
    ds_read_b64_tr_b16 a[76:77], v27 offset:2048
    ds_read_b64_tr_b16 a[78:79], v27 offset:3072
    s_waitcnt lgkmcnt(6)
    ds_read_b64_tr_b16 a[80:81], v26 offset:4096
    ds_read_b64_tr_b16 a[82:83], v26 offset:5120
    ds_read_b64_tr_b16 a[84:85], v27 offset:4096
    ds_read_b64_tr_b16 a[86:87], v27 offset:5120
    ds_read_b64_tr_b16 a[88:89], v26 offset:6144
    ds_read_b64_tr_b16 a[90:91], v26 offset:7168
    ds_read_b64_tr_b16 a[92:93], v27 offset:6144
    ds_read_b64_tr_b16 a[94:95], v27 offset:7168
    s_waitcnt lgkmcnt(6)
    ds_read_b64_tr_b16 a[96:97], v26 offset:8192
    ds_read_b64_tr_b16 a[98:99], v26 offset:9216
    ds_read_b64_tr_b16 a[100:101], v27 offset:8192
    ds_read_b64_tr_b16 a[102:103], v27 offset:9216
    ds_read_b64_tr_b16 a[104:105], v26 offset:10240
    ds_read_b64_tr_b16 a[106:107], v26 offset:11264
    ds_read_b64_tr_b16 a[108:109], v27 offset:10240
    ds_read_b64_tr_b16 a[110:111], v27 offset:11264
    s_waitcnt lgkmcnt(6)
    ds_read_b64_tr_b16 a[112:113], v26 offset:12288
    ds_read_b64_tr_b16 a[114:115], v26 offset:13312
    ds_read_b64_tr_b16 a[116:117], v27 offset:12288
    ds_read_b64_tr_b16 a[118:119], v27 offset:13312
    ds_read_b64_tr_b16 a[120:121], v26 offset:14336
    ds_read_b64_tr_b16 a[122:123], v26 offset:15360
    ds_read_b64_tr_b16 a[124:125], v27 offset:14336
    ds_read_b64_tr_b16 a[126:127], v27 offset:15360
    s_waitcnt lgkmcnt(6)
    s_waitcnt lgkmcnt(0)
    s_waitcnt vmcnt(0)
    s_waitcnt lgkmcnt(0)
    s_barrier
    s_cmp_lg_u32 s3, 0
    s_cbranch_scc1 Larr_9
    s_add_u32 s72, s64, 1
    s_lshl_b32 s73, s2, 7
    v_mov_b32 v2, s72
    v_mov_b32 v3, s73
    s_mov_b64 exec, 1
    buffer_store_dword v2, v3, s[8:11], 0 offen sc0 sc1
    s_mov_b64 exec, -1
Larr_9:
    v_and_b32 v2, 15, v1
    v_lshlrev_b32 v2, 11, v2
    v_lshrrev_b32 v3, 4, v1
    v_lshl_add_u32 v2, v3, 3, v2
    s_lshl_b32 s72, s67, 15
    s_lshl_b32 s73, s68, 8
    s_add_u32 s72, s72, s73
    s_lshl_b32 s73, s3, 6
    s_add_u32 s72, s72, s73
    buffer_load_dwordx2 v[104:105], v2, s[12:15], s72 offen offset:0
    buffer_load_dwordx2 v[106:107], v2, s[12:15], s72 offen offset:1024
    buffer_load_dwordx2 v[108:109], v2, s[12:15], s72 offen offset:32
    buffer_load_dwordx2 v[110:111], v2, s[12:15], s72 offen offset:1056
    s_lshl_b32 s75, s3, 14
    s_add_u32 s75, s75, 98304
    v_and_b32 v4, 31, v1
    v_mul_u32_u24 v4, 272, v4
    v_lshrrev_b32 v5, 5, v1
    v_lshl_add_u32 v4, v5, 4, v4
    v_add_u32 v7, s75, v4
    v_accvgpr_read_b32 v8, a184
    v_accvgpr_read_b32 v9, a185
    v_accvgpr_read_b32 v10, a186
    v_accvgpr_read_b32 v11, a187
    v_accvgpr_read_b32 v12, a188
    v_accvgpr_read_b32 v13, a189
    v_accvgpr_read_b32 v14, a190
    v_accvgpr_read_b32 v15, a191
    v_add_u32 v8, 8192, v8
    v_add_u32 v9, 8192, v9
    v_add_u32 v10, 8192, v10
    v_add_u32 v11, 8192, v11
    v_add_u32 v12, 8192, v12
    v_add_u32 v13, 8192, v13
    v_add_u32 v14, 8192, v14
    v_add_u32 v15, 8192, v15
    s_waitcnt lgkmcnt(0)
    ds_read_b128 v[64:67], v7 offset:0
    ds_read_b128 v[68:71], v7 offset:5712
    ds_read_b128 v[72:75], v7 offset:32
    ds_read_b128 v[76:79], v7 offset:5744
    ds_read_b128 v[80:83], v7 offset:64
    ds_read_b128 v[84:87], v7 offset:5776
    ds_read_b128 v[88:91], v7 offset:96
    ds_read_b128 v[92:95], v7 offset:5808
    s_waitcnt lgkmcnt(6)
    v_mfma_f32_32x32x16_bf16 v[48:63], v[64:67], v[68:71], 0
    ds_read_b128 v[64:67], v7 offset:128
    ds_read_b128 v[68:71], v7 offset:5840
    s_waitcnt lgkmcnt(6)
    v_mfma_f32_32x32x16_bf16 v[48:63], v[72:75], v[76:79], v[48:63]
    ds_read_b128 v[72:75], v7 offset:160
    ds_read_b128 v[76:79], v7 offset:5872
    s_waitcnt lgkmcnt(6)
    v_mfma_f32_32x32x16_bf16 v[48:63], v[80:83], v[84:87], v[48:63]
    ds_read_b128 v[80:83], v7 offset:192
    ds_read_b128 v[84:87], v7 offset:5904
    s_waitcnt lgkmcnt(6)
    v_mfma_f32_32x32x16_bf16 v[48:63], v[88:91], v[92:95], v[48:63]
    ds_read_b128 v[88:91], v7 offset:224
    ds_read_b128 v[92:95], v7 offset:5936
    s_waitcnt lgkmcnt(6)
    v_mfma_f32_32x32x16_bf16 v[48:63], v[64:67], v[68:71], v[48:63]
    s_waitcnt lgkmcnt(4)
    v_mfma_f32_32x32x16_bf16 v[48:63], v[72:75], v[76:79], v[48:63]
    s_waitcnt lgkmcnt(2)
    v_mfma_f32_32x32x16_bf16 v[48:63], v[80:83], v[84:87], v[48:63]
    s_waitcnt lgkmcnt(0)
    v_mfma_f32_32x32x16_bf16 v[48:63], v[88:91], v[92:95], v[48:63]
    s_lshr_b32 s75, s3, 1
    s_mul_i32 s75, s75, 1312
    s_add_u32 s75, s75, 8192
    v_and_b32 v2, 31, v1
    v_lshrrev_b32 v3, 5, v1
    v_cmp_eq_u32 vcc, 0, v3
    v_lshlrev_b32 v4, 3, v2
    v_lshl_add_u32 v4, v3, 2, v4
    v_lshlrev_b32 v4, 1, v4
    v_add_u32 v16, s75, v4
    v_lshlrev_b32 v4, 2, v2
    v_add_u32 v4, 256, v4
    v_lshlrev_b32 v5, 1, v2
    v_add_u32 v5, 384, v5
    v_cndmask_b32 v17, v5, v4, vcc
    v_lshlrev_b32 v17, 1, v17
    v_add_u32 v17, s75, v17
    v_add_u32 v4, 512, v2
    v_cmp_eq_u32 s[76:77], 32, v1
    v_mov_b32 v5, 646
    v_mov_b32 v20, 640
    v_cndmask_b32 v5, v5, v20, s[76:77]
    v_cndmask_b32 v18, v5, v4, vcc
    v_lshlrev_b32 v18, 1, v18
    v_add_u32 v18, s75, v18
    v_mov_b32 v5, 646
    v_lshlrev_b32 v5, 1, v5
    v_add_u32 v19, s75, v5
    s_or_b32 s72, s3, 1
    s_lshl_b32 s72, s72, 14
    s_add_u32 s72, s72, 32768
    v_lshlrev_b32 v6, 4, v1
    v_add_u32 v6, s72, v6
    s_and_b32 s73, s3, 1
    s_cmp_eq_u32 s73, 0
    s_cbranch_scc1 Lgo_10
    ds_write_b128 v6, v[48:51] offset:0
    ds_write_b128 v6, v[52:55] offset:1024
    ds_write_b128 v6, v[56:59] offset:2048
    ds_write_b128 v6, v[60:63] offset:3072
Lgo_10:
    s_waitcnt lgkmcnt(0)
    s_barrier
    s_and_b32 s73, s3, 1
    s_cmp_lg_u32 s73, 0
    s_cbranch_scc1 Lgd_11
    ds_read_b128 v[64:67], v6 offset:0
    ds_read_b128 v[68:71], v6 offset:1024
    ds_read_b128 v[72:75], v6 offset:2048
    s_waitcnt lgkmcnt(0)
    v_add_f32 v48, v48, v64
    v_add_f32 v49, v49, v65
    v_add_f32 v50, v50, v66
    v_add_f32 v51, v51, v67
    v_add_f32 v52, v52, v68
    v_add_f32 v53, v53, v69
    v_add_f32 v54, v54, v70
    v_add_f32 v55, v55, v71
    v_add_f32 v56, v56, v72
    v_add_f32 v57, v57, v73
    v_add_f32 v58, v58, v74
    v_add_f32 v59, v59, v75
    v_cvt_pk_bf16_f32 v20, v48, v52
    v_cvt_pk_bf16_f32 v21, v56, v56
    ds_write_b16 v16, v20 offset:0
    ds_write_b16_d16_hi v17, v20 offset:0
    ds_write_b16 v18, v21
    v_cvt_pk_bf16_f32 v20, v49, v53
    v_cvt_pk_bf16_f32 v21, v57, v57
    ds_write_b16 v16, v20 offset:2
    ds_write_b16_d16_hi v17, v20 offset:2
    v_add_u32 v22, 64, v18
    v_cndmask_b32 v22, v19, v22, vcc
    ds_write_b16 v22, v21
    v_cvt_pk_bf16_f32 v20, v50, v54
    v_cvt_pk_bf16_f32 v21, v58, v58
    ds_write_b16 v16, v20 offset:4
    v_add_u32 v22, 128, v17
    v_add_u32 v23, 4, v17
    v_cndmask_b32 v22, v22, v23, vcc
    ds_write_b16_d16_hi v22, v20
    v_add_u32 v22, 128, v18
    v_cndmask_b32 v22, v19, v22, vcc
    ds_write_b16 v22, v21
    v_cvt_pk_bf16_f32 v20, v51, v55
    v_cvt_pk_bf16_f32 v21, v59, v59
    ds_write_b16 v16, v20 offset:6
    v_add_u32 v22, 130, v17
    v_add_u32 v23, 6, v17
    v_cndmask_b32 v22, v22, v23, vcc
    ds_write_b16_d16_hi v22, v20
    v_add_u32 v22, 192, v18
    v_cndmask_b32 v22, v19, v22, vcc
    ds_write_b16 v22, v21
Lgd_11:
    s_waitcnt lgkmcnt(0)
    s_barrier
    v_lshlrev_b32 v100, 7, v0
    buffer_load_dword v101, v100, s[8:11], 0 offen sc1
    ds_read_u16 v24, v8 offset:0
    ds_read_u16 v25, v9 offset:0
    ds_read_u16 v26, v10 offset:0
    ds_read_u16 v27, v11 offset:0
    ds_read_u16 v28, v12 offset:0
    ds_read_u16 v29, v13 offset:0
    ds_read_u16 v30, v14 offset:0
    ds_read_u16 v31, v15 offset:0
    ds_read_u16 v32, v8 offset:1312
    ds_read_u16 v33, v9 offset:1312
    ds_read_u16 v34, v10 offset:1312
    ds_read_u16 v35, v11 offset:1312
    ds_read_u16 v36, v12 offset:1312
    ds_read_u16 v37, v13 offset:1312
    ds_read_u16 v38, v14 offset:1312
    ds_read_u16 v39, v15 offset:1312
    s_lshl_b32 s72, s96, 1
    s_mul_i32 s73, s72, 4128
    s_add_u32 s73, s73, 147328
    v_lshlrev_b32 v6, 4, v0
    v_add_u32 v7, s73, v6
    s_waitcnt lgkmcnt(8)
    v_lshl_or_b32 v40, v25, 16, v24
    v_lshl_or_b32 v41, v27, 16, v26
    v_lshl_or_b32 v42, v29, 16, v28
    v_lshl_or_b32 v43, v31, 16, v30
    ds_write_b128 v7, v[40:43] offset:0
    s_waitcnt lgkmcnt(1)
    v_lshl_or_b32 v44, v33, 16, v32
    v_lshl_or_b32 v45, v35, 16, v34
    v_lshl_or_b32 v46, v37, 16, v36
    v_lshl_or_b32 v47, v39, 16, v38
    ds_write_b128 v7, v[44:47] offset:4128
    v_mov_b32 v36, 0
    v_mov_b32 v37, 0
    v_mov_b32 v38, 0
    v_mov_b32 v39, 0
    v_lshrrev_b32 v2, 1, v0
    v_mul_u32_u24 v2, 4128, v2
    v_and_b32 v3, 1, v0
    v_lshl_add_u32 v2, v3, 4, v2
    v_add_u32 v2, 151424, v2
    v_cmp_gt_u32 vcc, 8, v0
    s_nop 3
    s_and_saveexec_b64 s[76:77], vcc
    s_cbranch_execz Lrz_12
    ds_write_b128 v2, v[36:39]
Lrz_12:
    s_mov_b64 exec, s[76:77]
    v_lshlrev_b32 v10, 4, v1
    s_lshl_b32 s61, s3, 10
    s_add_u32 s61, s61, 131072
    s_lshl_b32 s36, s3, 14
    s_add_u32 s36, s36, 65536
    s_lshl_b32 s37, s67, 16
    s_lshl_b32 s74, s3, 14
    s_add_u32 s37, s37, s74
    s_add_u32 s37, s37, 4194304
    s_lshl_b32 s74, s3, 9
    s_add_u32 s74, s74, 131072
    v_lshlrev_b32 v11, 3, v1
    v_add_u32 v11, s74, v11
    v_lshrrev_b32 v8, 4, v1
    v_lshlrev_b32 v8, 4, v8
    v_add_u32 v8, s74, v8
    v_add_u32 v9, 98304, v10
    s_lshl_b32 s74, s3, 13
    v_add_u32 v9, s74, v9
    v_and_b32 v4, 15, v1
    v_lshlrev_b32 v4, 4, v4
    v_lshrrev_b32 v5, 4, v1
    v_lshl_add_u32 v38, v5, 14, v4
    v_lshl_add_u32 v39, v5, 2, v4
    s_lshl_b32 s72, s68, 5
    s_lshl_b32 s73, s3, 3
    s_add_u32 s72, s72, s73
    s_add_u32 s72, s72, 0
    s_lshl_b32 s72, s72, 14
    s_lshl_b32 s73, s67, 8
    s_add_u32 s72, s72, s73
    s_add_u32 s62, s72, 12582912
    s_lshl_b32 s72, s68, 5
    s_lshl_b32 s73, s3, 3
    s_add_u32 s72, s72, s73
    s_add_u32 s72, s72, 4
    s_lshl_b32 s72, s72, 14
    s_lshl_b32 s73, s67, 8
    s_add_u32 s72, s72, s73
    s_add_u32 s63, s72, 12582912
    s_lshl_b32 s72, s67, 8
    s_add_u32 s45, s72, 278528
    s_waitcnt vmcnt(0) lgkmcnt(0)
    v_lshlrev_b32 v2, 7, v0
    s_add_u32 s72, s64, 1
    s_mov_b32 s73, 0
    v_subrev_u32 v3, s72, v101
    v_cmpx_le_u32 vcc, 8, v3
    s_nop 4
    s_cbranch_execz Lgx_14
Lgw_13:
    buffer_load_dword v3, v2, s[8:11], 0 offen sc1
    s_add_u32 s73, s73, 1
    s_cmp_gt_u32 s73, 0x40000
    s_cbranch_scc1 Lgx_14
    s_waitcnt vmcnt(0)
    v_subrev_u32 v3, s72, v3
    v_cmpx_le_u32 vcc, 8, v3
    s_nop 4
    s_cbranch_execz Lgx_14
    s_branch Lgw_13
Lgx_14:
    s_waitcnt vmcnt(0)
    s_mov_b64 exec, -1
    s_barrier
    buffer_load_dwordx4 v[4:7], v10, s[8:11], s61 offen sc1
    s_add_u32 s38, s36, 0
    s_add_u32 s39, s37, 0
    buffer_load_dwordx4 v[128:131], v10, s[8:11], s38 offen sc1
    buffer_load_dwordx4 v[192:195], v10, s[8:11], s39 offen sc1
    buffer_load_dwordx4 v[132:135], v10, s[8:11], s38 offen offset:1024 sc1
    buffer_load_dwordx4 v[196:199], v10, s[8:11], s39 offen offset:1024 sc1
    s_add_u32 s38, s36, 2048
    s_add_u32 s39, s37, 2048
    buffer_load_dwordx4 v[136:139], v10, s[8:11], s38 offen sc1
    buffer_load_dwordx4 v[200:203], v10, s[8:11], s39 offen sc1
    buffer_load_dwordx4 v[140:143], v10, s[8:11], s38 offen offset:1024 sc1
    buffer_load_dwordx4 v[204:207], v10, s[8:11], s39 offen offset:1024 sc1
    s_add_u32 s38, s36, 4096
    s_add_u32 s39, s37, 4096
    buffer_load_dwordx4 v[144:147], v10, s[8:11], s38 offen sc1
    buffer_load_dwordx4 v[208:211], v10, s[8:11], s39 offen sc1
    buffer_load_dwordx4 v[148:151], v10, s[8:11], s38 offen offset:1024 sc1
    buffer_load_dwordx4 v[212:215], v10, s[8:11], s39 offen offset:1024 sc1
    s_add_u32 s38, s36, 6144
    s_add_u32 s39, s37, 6144
    buffer_load_dwordx4 v[152:155], v10, s[8:11], s38 offen sc1
    buffer_load_dwordx4 v[216:219], v10, s[8:11], s39 offen sc1
    buffer_load_dwordx4 v[156:159], v10, s[8:11], s38 offen offset:1024 sc1
    buffer_load_dwordx4 v[220:223], v10, s[8:11], s39 offen offset:1024 sc1
    s_lshl_b32 s72, s96, 1
    s_lshl_b32 s73, s69, 2
    s_add_u32 s73, s73, s72
    s_mul_i32 s73, s73, 4128
    s_add_u32 s73, s73, 18874368
    v_lshlrev_b32 v3, 4, v0
    buffer_store_dwordx4 v[40:43], v3, s[8:11], s73 offen sc1
    s_add_u32 s73, s73, 4128
    buffer_store_dwordx4 v[44:47], v3, s[8:11], s73 offen sc1
    v_lshlrev_b32 v60, 4, v0
    v_add_u32 v61, 147328, v60
    s_lshl_b32 s72, s96, 1
    s_mul_i32 s74, s72, 4128
    s_mul_i32 s75, s72, 16640
    s_add_u32 s75, s75, 0
    v_add_u32 v37, s74, v61
    ds_read_b128 v[12:15], v37 offset:0
    ds_read_b64 v[16:17], v37 offset:16
    ds_read_b128 v[20:23], v37 offset:4128
    ds_read_b64 v[24:25], v37 offset:4144
    v_add_u32 v36, s75, v60
    s_waitcnt lgkmcnt(2)
    v_alignbyte_b32 v44, v13, v12, 2
    v_alignbyte_b32 v48, v14, v13, 2
    v_alignbyte_b32 v45, v14, v13, 2
    v_alignbyte_b32 v49, v15, v14, 2
    v_alignbyte_b32 v46, v15, v14, 2
    v_alignbyte_b32 v50, v16, v15, 2
    v_alignbyte_b32 v47, v16, v15, 2
    v_alignbyte_b32 v51, v17, v16, 2
    v_mov_b32 v52, v13
    v_mov_b32 v53, v14
    v_mov_b32 v54, v15
    v_mov_b32 v55, v16
    ds_write_b128 v36, v[12:15] offset:12480
    ds_write_b128 v36, v[44:47] offset:8320
    ds_write_b128 v36, v[48:51] offset:0
    ds_write_b128 v36, v[52:55] offset:4160
    s_waitcnt lgkmcnt(4)
    v_alignbyte_b32 v44, v21, v20, 2
    v_alignbyte_b32 v48, v22, v21, 2
    v_alignbyte_b32 v45, v22, v21, 2
    v_alignbyte_b32 v49, v23, v22, 2
    v_alignbyte_b32 v46, v23, v22, 2
    v_alignbyte_b32 v50, v24, v23, 2
    v_alignbyte_b32 v47, v24, v23, 2
    v_alignbyte_b32 v51, v25, v24, 2
    v_mov_b32 v52, v21
    v_mov_b32 v53, v22
    v_mov_b32 v54, v23
    v_mov_b32 v55, v24
    ds_write_b128 v36, v[20:23] offset:29120
    ds_write_b128 v36, v[44:47] offset:24960
    ds_write_b128 v36, v[48:51] offset:16640
    ds_write_b128 v36, v[52:55] offset:20800
    v_mov_b32 v56, 0
    v_mov_b32 v57, 0
    v_mov_b32 v58, 0
    v_mov_b32 v59, 0
    v_lshrrev_b32 v62, 1, v0
    v_mul_u32_u24 v62, 4160, v62
    v_and_b32 v63, 1, v0
    v_lshl_add_u32 v62, v63, 4, v62
    v_add_u32 v62, 4096, v62
    v_cmp_gt_u32 vcc, 32, v0
    s_nop 3
    s_and_saveexec_b64 s[76:77], vcc
    s_cbranch_execz Lcz_15
    ds_write_b128 v62, v[56:59]
Lcz_15:
    s_mov_b64 exec, s[76:77]
    s_waitcnt vmcnt(18)
    v_cvt_pk_bf16_f32 v4, v4, v5
    v_cvt_pk_bf16_f32 v5, v6, v7
    ds_write_b64 v11, v[4:5]
    s_waitcnt lgkmcnt(0)
    ds_read_b128 v[72:75], v8 offset:0
    ds_read_b128 v[76:79], v8 offset:64
    ds_read_b128 v[80:83], v8 offset:128
    ds_read_b128 v[84:87], v8 offset:192
    ds_read_b128 v[88:91], v8 offset:256
    ds_read_b128 v[92:95], v8 offset:320
    ds_read_b128 v[96:99], v8 offset:384
    ds_read_b128 v[100:103], v8 offset:448
    s_waitcnt vmcnt(14)
    v_cvt_pk_bf16_f32 v40, v128, v129
    v_cvt_pk_bf16_f32 v41, v130, v131
    v_cvt_pk_bf16_f32 v42, v132, v133
    v_cvt_pk_bf16_f32 v43, v134, v135
    s_waitcnt lgkmcnt(0)
    v_mfma_f32_16x16x32_bf16 v[16:19], v[72:75], v[192:195], 0
    v_mfma_f32_16x16x32_bf16 v[24:27], v[72:75], v[196:199], 0
    v_mfma_f32_16x16x32_bf16 v[12:15], v[40:43], v[192:195], 0
    v_mfma_f32_16x16x32_bf16 v[20:23], v[40:43], v[196:199], 0
    s_add_u32 s38, s36, 8192
    s_add_u32 s39, s37, 8192
    buffer_load_dwordx4 v[160:163], v10, s[8:11], s38 offen sc1
    buffer_load_dwordx4 v[224:227], v10, s[8:11], s39 offen sc1
    buffer_load_dwordx4 v[164:167], v10, s[8:11], s38 offen offset:1024 sc1
    buffer_load_dwordx4 v[228:231], v10, s[8:11], s39 offen offset:1024 sc1
    s_waitcnt vmcnt(14)
    v_cvt_pk_bf16_f32 v44, v136, v137
    v_cvt_pk_bf16_f32 v45, v138, v139
    v_cvt_pk_bf16_f32 v46, v140, v141
    v_cvt_pk_bf16_f32 v47, v142, v143
    s_nop 0
    v_mfma_f32_16x16x32_bf16 v[116:119], v[76:79], v[200:203], 0
    v_mfma_f32_16x16x32_bf16 v[124:127], v[76:79], v[204:207], 0
    v_mfma_f32_16x16x32_bf16 v[112:115], v[44:47], v[200:203], 0
    v_mfma_f32_16x16x32_bf16 v[120:123], v[44:47], v[204:207], 0
    v_add_f32 v16, 0x358637bd, v16
    v_add_f32 v24, 0x358637bd, v24
    v_rcp_f32 v16, v16
    v_rcp_f32 v24, v24
    v_mul_f32 v12, v12, v16
    v_mul_f32 v13, v13, v16
    v_mul_f32 v14, v14, v16
    v_mul_f32 v15, v15, v16
    v_mul_f32 v20, v20, v24
    v_mul_f32 v21, v21, v24
    v_mul_f32 v22, v22, v24
    v_mul_f32 v23, v23, v24
    v_cvt_pk_bf16_f32 v28, v12, v13
    v_cvt_pk_bf16_f32 v29, v14, v15
    v_cvt_pk_bf16_f32 v32, v20, v21
    v_cvt_pk_bf16_f32 v33, v22, v23
    s_add_u32 s38, s36, 10240
    s_add_u32 s39, s37, 10240
    buffer_load_dwordx4 v[168:171], v10, s[8:11], s38 offen sc1
    buffer_load_dwordx4 v[232:235], v10, s[8:11], s39 offen sc1
    buffer_load_dwordx4 v[172:175], v10, s[8:11], s38 offen offset:1024 sc1
    buffer_load_dwordx4 v[236:239], v10, s[8:11], s39 offen offset:1024 sc1
    s_waitcnt vmcnt(14)
    v_cvt_pk_bf16_f32 v48, v144, v145
    v_cvt_pk_bf16_f32 v49, v146, v147
    v_cvt_pk_bf16_f32 v50, v148, v149
    v_cvt_pk_bf16_f32 v51, v150, v151
    s_nop 0
    v_mfma_f32_16x16x32_bf16 v[16:19], v[80:83], v[208:211], 0
    v_mfma_f32_16x16x32_bf16 v[24:27], v[80:83], v[212:215], 0
    v_mfma_f32_16x16x32_bf16 v[12:15], v[48:51], v[208:211], 0
    v_mfma_f32_16x16x32_bf16 v[20:23], v[48:51], v[212:215], 0
    v_add_f32 v116, 0x358637bd, v116
    v_add_f32 v124, 0x358637bd, v124
    v_rcp_f32 v116, v116
    v_rcp_f32 v124, v124
    v_mul_f32 v112, v112, v116
    v_mul_f32 v113, v113, v116
    v_mul_f32 v114, v114, v116
    v_mul_f32 v115, v115, v116
    v_mul_f32 v120, v120, v124
    v_mul_f32 v121, v121, v124
    v_mul_f32 v122, v122, v124
    v_mul_f32 v123, v123, v124
    v_cvt_pk_bf16_f32 v30, v112, v113
    v_cvt_pk_bf16_f32 v31, v114, v115
    v_cvt_pk_bf16_f32 v34, v120, v121
    v_cvt_pk_bf16_f32 v35, v122, v123
    ds_write_b128 v9, v[28:31] offset:0
    ds_write_b128 v9, v[32:35] offset:1024
    s_add_u32 s38, s36, 12288
    s_add_u32 s39, s37, 12288
    buffer_load_dwordx4 v[176:179], v10, s[8:11], s38 offen sc1
    buffer_load_dwordx4 v[240:243], v10, s[8:11], s39 offen sc1
    buffer_load_dwordx4 v[180:183], v10, s[8:11], s38 offen offset:1024 sc1
    buffer_load_dwordx4 v[244:247], v10, s[8:11], s39 offen offset:1024 sc1
    s_waitcnt vmcnt(14)
    v_cvt_pk_bf16_f32 v52, v152, v153
    v_cvt_pk_bf16_f32 v53, v154, v155
    v_cvt_pk_bf16_f32 v54, v156, v157
    v_cvt_pk_bf16_f32 v55, v158, v159
    s_nop 0
    v_mfma_f32_16x16x32_bf16 v[116:119], v[84:87], v[216:219], 0
    v_mfma_f32_16x16x32_bf16 v[124:127], v[84:87], v[220:223], 0
    v_mfma_f32_16x16x32_bf16 v[112:115], v[52:55], v[216:219], 0
    v_mfma_f32_16x16x32_bf16 v[120:123], v[52:55], v[220:223], 0
    v_add_f32 v16, 0x358637bd, v16
    v_add_f32 v24, 0x358637bd, v24
    v_rcp_f32 v16, v16
    v_rcp_f32 v24, v24
    v_mul_f32 v12, v12, v16
    v_mul_f32 v13, v13, v16
    v_mul_f32 v14, v14, v16
    v_mul_f32 v15, v15, v16
    v_mul_f32 v20, v20, v24
    v_mul_f32 v21, v21, v24
    v_mul_f32 v22, v22, v24
    v_mul_f32 v23, v23, v24
    v_cvt_pk_bf16_f32 v28, v12, v13
    v_cvt_pk_bf16_f32 v29, v14, v15
    v_cvt_pk_bf16_f32 v32, v20, v21
    v_cvt_pk_bf16_f32 v33, v22, v23
    s_add_u32 s38, s36, 14336
    s_add_u32 s39, s37, 14336
    buffer_load_dwordx4 v[184:187], v10, s[8:11], s38 offen sc1
    buffer_load_dwordx4 v[248:251], v10, s[8:11], s39 offen sc1
    buffer_load_dwordx4 v[188:191], v10, s[8:11], s38 offen offset:1024 sc1
    buffer_load_dwordx4 v[252:255], v10, s[8:11], s39 offen offset:1024 sc1
    s_waitcnt vmcnt(12)
    v_cvt_pk_bf16_f32 v56, v160, v161
    v_cvt_pk_bf16_f32 v57, v162, v163
    v_cvt_pk_bf16_f32 v58, v164, v165
    v_cvt_pk_bf16_f32 v59, v166, v167
    s_nop 0
    v_mfma_f32_16x16x32_bf16 v[16:19], v[88:91], v[224:227], 0
    v_mfma_f32_16x16x32_bf16 v[24:27], v[88:91], v[228:231], 0
    v_mfma_f32_16x16x32_bf16 v[12:15], v[56:59], v[224:227], 0
    v_mfma_f32_16x16x32_bf16 v[20:23], v[56:59], v[228:231], 0
    s_barrier
    s_cmp_lg_u32 s3, 0
    s_cbranch_scc1 Lrf_16
    s_lshl_b32 s73, s2, 7
    s_add_u32 s73, s73, 32768
    v_mov_b32 v36, s64
    v_mov_b32 v37, s73
    s_mov_b64 exec, 1
    buffer_store_dword v36, v37, s[8:11], 0 offen sc0 sc1
    s_mov_b64 exec, -1
Lrf_16:
    v_add_f32 v116, 0x358637bd, v116
    v_add_f32 v124, 0x358637bd, v124
    v_rcp_f32 v116, v116
    v_rcp_f32 v124, v124
    v_mul_f32 v112, v112, v116
    v_mul_f32 v113, v113, v116
    v_mul_f32 v114, v114, v116
    v_mul_f32 v115, v115, v116
    v_mul_f32 v120, v120, v124
    v_mul_f32 v121, v121, v124
    v_mul_f32 v122, v122, v124
    v_mul_f32 v123, v123, v124
    v_cvt_pk_bf16_f32 v30, v112, v113
    v_cvt_pk_bf16_f32 v31, v114, v115
    v_cvt_pk_bf16_f32 v34, v120, v121
    v_cvt_pk_bf16_f32 v35, v122, v123
    ds_write_b128 v9, v[28:31] offset:2048
    ds_write_b128 v9, v[32:35] offset:3072
    s_waitcnt vmcnt(8)
    v_cvt_pk_bf16_f32 v60, v168, v169
    v_cvt_pk_bf16_f32 v61, v170, v171
    v_cvt_pk_bf16_f32 v62, v172, v173
    v_cvt_pk_bf16_f32 v63, v174, v175
    s_nop 0
    v_mfma_f32_16x16x32_bf16 v[116:119], v[92:95], v[232:235], 0
    v_mfma_f32_16x16x32_bf16 v[124:127], v[92:95], v[236:239], 0
    v_mfma_f32_16x16x32_bf16 v[112:115], v[60:63], v[232:235], 0
    v_mfma_f32_16x16x32_bf16 v[120:123], v[60:63], v[236:239], 0
    v_add_f32 v16, 0x358637bd, v16
    v_add_f32 v24, 0x358637bd, v24
    v_rcp_f32 v16, v16
    v_rcp_f32 v24, v24
    v_mul_f32 v12, v12, v16
    v_mul_f32 v13, v13, v16
    v_mul_f32 v14, v14, v16
    v_mul_f32 v15, v15, v16
    v_mul_f32 v20, v20, v24
    v_mul_f32 v21, v21, v24
    v_mul_f32 v22, v22, v24
    v_mul_f32 v23, v23, v24
    v_cvt_pk_bf16_f32 v28, v12, v13
    v_cvt_pk_bf16_f32 v29, v14, v15
    v_cvt_pk_bf16_f32 v32, v20, v21
    v_cvt_pk_bf16_f32 v33, v22, v23
    s_waitcnt vmcnt(4)
    v_cvt_pk_bf16_f32 v64, v176, v177
    v_cvt_pk_bf16_f32 v65, v178, v179
    v_cvt_pk_bf16_f32 v66, v180, v181
    v_cvt_pk_bf16_f32 v67, v182, v183
    s_nop 0
    v_mfma_f32_16x16x32_bf16 v[16:19], v[96:99], v[240:243], 0
    v_mfma_f32_16x16x32_bf16 v[24:27], v[96:99], v[244:247], 0
    v_mfma_f32_16x16x32_bf16 v[12:15], v[64:67], v[240:243], 0
    v_mfma_f32_16x16x32_bf16 v[20:23], v[64:67], v[244:247], 0
    v_add_f32 v116, 0x358637bd, v116
    v_add_f32 v124, 0x358637bd, v124
    v_rcp_f32 v116, v116
    v_rcp_f32 v124, v124
    v_mul_f32 v112, v112, v116
    v_mul_f32 v113, v113, v116
    v_mul_f32 v114, v114, v116
    v_mul_f32 v115, v115, v116
    v_mul_f32 v120, v120, v124
    v_mul_f32 v121, v121, v124
    v_mul_f32 v122, v122, v124
    v_mul_f32 v123, v123, v124
    v_cvt_pk_bf16_f32 v30, v112, v113
    v_cvt_pk_bf16_f32 v31, v114, v115
    v_cvt_pk_bf16_f32 v34, v120, v121
    v_cvt_pk_bf16_f32 v35, v122, v123
    ds_write_b128 v9, v[28:31] offset:4096
    ds_write_b128 v9, v[32:35] offset:5120
    s_waitcnt vmcnt(0)
    v_cvt_pk_bf16_f32 v68, v184, v185
    v_cvt_pk_bf16_f32 v69, v186, v187
    v_cvt_pk_bf16_f32 v70, v188, v189
    v_cvt_pk_bf16_f32 v71, v190, v191
    s_nop 0
    v_mfma_f32_16x16x32_bf16 v[116:119], v[100:103], v[248:251], 0
    v_mfma_f32_16x16x32_bf16 v[124:127], v[100:103], v[252:255], 0
    v_mfma_f32_16x16x32_bf16 v[112:115], v[68:71], v[248:251], 0
    v_mfma_f32_16x16x32_bf16 v[120:123], v[68:71], v[252:255], 0
    v_add_f32 v16, 0x358637bd, v16
    v_add_f32 v24, 0x358637bd, v24
    v_rcp_f32 v16, v16
    v_rcp_f32 v24, v24
    v_mul_f32 v12, v12, v16
    v_mul_f32 v13, v13, v16
    v_mul_f32 v14, v14, v16
    v_mul_f32 v15, v15, v16
    v_mul_f32 v20, v20, v24
    v_mul_f32 v21, v21, v24
    v_mul_f32 v22, v22, v24
    v_mul_f32 v23, v23, v24
    v_cvt_pk_bf16_f32 v28, v12, v13
    v_cvt_pk_bf16_f32 v29, v14, v15
    v_cvt_pk_bf16_f32 v32, v20, v21
    v_cvt_pk_bf16_f32 v33, v22, v23
    v_add_f32 v116, 0x358637bd, v116
    v_add_f32 v124, 0x358637bd, v124
    v_rcp_f32 v116, v116
    v_rcp_f32 v124, v124
    v_mul_f32 v112, v112, v116
    v_mul_f32 v113, v113, v116
    v_mul_f32 v114, v114, v116
    v_mul_f32 v115, v115, v116
    v_mul_f32 v120, v120, v124
    v_mul_f32 v121, v121, v124
    v_mul_f32 v122, v122, v124
    v_mul_f32 v123, v123, v124
    v_cvt_pk_bf16_f32 v30, v112, v113
    v_cvt_pk_bf16_f32 v31, v114, v115
    v_cvt_pk_bf16_f32 v34, v120, v121
    v_cvt_pk_bf16_f32 v35, v122, v123
    ds_write_b128 v9, v[28:31] offset:6144
    ds_write_b128 v9, v[32:35] offset:7168
    s_waitcnt lgkmcnt(0)
    s_barrier
    v_add_u32 v9, 98304, v10
    ds_read_b128 v[128:131], v9 offset:0
    ds_read_b128 v[132:135], v9 offset:1024
    ds_read_b128 v[136:139], v9 offset:2048
    ds_read_b128 v[140:143], v9 offset:3072
    ds_read_b128 v[144:147], v9 offset:4096
    ds_read_b128 v[148:151], v9 offset:5120
    ds_read_b128 v[152:155], v9 offset:6144
    ds_read_b128 v[156:159], v9 offset:7168
    s_waitcnt lgkmcnt(6)
    v_mfma_f32_16x16x32_bf16 v[12:15], a[0:3], v[128:131], 0
    v_mfma_f32_16x16x32_bf16 v[16:19], a[0:3], v[132:135], 0
    v_mfma_f32_16x16x32_bf16 v[20:23], a[4:7], v[128:131], 0
    v_mfma_f32_16x16x32_bf16 v[24:27], a[4:7], v[132:135], 0
    ds_read_b128 v[160:163], v9 offset:8192
    ds_read_b128 v[164:167], v9 offset:9216
    s_waitcnt lgkmcnt(6)
    v_mfma_f32_16x16x32_bf16 v[12:15], a[8:11], v[136:139], v[12:15]
    v_mfma_f32_16x16x32_bf16 v[16:19], a[8:11], v[140:143], v[16:19]
    v_mfma_f32_16x16x32_bf16 v[20:23], a[12:15], v[136:139], v[20:23]
    v_mfma_f32_16x16x32_bf16 v[24:27], a[12:15], v[140:143], v[24:27]
    ds_read_b128 v[168:171], v9 offset:10240
    ds_read_b128 v[172:175], v9 offset:11264
    s_waitcnt lgkmcnt(6)
    v_mfma_f32_16x16x32_bf16 v[12:15], a[16:19], v[144:147], v[12:15]
    v_mfma_f32_16x16x32_bf16 v[16:19], a[16:19], v[148:151], v[16:19]
    v_mfma_f32_16x16x32_bf16 v[20:23], a[20:23], v[144:147], v[20:23]
    v_mfma_f32_16x16x32_bf16 v[24:27], a[20:23], v[148:151], v[24:27]
    ds_read_b128 v[176:179], v9 offset:12288
    ds_read_b128 v[180:183], v9 offset:13312
    s_waitcnt lgkmcnt(6)
    v_mfma_f32_16x16x32_bf16 v[12:15], a[24:27], v[152:155], v[12:15]
    v_mfma_f32_16x16x32_bf16 v[16:19], a[24:27], v[156:159], v[16:19]
    v_mfma_f32_16x16x32_bf16 v[20:23], a[28:31], v[152:155], v[20:23]
    v_mfma_f32_16x16x32_bf16 v[24:27], a[28:31], v[156:159], v[24:27]
    ds_read_b128 v[184:187], v9 offset:14336
    ds_read_b128 v[188:191], v9 offset:15360
    s_waitcnt lgkmcnt(6)
    v_mfma_f32_16x16x32_bf16 v[12:15], a[32:35], v[160:163], v[12:15]
    v_mfma_f32_16x16x32_bf16 v[16:19], a[32:35], v[164:167], v[16:19]
    v_mfma_f32_16x16x32_bf16 v[20:23], a[36:39], v[160:163], v[20:23]
    v_mfma_f32_16x16x32_bf16 v[24:27], a[36:39], v[164:167], v[24:27]
    ds_read_b128 v[192:195], v9 offset:16384
    ds_read_b128 v[196:199], v9 offset:17408
    s_waitcnt lgkmcnt(6)
    v_mfma_f32_16x16x32_bf16 v[12:15], a[40:43], v[168:171], v[12:15]
    v_mfma_f32_16x16x32_bf16 v[16:19], a[40:43], v[172:175], v[16:19]
    v_mfma_f32_16x16x32_bf16 v[20:23], a[44:47], v[168:171], v[20:23]
    v_mfma_f32_16x16x32_bf16 v[24:27], a[44:47], v[172:175], v[24:27]
    ds_read_b128 v[200:203], v9 offset:18432
    ds_read_b128 v[204:207], v9 offset:19456
    s_waitcnt lgkmcnt(6)
    v_mfma_f32_16x16x32_bf16 v[12:15], a[48:51], v[176:179], v[12:15]
    v_mfma_f32_16x16x32_bf16 v[16:19], a[48:51], v[180:183], v[16:19]
    v_mfma_f32_16x16x32_bf16 v[20:23], a[52:55], v[176:179], v[20:23]
    v_mfma_f32_16x16x32_bf16 v[24:27], a[52:55], v[180:183], v[24:27]
    ds_read_b128 v[208:211], v9 offset:20480
    ds_read_b128 v[212:215], v9 offset:21504
    s_waitcnt lgkmcnt(6)
    v_mfma_f32_16x16x32_bf16 v[12:15], a[56:59], v[184:187], v[12:15]
    v_mfma_f32_16x16x32_bf16 v[16:19], a[56:59], v[188:191], v[16:19]
    v_mfma_f32_16x16x32_bf16 v[20:23], a[60:63], v[184:187], v[20:23]
    v_mfma_f32_16x16x32_bf16 v[24:27], a[60:63], v[188:191], v[24:27]
    ds_read_b128 v[216:219], v9 offset:22528
    ds_read_b128 v[220:223], v9 offset:23552
    s_waitcnt lgkmcnt(6)
    v_mfma_f32_16x16x32_bf16 v[12:15], a[64:67], v[192:195], v[12:15]
    v_mfma_f32_16x16x32_bf16 v[16:19], a[64:67], v[196:199], v[16:19]
    v_mfma_f32_16x16x32_bf16 v[20:23], a[68:71], v[192:195], v[20:23]
    v_mfma_f32_16x16x32_bf16 v[24:27], a[68:71], v[196:199], v[24:27]
    ds_read_b128 v[224:227], v9 offset:24576
    ds_read_b128 v[228:231], v9 offset:25600
    s_waitcnt lgkmcnt(6)
    v_mfma_f32_16x16x32_bf16 v[12:15], a[72:75], v[200:203], v[12:15]
    v_mfma_f32_16x16x32_bf16 v[16:19], a[72:75], v[204:207], v[16:19]
    v_mfma_f32_16x16x32_bf16 v[20:23], a[76:79], v[200:203], v[20:23]
    v_mfma_f32_16x16x32_bf16 v[24:27], a[76:79], v[204:207], v[24:27]
    ds_read_b128 v[232:235], v9 offset:26624
    ds_read_b128 v[236:239], v9 offset:27648
    s_waitcnt lgkmcnt(6)
    v_mfma_f32_16x16x32_bf16 v[12:15], a[80:83], v[208:211], v[12:15]
    v_mfma_f32_16x16x32_bf16 v[16:19], a[80:83], v[212:215], v[16:19]
    v_mfma_f32_16x16x32_bf16 v[20:23], a[84:87], v[208:211], v[20:23]
    v_mfma_f32_16x16x32_bf16 v[24:27], a[84:87], v[212:215], v[24:27]
    ds_read_b128 v[240:243], v9 offset:28672
    ds_read_b128 v[244:247], v9 offset:29696
    s_waitcnt lgkmcnt(6)
    v_mfma_f32_16x16x32_bf16 v[12:15], a[88:91], v[216:219], v[12:15]
    v_mfma_f32_16x16x32_bf16 v[16:19], a[88:91], v[220:223], v[16:19]
    v_mfma_f32_16x16x32_bf16 v[20:23], a[92:95], v[216:219], v[20:23]
    v_mfma_f32_16x16x32_bf16 v[24:27], a[92:95], v[220:223], v[24:27]
    ds_read_b128 v[248:251], v9 offset:30720
    ds_read_b128 v[252:255], v9 offset:31744
    s_waitcnt lgkmcnt(6)
    v_mfma_f32_16x16x32_bf16 v[12:15], a[96:99], v[224:227], v[12:15]
    v_mfma_f32_16x16x32_bf16 v[16:19], a[96:99], v[228:231], v[16:19]
    v_mfma_f32_16x16x32_bf16 v[20:23], a[100:103], v[224:227], v[20:23]
    v_mfma_f32_16x16x32_bf16 v[24:27], a[100:103], v[228:231], v[24:27]
    s_waitcnt lgkmcnt(4)
    v_mfma_f32_16x16x32_bf16 v[12:15], a[104:107], v[232:235], v[12:15]
    v_mfma_f32_16x16x32_bf16 v[16:19], a[104:107], v[236:239], v[16:19]
    v_mfma_f32_16x16x32_bf16 v[20:23], a[108:111], v[232:235], v[20:23]
    v_mfma_f32_16x16x32_bf16 v[24:27], a[108:111], v[236:239], v[24:27]
    s_waitcnt lgkmcnt(2)
    v_mfma_f32_16x16x32_bf16 v[12:15], a[112:115], v[240:243], v[12:15]
    v_mfma_f32_16x16x32_bf16 v[16:19], a[112:115], v[244:247], v[16:19]
    v_mfma_f32_16x16x32_bf16 v[20:23], a[116:119], v[240:243], v[20:23]
    v_mfma_f32_16x16x32_bf16 v[24:27], a[116:119], v[244:247], v[24:27]
    s_waitcnt lgkmcnt(0)
    v_mfma_f32_16x16x32_bf16 v[12:15], a[120:123], v[248:251], v[12:15]
    v_mfma_f32_16x16x32_bf16 v[16:19], a[120:123], v[252:255], v[16:19]
    v_mfma_f32_16x16x32_bf16 v[20:23], a[124:127], v[248:251], v[20:23]
    v_mfma_f32_16x16x32_bf16 v[24:27], a[124:127], v[252:255], v[24:27]
    s_xor_b32 s73, s2, 8
    s_lshl_b32 s73, s73, 7
    s_add_u32 s73, s73, 32768
    v_mov_b32 v37, s73
    buffer_load_dword v36, v37, s[8:11], 0 offen sc1
    v_lshlrev_b32 v40, 16, v104
    v_and_b32 v41, s44, v104
    v_lshlrev_b32 v42, 16, v105
    v_and_b32 v43, s44, v105
    v_lshlrev_b32 v44, 16, v106
    v_and_b32 v45, s44, v106
    v_lshlrev_b32 v46, 16, v107
    v_and_b32 v47, s44, v107
    v_lshlrev_b32 v48, 16, v108
    v_and_b32 v49, s44, v108
    v_lshlrev_b32 v50, 16, v109
    v_and_b32 v51, s44, v109
    v_lshlrev_b32 v52, 16, v110
    v_and_b32 v53, s44, v110
    v_lshlrev_b32 v54, 16, v111
    v_and_b32 v55, s44, v111
    v_pk_add_f32 v[12:13], v[12:13], v[40:41]
    v_pk_add_f32 v[14:15], v[14:15], v[42:43]
    v_pk_add_f32 v[16:17], v[16:17], v[44:45]
    v_pk_add_f32 v[18:19], v[18:19], v[46:47]
    v_pk_add_f32 v[20:21], v[20:21], v[48:49]
    v_pk_add_f32 v[22:23], v[22:23], v[50:51]
    v_pk_add_f32 v[24:25], v[24:25], v[52:53]
    v_pk_add_f32 v[26:27], v[26:27], v[54:55]
    v_cvt_pk_bf16_f32 v56, v12, v13
    v_cvt_pk_bf16_f32 v57, v14, v15
    v_cvt_pk_bf16_f32 v58, v16, v17
    v_cvt_pk_bf16_f32 v59, v18, v19
    buffer_store_dwordx4 v[56:59], v38, s[8:11], s62 offen sc1
    v_cvt_pk_bf16_f32 v60, v20, v21
    v_cvt_pk_bf16_f32 v61, v22, v23
    v_cvt_pk_bf16_f32 v62, v24, v25
    v_cvt_pk_bf16_f32 v63, v26, v27
    buffer_store_dwordx4 v[60:63], v38, s[8:11], s63 offen sc1
    v_pk_add_f32 v[48:49], v[12:13], v[14:15]
    v_pk_add_f32 v[50:51], v[20:21], v[22:23]
    v_pk_mul_f32 v[52:53], v[12:13], v[12:13]
    v_pk_fma_f32 v[52:53], v[14:15], v[14:15], v[52:53]
    v_pk_add_f32 v[48:49], v[48:49], v[50:51]
    v_pk_fma_f32 v[52:53], v[20:21], v[20:21], v[52:53]
    v_pk_fma_f32 v[52:53], v[22:23], v[22:23], v[52:53]
    v_add_f32 v44, v48, v49
    v_add_f32 v45, v52, v53
    v_pk_add_f32 v[48:49], v[16:17], v[18:19]
    v_pk_add_f32 v[50:51], v[24:25], v[26:27]
    v_pk_mul_f32 v[52:53], v[16:17], v[16:17]
    v_pk_fma_f32 v[52:53], v[18:19], v[18:19], v[52:53]
    v_pk_add_f32 v[48:49], v[48:49], v[50:51]
    v_pk_fma_f32 v[52:53], v[24:25], v[24:25], v[52:53]
    v_pk_fma_f32 v[52:53], v[26:27], v[26:27], v[52:53]
    v_add_f32 v46, v48, v49
    v_add_f32 v47, v52, v53
    s_nop 0
    v_permlane32_swap_b32 v44, v46
    v_permlane32_swap_b32 v45, v47
    v_add_f32 v44, v44, v46
    v_add_f32 v45, v45, v47
    s_nop 1
    v_permlane16_swap_b32 v44, v45
    v_add_f32 v44, v44, v45
    buffer_atomic_add_f32 v44, v39, s[8:11], s45 offen
    s_waitcnt vmcnt(3)
    v_cmp_ne_u32 vcc, s64, v36
    s_nop 4
    s_cbranch_vccz Lrx_18
    s_mov_b32 s72, 0
Lrp_17:
    buffer_load_dword v36, v37, s[8:11], 0 offen sc1
    s_add_u32 s72, s72, 1
    s_cmp_gt_u32 s72, 0x40000
    s_cbranch_scc1 Lrx_18
    s_waitcnt vmcnt(0)
    v_cmp_ne_u32 vcc, s64, v36
    s_nop 4
    s_cbranch_vccnz Lrp_17
Lrx_18:
    s_xor_b32 s72, s96, 1
    s_lshl_b32 s72, s72, 1
    s_lshl_b32 s73, s69, 2
    s_add_u32 s73, s73, s72
    s_mul_i32 s73, s73, 4128
    s_add_u32 s73, s73, 18874368
    v_lshlrev_b32 v69, 4, v0
    buffer_load_dwordx4 v[72:75], v69, s[8:11], s73 offen sc1
    s_add_u32 s73, s73, 4128
    buffer_load_dwordx4 v[76:79], v69, s[8:11], s73 offen sc1
    s_mul_i32 s73, s72, 4128
    s_add_u32 s73, s73, 147328
    v_add_u32 v68, s73, v69
    v_and_b32 v32, 3, v1
    v_mul_u32_u24 v32, 4160, v32
    v_and_b32 v33, 12, v1
    v_sub_u32 v33, 28, v33
    v_lshrrev_b32 v31, 5, v1
    v_lshlrev_b32 v31, 4, v31
    v_sub_u32 v33, v33, v31
    v_bfe_u32 v31, v1, 4, 1
    v_lshl_add_u32 v33, v31, 3, v33
    v_lshl_add_u32 v32, v33, 1, v32
    s_mul_i32 s72, s3, 16640
    s_add_u32 s72, s72, 0
    v_add_u32 v32, s72, v32
    v_lshrrev_b32 v5, 7, v0
    v_and_b32 v14, 127, v0
    v_lshlrev_b32 v14, 1, v14
    s_xor_b32 s72, s96, 0
    s_cmp_eq_u32 s72, 0
    s_cselect_b32 s73, 3, 1
    v_mul_u32_u24 v4, s73, v5
    v_add_u32 v4, s72, v4
    v_lshl_add_u32 v6, v4, 8, v14
    s_xor_b32 s72, s96, 1
    s_cmp_eq_u32 s72, 0
    s_cselect_b32 s73, 3, 1
    v_mul_u32_u24 v4, s73, v5
    v_add_u32 v4, s72, v4
    v_lshl_add_u32 v7, v4, 8, v14
    s_lshl_b32 s36, s69, 14
    s_add_u32 s36, s36, 12582912
    s_mov_b32 s37, 278528
    v_lshlrev_b32 v8, 3, v6
    v_lshlrev_b32 v9, 3, v7
    v_add_u32 v10, 8192, v8
    v_add_u32 v11, 8192, v9
    v_lshlrev_b32 v12, 1, v6
    v_add_u32 v12, 98816, v12
    v_lshlrev_b32 v13, 1, v7
    v_add_u32 v13, 98816, v13
    v_and_b32 v4, 15, v1
    v_lshrrev_b32 v5, 5, v1
    v_sub_u32 v4, v4, v5
    v_lshlrev_b32 v4, 5, v4
    v_bfe_u32 v5, v1, 4, 1
    v_lshl_add_u32 v4, v5, 4, v4
    s_mul_i32 s72, s3, 4608
    s_add_u32 s72, s72, 98368
    v_add_u32 v4, s72, v4
    v_and_b32 v14, 15, v1
    v_lshlrev_b32 v14, 6, v14
    v_lshrrev_b32 v5, 4, v1
    v_lshl_add_u32 v14, v5, 4, v14
    s_lshl_b32 s72, s3, 12
    s_add_u32 s72, s72, 118784
    v_add_u32 v14, s72, v14
    v_lshrrev_b32 v15, 7, v0
    v_and_b32 v5, 127, v0
    v_lshlrev_b32 v5, 3, v5
    v_lshl_add_u32 v15, v15, 10, v5
    v_add_u32 v15, 118784, v15
    s_waitcnt vmcnt(2)
    s_waitcnt lgkmcnt(0)
    s_barrier
    s_cmp_lg_u32 s3, 0
    s_cbranch_scc1 Larr_19
    s_add_u32 s72, s64, 2
    s_lshl_b32 s73, s2, 7
    v_mov_b32 v2, s72
    v_mov_b32 v3, s73
    s_mov_b64 exec, 1
    buffer_store_dword v2, v3, s[8:11], 0 offen sc0 sc1
    s_mov_b64 exec, -1
Larr_19:
    v_mov_b32 v56, 0
    v_mov_b32 v57, 0
    v_mov_b32 v58, 0
    v_mov_b32 v59, 0
    v_lshrrev_b32 v30, 5, v0
    v_mul_u32_u24 v30, 4608, v30
    v_and_b32 v33, 31, v0
    v_lshl_add_u32 v30, v33, 4, v30
    v_add_u32 v30, 98304, v30
    v_cmp_gt_u32 vcc, 128, v0
    s_nop 3
    s_and_saveexec_b64 s[76:77], vcc
    s_cbranch_execz Luz_20
    ds_write_b128 v30, v[56:59]
Luz_20:
    s_mov_b64 exec, s[76:77]
    v_lshlrev_b32 v60, 4, v0
    v_add_u32 v61, 147328, v60
    s_xor_b32 s72, s96, 1
    s_lshl_b32 s72, s72, 1
    s_mul_i32 s74, s72, 4128
    s_mul_i32 s75, s72, 16640
    s_add_u32 s75, s75, 0
    s_cmp_eq_u32 s3, 0
    s_cbranch_scc1 Lrw0_21
    s_waitcnt vmcnt(0)
    s_branch Lrw1_22
Lrw0_21:
    s_waitcnt vmcnt(1)
Lrw1_22:
    ds_write_b128 v68, v[72:75]
    ds_write_b128 v68, v[76:79] offset:4128
    s_waitcnt lgkmcnt(0)
    s_barrier
    v_add_u32 v30, s74, v61
    ds_read_b128 v[16:19], v30 offset:0
    ds_read_b64 v[20:21], v30 offset:16
    ds_read_b128 v[24:27], v30 offset:4128
    ds_read_b64 v[28:29], v30 offset:4144
    v_add_u32 v31, s75, v60
    s_waitcnt lgkmcnt(2)
    v_alignbyte_b32 v44, v17, v16, 2
    v_alignbyte_b32 v48, v18, v17, 2
    v_alignbyte_b32 v45, v18, v17, 2
    v_alignbyte_b32 v49, v19, v18, 2
    v_alignbyte_b32 v46, v19, v18, 2
    v_alignbyte_b32 v50, v20, v19, 2
    v_alignbyte_b32 v47, v20, v19, 2
    v_alignbyte_b32 v51, v21, v20, 2
    v_mov_b32 v52, v17
    v_mov_b32 v53, v18
    v_mov_b32 v54, v19
    v_mov_b32 v55, v20
    ds_write_b128 v31, v[16:19] offset:12480
    ds_write_b128 v31, v[44:47] offset:8320
    ds_write_b128 v31, v[48:51] offset:0
    ds_write_b128 v31, v[52:55] offset:4160
    s_waitcnt lgkmcnt(4)
    v_alignbyte_b32 v44, v25, v24, 2
    v_alignbyte_b32 v48, v26, v25, 2
    v_alignbyte_b32 v45, v26, v25, 2
    v_alignbyte_b32 v49, v27, v26, 2
    v_alignbyte_b32 v46, v27, v26, 2
    v_alignbyte_b32 v50, v28, v27, 2
    v_alignbyte_b32 v47, v28, v27, 2
    v_alignbyte_b32 v51, v29, v28, 2
    v_mov_b32 v52, v25
    v_mov_b32 v53, v26
    v_mov_b32 v54, v27
    v_mov_b32 v55, v28
    ds_write_b128 v31, v[24:27] offset:29120
    ds_write_b128 v31, v[44:47] offset:24960
    ds_write_b128 v31, v[48:51] offset:16640
    ds_write_b128 v31, v[52:55] offset:20800
    s_waitcnt lgkmcnt(0)
    s_barrier
    ds_read_b64 a[128:129], v32 offset:4032
    ds_read_b64 a[130:131], v32 offset:4040
    ds_read_b64 a[132:133], v32 offset:3968
    ds_read_b64 a[134:135], v32 offset:3976
    ds_read_b64 a[136:137], v32 offset:3904
    ds_read_b64 a[138:139], v32 offset:3912
    ds_read_b64 a[140:141], v32 offset:3840
    ds_read_b64 a[142:143], v32 offset:3848
    s_waitcnt lgkmcnt(6)
    ds_read_b64 a[144:145], v32 offset:3776
    ds_read_b64 a[146:147], v32 offset:3784
    ds_read_b64 a[148:149], v32 offset:3712
    ds_read_b64 a[150:151], v32 offset:3720
    ds_read_b64 a[152:153], v32 offset:3648
    ds_read_b64 a[154:155], v32 offset:3656
    ds_read_b64 a[156:157], v32 offset:3584
    ds_read_b64 a[158:159], v32 offset:3592
    s_waitcnt lgkmcnt(6)
    ds_read_b64 a[160:161], v32 offset:3520
    ds_read_b64 a[162:163], v32 offset:3528
    ds_read_b64 a[164:165], v32 offset:3456
    ds_read_b64 a[166:167], v32 offset:3464
    ds_read_b64 a[168:169], v32 offset:3392
    ds_read_b64 a[170:171], v32 offset:3400
    ds_read_b64 a[172:173], v32 offset:3328
    ds_read_b64 a[174:175], v32 offset:3336
    s_waitcnt lgkmcnt(6)
    ds_read_b64 a[176:177], v32 offset:3264
    ds_read_b64 a[178:179], v32 offset:3272
    ds_read_b64 a[180:181], v32 offset:3200
    ds_read_b64 a[182:183], v32 offset:3208
    ds_read_b64 a[184:185], v32 offset:3136
    ds_read_b64 a[186:187], v32 offset:3144
    ds_read_b64 a[188:189], v32 offset:3072
    ds_read_b64 a[190:191], v32 offset:3080
    s_waitcnt lgkmcnt(6)
    ds_read_b64 a[192:193], v32 offset:3008
    ds_read_b64 a[194:195], v32 offset:3016
    ds_read_b64 a[196:197], v32 offset:2944
    ds_read_b64 a[198:199], v32 offset:2952
    ds_read_b64 a[200:201], v32 offset:2880
    ds_read_b64 a[202:203], v32 offset:2888
    ds_read_b64 a[204:205], v32 offset:2816
    ds_read_b64 a[206:207], v32 offset:2824
    s_waitcnt lgkmcnt(6)
    ds_read_b64 a[208:209], v32 offset:2752
    ds_read_b64 a[210:211], v32 offset:2760
    ds_read_b64 a[212:213], v32 offset:2688
    ds_read_b64 a[214:215], v32 offset:2696
    ds_read_b64 a[216:217], v32 offset:2624
    ds_read_b64 a[218:219], v32 offset:2632
    ds_read_b64 a[220:221], v32 offset:2560
    ds_read_b64 a[222:223], v32 offset:2568
    s_waitcnt lgkmcnt(6)
    ds_read_b64 a[224:225], v32 offset:2496
    ds_read_b64 a[226:227], v32 offset:2504
    ds_read_b64 a[228:229], v32 offset:2432
    ds_read_b64 a[230:231], v32 offset:2440
    ds_read_b64 a[232:233], v32 offset:2368
    ds_read_b64 a[234:235], v32 offset:2376
    ds_read_b64 a[236:237], v32 offset:2304
    ds_read_b64 a[238:239], v32 offset:2312
    s_waitcnt lgkmcnt(6)
    ds_read_b64 v[112:113], v32 offset:2240
    ds_read_b64 v[114:115], v32 offset:2248
    ds_read_b64 v[116:117], v32 offset:2176
    ds_read_b64 v[118:119], v32 offset:2184
    ds_read_b64 v[120:121], v32 offset:2112
    ds_read_b64 v[122:123], v32 offset:2120
    ds_read_b64 v[124:125], v32 offset:2048
    ds_read_b64 v[126:127], v32 offset:2056
    s_waitcnt lgkmcnt(6)
    ds_read_b64 v[128:129], v32 offset:1984
    ds_read_b64 v[130:131], v32 offset:1992
    ds_read_b64 v[132:133], v32 offset:1920
    ds_read_b64 v[134:135], v32 offset:1928
    ds_read_b64 v[136:137], v32 offset:1856
    ds_read_b64 v[138:139], v32 offset:1864
    ds_read_b64 v[140:141], v32 offset:1792
    ds_read_b64 v[142:143], v32 offset:1800
    s_waitcnt lgkmcnt(6)
    v_lshlrev_b32 v100, 7, v0
    buffer_load_dword v101, v100, s[8:11], 0 offen sc1
    ds_read_b64 v[144:145], v32 offset:1728
    ds_read_b64 v[146:147], v32 offset:1736
    ds_read_b64 v[148:149], v32 offset:1664
    ds_read_b64 v[150:151], v32 offset:1672
    ds_read_b64 v[152:153], v32 offset:1600
    ds_read_b64 v[154:155], v32 offset:1608
    ds_read_b64 v[156:157], v32 offset:1536
    ds_read_b64 v[158:159], v32 offset:1544
    s_waitcnt lgkmcnt(6)
    ds_read_b64 v[160:161], v32 offset:1472
    ds_read_b64 v[162:163], v32 offset:1480
    ds_read_b64 v[164:165], v32 offset:1408
    ds_read_b64 v[166:167], v32 offset:1416
    ds_read_b64 v[168:169], v32 offset:1344
    ds_read_b64 v[170:171], v32 offset:1352
    ds_read_b64 v[172:173], v32 offset:1280
    ds_read_b64 v[174:175], v32 offset:1288
    s_waitcnt lgkmcnt(6)
    ds_read_b64 v[176:177], v32 offset:1216
    ds_read_b64 v[178:179], v32 offset:1224
    ds_read_b64 v[180:181], v32 offset:1152
    ds_read_b64 v[182:183], v32 offset:1160
    ds_read_b64 v[184:185], v32 offset:1088
    ds_read_b64 v[186:187], v32 offset:1096
    ds_read_b64 v[188:189], v32 offset:1024
    ds_read_b64 v[190:191], v32 offset:1032
    s_waitcnt lgkmcnt(6)
    ds_read_b64 v[192:193], v32 offset:960
    ds_read_b64 v[194:195], v32 offset:968
    ds_read_b64 v[196:197], v32 offset:896
    ds_read_b64 v[198:199], v32 offset:904
    ds_read_b64 v[200:201], v32 offset:832
    ds_read_b64 v[202:203], v32 offset:840
    ds_read_b64 v[204:205], v32 offset:768
    ds_read_b64 v[206:207], v32 offset:776
    s_waitcnt lgkmcnt(6)
    ds_read_b64 v[208:209], v32 offset:704
    ds_read_b64 v[210:211], v32 offset:712
    ds_read_b64 v[212:213], v32 offset:640
    ds_read_b64 v[214:215], v32 offset:648
    ds_read_b64 v[216:217], v32 offset:576
    ds_read_b64 v[218:219], v32 offset:584
    ds_read_b64 v[220:221], v32 offset:512
    ds_read_b64 v[222:223], v32 offset:520
    s_waitcnt lgkmcnt(6)
    ds_read_b64 v[224:225], v32 offset:448
    ds_read_b64 v[226:227], v32 offset:456
    ds_read_b64 v[228:229], v32 offset:384
    ds_read_b64 v[230:231], v32 offset:392
    ds_read_b64 v[232:233], v32 offset:320
    ds_read_b64 v[234:235], v32 offset:328
    ds_read_b64 v[236:237], v32 offset:256
    ds_read_b64 v[238:239], v32 offset:264
    s_waitcnt lgkmcnt(6)
    ds_read_b64 v[240:241], v32 offset:192
    ds_read_b64 v[242:243], v32 offset:200
    ds_read_b64 v[244:245], v32 offset:128
    ds_read_b64 v[246:247], v32 offset:136
    ds_read_b64 v[248:249], v32 offset:64
    ds_read_b64 v[250:251], v32 offset:72
    ds_read_b64 v[252:253], v32 offset:0
    ds_read_b64 v[254:255], v32 offset:8
    s_waitcnt lgkmcnt(6)
    s_waitcnt lgkmcnt(0)
    s_waitcnt vmcnt(0) lgkmcnt(0)
    v_lshlrev_b32 v2, 7, v0
    s_add_u32 s72, s64, 2
    s_mov_b32 s73, 0
    v_subrev_u32 v3, s72, v101
    v_cmpx_le_u32 vcc, 8, v3
    s_nop 4
    s_cbranch_execz Lgx_24
Lgw_23:
    buffer_load_dword v3, v2, s[8:11], 0 offen sc1
    s_add_u32 s73, s73, 1
    s_cmp_gt_u32 s73, 0x40000
    s_cbranch_scc1 Lgx_24
    s_waitcnt vmcnt(0)
    v_subrev_u32 v3, s72, v3
    v_cmpx_le_u32 vcc, 8, v3
    s_nop 4
    s_cbranch_execz Lgx_24
    s_branch Lgw_23
Lgx_24:
    s_waitcnt vmcnt(0)
    s_mov_b64 exec, -1
    s_barrier
    buffer_load_dwordx4 v[80:83], v8, s[8:11], s37 offen sc1
    buffer_load_dwordx4 v[64:67], v8, s[8:11], s36 offen sc1
    buffer_load_dwordx4 v[84:87], v10, s[8:11], s37 offen sc1
    buffer_load_dwordx4 v[68:71], v10, s[8:11], s36 offen sc1
    buffer_load_dwordx4 v[88:91], v9, s[8:11], s37 offen sc1
    buffer_load_dwordx4 v[72:75], v9, s[8:11], s36 offen sc1
    buffer_load_dwordx4 v[92:95], v11, s[8:11], s37 offen sc1
    buffer_load_dwordx4 v[76:79], v11, s[8:11], s36 offen sc1
    v_lshlrev_b32 v3, 7, v1
    s_mul_i32 s38, s7, 98304
    s_mul_i32 s74, s3, 24576
    s_add_u32 s38, s38, s74
    s_add_u32 s38, s38, 1048576
    buffer_load_dword v5, v3, s[8:11], s38 offen sc1
    s_add_u32 s38, s38, 8192
    buffer_load_dword v5, v3, s[8:11], s38 offen sc1
    s_add_u32 s38, s38, 8192
    buffer_load_dword v5, v3, s[8:11], s38 offen sc1
    s_waitcnt vmcnt(10)
    v_mul_f32 v80, 0x3b000000, v80
    v_mul_f32 v81, 0x3b000000, v81
    v_mul_f32 v82, 0x3b000000, v82
    v_mul_f32 v83, 0x3b000000, v83
    v_fma_f32 v81, -v80, v80, v81
    v_fma_f32 v83, -v82, v82, v83
    v_add_f32 v81, 0x3727c5ac, v81
    v_add_f32 v83, 0x3727c5ac, v83
    v_rsq_f32 v44, v81
    v_rsq_f32 v46, v83
    s_waitcnt vmcnt(9)
    v_lshlrev_b32 v16, 16, v64
    v_and_b32 v17, s44, v64
    v_lshlrev_b32 v18, 16, v65
    v_and_b32 v19, s44, v65
    v_lshlrev_b32 v20, 16, v66
    v_and_b32 v21, s44, v66
    v_lshlrev_b32 v22, 16, v67
    v_and_b32 v23, s44, v67
    v_mul_f32 v45, v80, v44
    v_mul_f32 v47, v82, v46
    v_pk_fma_f32 v[56:57], v[16:17], v[44:45], v[44:45] op_sel:[0,0,1] op_sel_hi:[1,0,1] neg_lo:[0,0,1] neg_hi:[0,0,1]
    v_pk_fma_f32 v[58:59], v[18:19], v[44:45], v[44:45] op_sel:[0,0,1] op_sel_hi:[1,0,1] neg_lo:[0,0,1] neg_hi:[0,0,1]
    v_pk_fma_f32 v[60:61], v[20:21], v[46:47], v[46:47] op_sel:[0,0,1] op_sel_hi:[1,0,1] neg_lo:[0,0,1] neg_hi:[0,0,1]
    v_pk_fma_f32 v[62:63], v[22:23], v[46:47], v[46:47] op_sel:[0,0,1] op_sel_hi:[1,0,1] neg_lo:[0,0,1] neg_hi:[0,0,1]
    v_cvt_pk_bf16_f32 v32, v56, v60
    v_cvt_pk_bf16_f32 v33, v57, v61
    v_cvt_pk_bf16_f32 v34, v58, v62
    v_cvt_pk_bf16_f32 v35, v59, v63
    ds_write_b32 v12, v32 offset:0
    ds_write_b32 v12, v33 offset:4608
    ds_write_b32 v12, v34 offset:9216
    ds_write_b32 v12, v35 offset:13824
    s_waitcnt vmcnt(8)
    v_mul_f32 v84, 0x3b000000, v84
    v_mul_f32 v85, 0x3b000000, v85
    v_mul_f32 v86, 0x3b000000, v86
    v_mul_f32 v87, 0x3b000000, v87
    v_fma_f32 v85, -v84, v84, v85
    v_fma_f32 v87, -v86, v86, v87
    v_add_f32 v85, 0x3727c5ac, v85
    v_add_f32 v87, 0x3727c5ac, v87
    v_rsq_f32 v44, v85
    v_rsq_f32 v46, v87
    s_waitcnt vmcnt(7)
    v_lshlrev_b32 v24, 16, v68
    v_and_b32 v25, s44, v68
    v_lshlrev_b32 v26, 16, v69
    v_and_b32 v27, s44, v69
    v_lshlrev_b32 v28, 16, v70
    v_and_b32 v29, s44, v70
    v_lshlrev_b32 v30, 16, v71
    v_and_b32 v31, s44, v71
    v_mul_f32 v45, v84, v44
    v_mul_f32 v47, v86, v46
    v_pk_fma_f32 v[56:57], v[24:25], v[44:45], v[44:45] op_sel:[0,0,1] op_sel_hi:[1,0,1] neg_lo:[0,0,1] neg_hi:[0,0,1]
    v_pk_fma_f32 v[58:59], v[26:27], v[44:45], v[44:45] op_sel:[0,0,1] op_sel_hi:[1,0,1] neg_lo:[0,0,1] neg_hi:[0,0,1]
    v_pk_fma_f32 v[60:61], v[28:29], v[46:47], v[46:47] op_sel:[0,0,1] op_sel_hi:[1,0,1] neg_lo:[0,0,1] neg_hi:[0,0,1]
    v_pk_fma_f32 v[62:63], v[30:31], v[46:47], v[46:47] op_sel:[0,0,1] op_sel_hi:[1,0,1] neg_lo:[0,0,1] neg_hi:[0,0,1]
    v_cvt_pk_bf16_f32 v36, v56, v60
    v_cvt_pk_bf16_f32 v37, v57, v61
    v_cvt_pk_bf16_f32 v38, v58, v62
    v_cvt_pk_bf16_f32 v39, v59, v63
    ds_write_b32 v12, v36 offset:2048
    ds_write_b32 v12, v37 offset:6656
    ds_write_b32 v12, v38 offset:11264
    ds_write_b32 v12, v39 offset:15872
    s_waitcnt vmcnt(6)
    v_mul_f32 v88, 0x3b000000, v88
    v_mul_f32 v89, 0x3b000000, v89
    v_mul_f32 v90, 0x3b000000, v90
    v_mul_f32 v91, 0x3b000000, v91
    v_fma_f32 v89, -v88, v88, v89
    v_fma_f32 v91, -v90, v90, v91
    v_add_f32 v89, 0x3727c5ac, v89
    v_add_f32 v91, 0x3727c5ac, v91
    v_rsq_f32 v44, v89
    v_rsq_f32 v46, v91
    s_waitcnt vmcnt(5)
    v_lshlrev_b32 v48, 16, v72
    v_and_b32 v49, s44, v72
    v_lshlrev_b32 v50, 16, v73
    v_and_b32 v51, s44, v73
    v_lshlrev_b32 v52, 16, v74
    v_and_b32 v53, s44, v74
    v_lshlrev_b32 v54, 16, v75
    v_and_b32 v55, s44, v75
    v_mul_f32 v45, v88, v44
    v_mul_f32 v47, v90, v46
    v_pk_fma_f32 v[56:57], v[48:49], v[44:45], v[44:45] op_sel:[0,0,1] op_sel_hi:[1,0,1] neg_lo:[0,0,1] neg_hi:[0,0,1]
    v_pk_fma_f32 v[58:59], v[50:51], v[44:45], v[44:45] op_sel:[0,0,1] op_sel_hi:[1,0,1] neg_lo:[0,0,1] neg_hi:[0,0,1]
    v_pk_fma_f32 v[60:61], v[52:53], v[46:47], v[46:47] op_sel:[0,0,1] op_sel_hi:[1,0,1] neg_lo:[0,0,1] neg_hi:[0,0,1]
    v_pk_fma_f32 v[62:63], v[54:55], v[46:47], v[46:47] op_sel:[0,0,1] op_sel_hi:[1,0,1] neg_lo:[0,0,1] neg_hi:[0,0,1]
    v_cvt_pk_bf16_f32 v40, v56, v60
    v_cvt_pk_bf16_f32 v41, v57, v61
    v_cvt_pk_bf16_f32 v42, v58, v62
    v_cvt_pk_bf16_f32 v43, v59, v63
    ds_write_b32 v13, v40 offset:0
    ds_write_b32 v13, v41 offset:4608
    ds_write_b32 v13, v42 offset:9216
    ds_write_b32 v13, v43 offset:13824
    s_waitcnt vmcnt(4)
    v_mul_f32 v92, 0x3b000000, v92
    v_mul_f32 v93, 0x3b000000, v93
    v_mul_f32 v94, 0x3b000000, v94
    v_mul_f32 v95, 0x3b000000, v95
    v_fma_f32 v93, -v92, v92, v93
    v_fma_f32 v95, -v94, v94, v95
    v_add_f32 v93, 0x3727c5ac, v93
    v_add_f32 v95, 0x3727c5ac, v95
    v_rsq_f32 v44, v93
    v_rsq_f32 v46, v95
    s_waitcnt vmcnt(3)
    v_lshlrev_b32 v48, 16, v76
    v_and_b32 v49, s44, v76
    v_lshlrev_b32 v50, 16, v77
    v_and_b32 v51, s44, v77
    v_lshlrev_b32 v52, 16, v78
    v_and_b32 v53, s44, v78
    v_lshlrev_b32 v54, 16, v79
    v_and_b32 v55, s44, v79
    v_mul_f32 v45, v92, v44
    v_mul_f32 v47, v94, v46
    v_pk_fma_f32 v[56:57], v[48:49], v[44:45], v[44:45] op_sel:[0,0,1] op_sel_hi:[1,0,1] neg_lo:[0,0,1] neg_hi:[0,0,1]
    v_pk_fma_f32 v[58:59], v[50:51], v[44:45], v[44:45] op_sel:[0,0,1] op_sel_hi:[1,0,1] neg_lo:[0,0,1] neg_hi:[0,0,1]
    v_pk_fma_f32 v[60:61], v[52:53], v[46:47], v[46:47] op_sel:[0,0,1] op_sel_hi:[1,0,1] neg_lo:[0,0,1] neg_hi:[0,0,1]
    v_pk_fma_f32 v[62:63], v[54:55], v[46:47], v[46:47] op_sel:[0,0,1] op_sel_hi:[1,0,1] neg_lo:[0,0,1] neg_hi:[0,0,1]
    v_cvt_pk_bf16_f32 v40, v56, v60
    v_cvt_pk_bf16_f32 v41, v57, v61
    v_cvt_pk_bf16_f32 v42, v58, v62
    v_cvt_pk_bf16_f32 v43, v59, v63
    ds_write_b32 v13, v40 offset:2048
    ds_write_b32 v13, v41 offset:6656
    ds_write_b32 v13, v42 offset:11264
    ds_write_b32 v13, v43 offset:15872
    s_waitcnt lgkmcnt(0)
    s_barrier
    s_lshl_b32 s36, s69, 14
    s_add_u32 s36, s36, 14680064
    s_add_u32 s37, s36, 8192
    s_cmp_eq_u32 s96, 0
    s_cbranch_scc0 LhsB_25
    ds_read_b128 v[64:67], v4 offset:448
    ds_read_b128 v[68:71], v4 offset:960
    ds_read_b128 v[72:75], v4 offset:1472
    ds_read_b128 v[76:79], v4 offset:1984
    ds_read_b128 v[80:83], v4 offset:2496
    ds_read_b128 v[84:87], v4 offset:3008
    ds_read_b128 v[88:91], v4 offset:3520
    ds_read_b128 v[92:95], v4 offset:4032
    s_waitcnt lgkmcnt(7)
    v_mfma_f32_16x16x32_bf16 v[96:99], a[128:131], v[64:67], 0
    v_mfma_f32_16x16x32_bf16 v[100:103], a[224:227], v[64:67], 0
    v_mfma_f32_16x16x32_bf16 v[104:107], v[128:131], v[64:67], 0
    v_mfma_f32_16x16x32_bf16 v[108:111], v[224:227], v[64:67], 0
    ds_read_b128 v[64:67], v4 offset:384
    s_waitcnt lgkmcnt(7)
    v_mfma_f32_16x16x32_bf16 v[100:103], a[192:195], v[68:71], v[100:103]
    v_mfma_f32_16x16x32_bf16 v[104:107], a[224:227], v[68:71], v[104:107]
    v_mfma_f32_16x16x32_bf16 v[108:111], v[192:195], v[68:71], v[108:111]
    ds_read_b128 v[68:71], v4 offset:896
    s_waitcnt lgkmcnt(7)
    v_mfma_f32_16x16x32_bf16 v[100:103], a[160:163], v[72:75], v[100:103]
    v_mfma_f32_16x16x32_bf16 v[104:107], a[192:195], v[72:75], v[104:107]
    v_mfma_f32_16x16x32_bf16 v[108:111], v[160:163], v[72:75], v[108:111]
    ds_read_b128 v[72:75], v4 offset:1408
    s_waitcnt lgkmcnt(7)
    v_mfma_f32_16x16x32_bf16 v[100:103], a[128:131], v[76:79], v[100:103]
    v_mfma_f32_16x16x32_bf16 v[104:107], a[160:163], v[76:79], v[104:107]
    v_mfma_f32_16x16x32_bf16 v[108:111], v[128:131], v[76:79], v[108:111]
    ds_read_b128 v[76:79], v4 offset:1920
    s_waitcnt lgkmcnt(7)
    v_mfma_f32_16x16x32_bf16 v[104:107], a[128:131], v[80:83], v[104:107]
    v_mfma_f32_16x16x32_bf16 v[108:111], a[224:227], v[80:83], v[108:111]
    ds_read_b128 v[80:83], v4 offset:2432
    s_waitcnt lgkmcnt(7)
    v_mfma_f32_16x16x32_bf16 v[108:111], a[192:195], v[84:87], v[108:111]
    ds_read_b128 v[84:87], v4 offset:2944
    s_waitcnt lgkmcnt(7)
    v_mfma_f32_16x16x32_bf16 v[108:111], a[160:163], v[88:91], v[108:111]
    ds_read_b128 v[88:91], v4 offset:3456
    s_waitcnt lgkmcnt(7)
    v_mfma_f32_16x16x32_bf16 v[108:111], a[128:131], v[92:95], v[108:111]
    ds_read_b128 v[92:95], v4 offset:3968
    s_waitcnt lgkmcnt(7)
    v_mfma_f32_16x16x32_bf16 v[96:99], a[132:135], v[64:67], v[96:99]
    v_mfma_f32_16x16x32_bf16 v[100:103], a[228:231], v[64:67], v[100:103]
    v_mfma_f32_16x16x32_bf16 v[104:107], v[132:135], v[64:67], v[104:107]
    v_mfma_f32_16x16x32_bf16 v[108:111], v[228:231], v[64:67], v[108:111]
    ds_read_b128 v[64:67], v4 offset:320
    s_waitcnt lgkmcnt(7)
    v_mfma_f32_16x16x32_bf16 v[100:103], a[196:199], v[68:71], v[100:103]
    v_mfma_f32_16x16x32_bf16 v[104:107], a[228:231], v[68:71], v[104:107]
    v_mfma_f32_16x16x32_bf16 v[108:111], v[196:199], v[68:71], v[108:111]
    ds_read_b128 v[68:71], v4 offset:832
    s_waitcnt lgkmcnt(7)
    v_mfma_f32_16x16x32_bf16 v[100:103], a[164:167], v[72:75], v[100:103]
    v_mfma_f32_16x16x32_bf16 v[104:107], a[196:199], v[72:75], v[104:107]
    v_mfma_f32_16x16x32_bf16 v[108:111], v[164:167], v[72:75], v[108:111]
    ds_read_b128 v[72:75], v4 offset:1344
    s_waitcnt lgkmcnt(7)
    v_mfma_f32_16x16x32_bf16 v[100:103], a[132:135], v[76:79], v[100:103]
    v_mfma_f32_16x16x32_bf16 v[104:107], a[164:167], v[76:79], v[104:107]
    v_mfma_f32_16x16x32_bf16 v[108:111], v[132:135], v[76:79], v[108:111]
    ds_read_b128 v[76:79], v4 offset:1856
    s_waitcnt lgkmcnt(7)
    v_mfma_f32_16x16x32_bf16 v[104:107], a[132:135], v[80:83], v[104:107]
    v_mfma_f32_16x16x32_bf16 v[108:111], a[228:231], v[80:83], v[108:111]
    ds_read_b128 v[80:83], v4 offset:2368
    s_waitcnt lgkmcnt(7)
    v_mfma_f32_16x16x32_bf16 v[108:111], a[196:199], v[84:87], v[108:111]
    ds_read_b128 v[84:87], v4 offset:2880
    s_waitcnt lgkmcnt(7)
    v_mfma_f32_16x16x32_bf16 v[108:111], a[164:167], v[88:91], v[108:111]
    ds_read_b128 v[88:91], v4 offset:3392
    s_waitcnt lgkmcnt(7)
    v_mfma_f32_16x16x32_bf16 v[108:111], a[132:135], v[92:95], v[108:111]
    ds_read_b128 v[92:95], v4 offset:3904
    s_waitcnt lgkmcnt(7)
    v_mfma_f32_16x16x32_bf16 v[96:99], a[136:139], v[64:67], v[96:99]
    v_mfma_f32_16x16x32_bf16 v[100:103], a[232:235], v[64:67], v[100:103]
    v_mfma_f32_16x16x32_bf16 v[104:107], v[136:139], v[64:67], v[104:107]
    v_mfma_f32_16x16x32_bf16 v[108:111], v[232:235], v[64:67], v[108:111]
    ds_read_b128 v[64:67], v4 offset:256
    s_waitcnt lgkmcnt(7)
    v_mfma_f32_16x16x32_bf16 v[100:103], a[200:203], v[68:71], v[100:103]
    v_mfma_f32_16x16x32_bf16 v[104:107], a[232:235], v[68:71], v[104:107]
    v_mfma_f32_16x16x32_bf16 v[108:111], v[200:203], v[68:71], v[108:111]
    ds_read_b128 v[68:71], v4 offset:768
    s_waitcnt lgkmcnt(7)
    v_mfma_f32_16x16x32_bf16 v[100:103], a[168:171], v[72:75], v[100:103]
    v_mfma_f32_16x16x32_bf16 v[104:107], a[200:203], v[72:75], v[104:107]
    v_mfma_f32_16x16x32_bf16 v[108:111], v[168:171], v[72:75], v[108:111]
    ds_read_b128 v[72:75], v4 offset:1280
    s_waitcnt lgkmcnt(7)
    v_mfma_f32_16x16x32_bf16 v[100:103], a[136:139], v[76:79], v[100:103]
    v_mfma_f32_16x16x32_bf16 v[104:107], a[168:171], v[76:79], v[104:107]
    v_mfma_f32_16x16x32_bf16 v[108:111], v[136:139], v[76:79], v[108:111]
    ds_read_b128 v[76:79], v4 offset:1792
    s_waitcnt lgkmcnt(7)
    v_mfma_f32_16x16x32_bf16 v[104:107], a[136:139], v[80:83], v[104:107]
    v_mfma_f32_16x16x32_bf16 v[108:111], a[232:235], v[80:83], v[108:111]
    ds_read_b128 v[80:83], v4 offset:2304
    s_waitcnt lgkmcnt(7)
    v_mfma_f32_16x16x32_bf16 v[108:111], a[200:203], v[84:87], v[108:111]
    ds_read_b128 v[84:87], v4 offset:2816
    s_waitcnt lgkmcnt(7)
    v_mfma_f32_16x16x32_bf16 v[108:111], a[168:171], v[88:91], v[108:111]
    ds_read_b128 v[88:91], v4 offset:3328
    s_waitcnt lgkmcnt(7)
    v_mfma_f32_16x16x32_bf16 v[108:111], a[136:139], v[92:95], v[108:111]
    ds_read_b128 v[92:95], v4 offset:3840
    s_waitcnt lgkmcnt(7)
    v_mfma_f32_16x16x32_bf16 v[96:99], a[140:143], v[64:67], v[96:99]
    v_mfma_f32_16x16x32_bf16 v[100:103], a[236:239], v[64:67], v[100:103]
    v_mfma_f32_16x16x32_bf16 v[104:107], v[140:143], v[64:67], v[104:107]
    v_mfma_f32_16x16x32_bf16 v[108:111], v[236:239], v[64:67], v[108:111]
    ds_read_b128 v[64:67], v4 offset:192
    s_waitcnt lgkmcnt(7)
    v_mfma_f32_16x16x32_bf16 v[100:103], a[204:207], v[68:71], v[100:103]
    v_mfma_f32_16x16x32_bf16 v[104:107], a[236:239], v[68:71], v[104:107]
    v_mfma_f32_16x16x32_bf16 v[108:111], v[204:207], v[68:71], v[108:111]
    ds_read_b128 v[68:71], v4 offset:704
    s_waitcnt lgkmcnt(7)
    v_mfma_f32_16x16x32_bf16 v[100:103], a[172:175], v[72:75], v[100:103]
    v_mfma_f32_16x16x32_bf16 v[104:107], a[204:207], v[72:75], v[104:107]
    v_mfma_f32_16x16x32_bf16 v[108:111], v[172:175], v[72:75], v[108:111]
    ds_read_b128 v[72:75], v4 offset:1216
    s_waitcnt lgkmcnt(7)
    v_mfma_f32_16x16x32_bf16 v[100:103], a[140:143], v[76:79], v[100:103]
    v_mfma_f32_16x16x32_bf16 v[104:107], a[172:175], v[76:79], v[104:107]
    v_mfma_f32_16x16x32_bf16 v[108:111], v[140:143], v[76:79], v[108:111]
    ds_read_b128 v[76:79], v4 offset:1728
    s_waitcnt lgkmcnt(7)
    v_mfma_f32_16x16x32_bf16 v[104:107], a[140:143], v[80:83], v[104:107]
    v_mfma_f32_16x16x32_bf16 v[108:111], a[236:239], v[80:83], v[108:111]
    ds_read_b128 v[80:83], v4 offset:2240
    s_waitcnt lgkmcnt(7)
    v_mfma_f32_16x16x32_bf16 v[108:111], a[204:207], v[84:87], v[108:111]
    ds_read_b128 v[84:87], v4 offset:2752
    s_waitcnt lgkmcnt(7)
    v_mfma_f32_16x16x32_bf16 v[108:111], a[172:175], v[88:91], v[108:111]
    ds_read_b128 v[88:91], v4 offset:3264
    s_waitcnt lgkmcnt(7)
    v_mfma_f32_16x16x32_bf16 v[108:111], a[140:143], v[92:95], v[108:111]
    ds_read_b128 v[92:95], v4 offset:3776
    s_waitcnt lgkmcnt(7)
    v_mfma_f32_16x16x32_bf16 v[96:99], a[144:147], v[64:67], v[96:99]
    v_mfma_f32_16x16x32_bf16 v[100:103], v[112:115], v[64:67], v[100:103]
    v_mfma_f32_16x16x32_bf16 v[104:107], v[144:147], v[64:67], v[104:107]
    v_mfma_f32_16x16x32_bf16 v[108:111], v[240:243], v[64:67], v[108:111]
    ds_read_b128 v[64:67], v4 offset:128
    s_waitcnt lgkmcnt(7)
    v_mfma_f32_16x16x32_bf16 v[100:103], a[208:211], v[68:71], v[100:103]
    v_mfma_f32_16x16x32_bf16 v[104:107], v[112:115], v[68:71], v[104:107]
    v_mfma_f32_16x16x32_bf16 v[108:111], v[208:211], v[68:71], v[108:111]
    ds_read_b128 v[68:71], v4 offset:640
    s_waitcnt lgkmcnt(7)
    v_mfma_f32_16x16x32_bf16 v[100:103], a[176:179], v[72:75], v[100:103]
    v_mfma_f32_16x16x32_bf16 v[104:107], a[208:211], v[72:75], v[104:107]
    v_mfma_f32_16x16x32_bf16 v[108:111], v[176:179], v[72:75], v[108:111]
    ds_read_b128 v[72:75], v4 offset:1152
    s_waitcnt lgkmcnt(7)
    v_mfma_f32_16x16x32_bf16 v[100:103], a[144:147], v[76:79], v[100:103]
    v_mfma_f32_16x16x32_bf16 v[104:107], a[176:179], v[76:79], v[104:107]
    v_mfma_f32_16x16x32_bf16 v[108:111], v[144:147], v[76:79], v[108:111]
    ds_read_b128 v[76:79], v4 offset:1664
    s_waitcnt lgkmcnt(7)
    v_mfma_f32_16x16x32_bf16 v[104:107], a[144:147], v[80:83], v[104:107]
    v_mfma_f32_16x16x32_bf16 v[108:111], v[112:115], v[80:83], v[108:111]
    ds_read_b128 v[80:83], v4 offset:2176
    s_waitcnt lgkmcnt(7)
    v_mfma_f32_16x16x32_bf16 v[108:111], a[208:211], v[84:87], v[108:111]
    ds_read_b128 v[84:87], v4 offset:2688
    s_waitcnt lgkmcnt(7)
    v_mfma_f32_16x16x32_bf16 v[108:111], a[176:179], v[88:91], v[108:111]
    ds_read_b128 v[88:91], v4 offset:3200
    s_waitcnt lgkmcnt(7)
    v_mfma_f32_16x16x32_bf16 v[108:111], a[144:147], v[92:95], v[108:111]
    ds_read_b128 v[92:95], v4 offset:3712
    s_waitcnt lgkmcnt(7)
    v_mfma_f32_16x16x32_bf16 v[96:99], a[148:151], v[64:67], v[96:99]
    v_mfma_f32_16x16x32_bf16 v[100:103], v[116:119], v[64:67], v[100:103]
    v_mfma_f32_16x16x32_bf16 v[104:107], v[148:151], v[64:67], v[104:107]
    v_mfma_f32_16x16x32_bf16 v[108:111], v[244:247], v[64:67], v[108:111]
    ds_read_b128 v[64:67], v4 offset:64
    s_waitcnt lgkmcnt(7)
    v_mfma_f32_16x16x32_bf16 v[100:103], a[212:215], v[68:71], v[100:103]
    v_mfma_f32_16x16x32_bf16 v[104:107], v[116:119], v[68:71], v[104:107]
    v_mfma_f32_16x16x32_bf16 v[108:111], v[212:215], v[68:71], v[108:111]
    ds_read_b128 v[68:71], v4 offset:576
    s_waitcnt lgkmcnt(7)
    v_mfma_f32_16x16x32_bf16 v[100:103], a[180:183], v[72:75], v[100:103]
    v_mfma_f32_16x16x32_bf16 v[104:107], a[212:215], v[72:75], v[104:107]
    v_mfma_f32_16x16x32_bf16 v[108:111], v[180:183], v[72:75], v[108:111]
    ds_read_b128 v[72:75], v4 offset:1088
    s_waitcnt lgkmcnt(7)
    v_mfma_f32_16x16x32_bf16 v[100:103], a[148:151], v[76:79], v[100:103]
    v_mfma_f32_16x16x32_bf16 v[104:107], a[180:183], v[76:79], v[104:107]
    v_mfma_f32_16x16x32_bf16 v[108:111], v[148:151], v[76:79], v[108:111]
    ds_read_b128 v[76:79], v4 offset:1600
    s_waitcnt lgkmcnt(7)
    v_mfma_f32_16x16x32_bf16 v[104:107], a[148:151], v[80:83], v[104:107]
    v_mfma_f32_16x16x32_bf16 v[108:111], v[116:119], v[80:83], v[108:111]
    ds_read_b128 v[80:83], v4 offset:2112
    s_waitcnt lgkmcnt(7)
    v_mfma_f32_16x16x32_bf16 v[108:111], a[212:215], v[84:87], v[108:111]
    ds_read_b128 v[84:87], v4 offset:2624
    s_waitcnt lgkmcnt(7)
    v_mfma_f32_16x16x32_bf16 v[108:111], a[180:183], v[88:91], v[108:111]
    ds_read_b128 v[88:91], v4 offset:3136
    s_waitcnt lgkmcnt(7)
    v_mfma_f32_16x16x32_bf16 v[108:111], a[148:151], v[92:95], v[108:111]
    ds_read_b128 v[92:95], v4 offset:3648
    s_waitcnt lgkmcnt(7)
    v_mfma_f32_16x16x32_bf16 v[96:99], a[152:155], v[64:67], v[96:99]
    v_mfma_f32_16x16x32_bf16 v[100:103], v[120:123], v[64:67], v[100:103]
    v_mfma_f32_16x16x32_bf16 v[104:107], v[152:155], v[64:67], v[104:107]
    v_mfma_f32_16x16x32_bf16 v[108:111], v[248:251], v[64:67], v[108:111]
    ds_read_b128 v[64:67], v4 offset:0
    s_waitcnt lgkmcnt(7)
    v_mfma_f32_16x16x32_bf16 v[100:103], a[216:219], v[68:71], v[100:103]
    v_mfma_f32_16x16x32_bf16 v[104:107], v[120:123], v[68:71], v[104:107]
    v_mfma_f32_16x16x32_bf16 v[108:111], v[216:219], v[68:71], v[108:111]
    ds_read_b128 v[68:71], v4 offset:512
    s_waitcnt lgkmcnt(7)
    v_mfma_f32_16x16x32_bf16 v[100:103], a[184:187], v[72:75], v[100:103]
    v_mfma_f32_16x16x32_bf16 v[104:107], a[216:219], v[72:75], v[104:107]
    v_mfma_f32_16x16x32_bf16 v[108:111], v[184:187], v[72:75], v[108:111]
    ds_read_b128 v[72:75], v4 offset:1024
    s_waitcnt lgkmcnt(7)
    v_mfma_f32_16x16x32_bf16 v[100:103], a[152:155], v[76:79], v[100:103]
    v_mfma_f32_16x16x32_bf16 v[104:107], a[184:187], v[76:79], v[104:107]
    v_mfma_f32_16x16x32_bf16 v[108:111], v[152:155], v[76:79], v[108:111]
    ds_read_b128 v[76:79], v4 offset:1536
    s_waitcnt lgkmcnt(7)
    v_mfma_f32_16x16x32_bf16 v[104:107], a[152:155], v[80:83], v[104:107]
    v_mfma_f32_16x16x32_bf16 v[108:111], v[120:123], v[80:83], v[108:111]
    ds_read_b128 v[80:83], v4 offset:2048
    s_waitcnt lgkmcnt(7)
    v_mfma_f32_16x16x32_bf16 v[108:111], a[216:219], v[84:87], v[108:111]
    ds_read_b128 v[84:87], v4 offset:2560
    s_waitcnt lgkmcnt(7)
    v_mfma_f32_16x16x32_bf16 v[108:111], a[184:187], v[88:91], v[108:111]
    ds_read_b128 v[88:91], v4 offset:3072
    s_waitcnt lgkmcnt(7)
    v_mfma_f32_16x16x32_bf16 v[108:111], a[152:155], v[92:95], v[108:111]
    ds_read_b128 v[92:95], v4 offset:3584
    s_waitcnt lgkmcnt(7)
    v_mfma_f32_16x16x32_bf16 v[96:99], a[156:159], v[64:67], v[96:99]
    v_mfma_f32_16x16x32_bf16 v[100:103], v[124:127], v[64:67], v[100:103]
    v_mfma_f32_16x16x32_bf16 v[104:107], v[156:159], v[64:67], v[104:107]
    v_mfma_f32_16x16x32_bf16 v[108:111], v[252:255], v[64:67], v[108:111]
    s_waitcnt lgkmcnt(6)
    v_mfma_f32_16x16x32_bf16 v[100:103], a[220:223], v[68:71], v[100:103]
    v_mfma_f32_16x16x32_bf16 v[104:107], v[124:127], v[68:71], v[104:107]
    v_mfma_f32_16x16x32_bf16 v[108:111], v[220:223], v[68:71], v[108:111]
    s_waitcnt lgkmcnt(5)
    v_mfma_f32_16x16x32_bf16 v[100:103], a[188:191], v[72:75], v[100:103]
    v_mfma_f32_16x16x32_bf16 v[104:107], a[220:223], v[72:75], v[104:107]
    v_mfma_f32_16x16x32_bf16 v[108:111], v[188:191], v[72:75], v[108:111]
    s_waitcnt lgkmcnt(4)
    v_mfma_f32_16x16x32_bf16 v[100:103], a[156:159], v[76:79], v[100:103]
    v_mfma_f32_16x16x32_bf16 v[104:107], a[188:191], v[76:79], v[104:107]
    v_mfma_f32_16x16x32_bf16 v[108:111], v[156:159], v[76:79], v[108:111]
    s_waitcnt lgkmcnt(3)
    v_mfma_f32_16x16x32_bf16 v[104:107], a[156:159], v[80:83], v[104:107]
    v_mfma_f32_16x16x32_bf16 v[108:111], v[124:127], v[80:83], v[108:111]
    s_waitcnt lgkmcnt(2)
    v_mfma_f32_16x16x32_bf16 v[108:111], a[220:223], v[84:87], v[108:111]
    s_waitcnt lgkmcnt(1)
    v_mfma_f32_16x16x32_bf16 v[108:111], a[188:191], v[88:91], v[108:111]
    s_waitcnt lgkmcnt(0)
    v_mfma_f32_16x16x32_bf16 v[108:111], a[156:159], v[92:95], v[108:111]
    s_branch LhsE_26
LhsB_25:
    ds_read_b128 v[64:67], v4 offset:448
    ds_read_b128 v[68:71], v4 offset:960
    ds_read_b128 v[72:75], v4 offset:1472
    ds_read_b128 v[76:79], v4 offset:1984
    ds_read_b128 v[80:83], v4 offset:2496
    ds_read_b128 v[84:87], v4 offset:3008
    ds_read_b128 v[88:91], v4 offset:3520
    s_waitcnt lgkmcnt(6)
    v_mfma_f32_16x16x32_bf16 v[96:99], a[160:163], v[64:67], 0
    v_mfma_f32_16x16x32_bf16 v[100:103], a[192:195], v[64:67], 0
    v_mfma_f32_16x16x32_bf16 v[104:107], v[160:163], v[64:67], 0
    v_mfma_f32_16x16x32_bf16 v[108:111], v[192:195], v[64:67], 0
    ds_read_b128 v[64:67], v4 offset:384
    s_waitcnt lgkmcnt(6)
    v_mfma_f32_16x16x32_bf16 v[96:99], a[128:131], v[68:71], v[96:99]
    v_mfma_f32_16x16x32_bf16 v[100:103], a[160:163], v[68:71], v[100:103]
    v_mfma_f32_16x16x32_bf16 v[104:107], v[128:131], v[68:71], v[104:107]
    v_mfma_f32_16x16x32_bf16 v[108:111], v[160:163], v[68:71], v[108:111]
    ds_read_b128 v[68:71], v4 offset:896
    s_waitcnt lgkmcnt(6)
    v_mfma_f32_16x16x32_bf16 v[100:103], a[128:131], v[72:75], v[100:103]
    v_mfma_f32_16x16x32_bf16 v[104:107], a[224:227], v[72:75], v[104:107]
    v_mfma_f32_16x16x32_bf16 v[108:111], v[128:131], v[72:75], v[108:111]
    ds_read_b128 v[72:75], v4 offset:1408
    s_waitcnt lgkmcnt(6)
    v_mfma_f32_16x16x32_bf16 v[104:107], a[192:195], v[76:79], v[104:107]
    v_mfma_f32_16x16x32_bf16 v[108:111], a[224:227], v[76:79], v[108:111]
    ds_read_b128 v[76:79], v4 offset:1920
    s_waitcnt lgkmcnt(6)
    v_mfma_f32_16x16x32_bf16 v[104:107], a[160:163], v[80:83], v[104:107]
    v_mfma_f32_16x16x32_bf16 v[108:111], a[192:195], v[80:83], v[108:111]
    ds_read_b128 v[80:83], v4 offset:2432
    s_waitcnt lgkmcnt(6)
    v_mfma_f32_16x16x32_bf16 v[104:107], a[128:131], v[84:87], v[104:107]
    v_mfma_f32_16x16x32_bf16 v[108:111], a[160:163], v[84:87], v[108:111]
    ds_read_b128 v[84:87], v4 offset:2944
    s_waitcnt lgkmcnt(6)
    v_mfma_f32_16x16x32_bf16 v[108:111], a[128:131], v[88:91], v[108:111]
    ds_read_b128 v[88:91], v4 offset:3456
    s_waitcnt lgkmcnt(6)
    v_mfma_f32_16x16x32_bf16 v[96:99], a[164:167], v[64:67], v[96:99]
    v_mfma_f32_16x16x32_bf16 v[100:103], a[196:199], v[64:67], v[100:103]
    v_mfma_f32_16x16x32_bf16 v[104:107], v[164:167], v[64:67], v[104:107]
    v_mfma_f32_16x16x32_bf16 v[108:111], v[196:199], v[64:67], v[108:111]
    ds_read_b128 v[64:67], v4 offset:320
    s_waitcnt lgkmcnt(6)
    v_mfma_f32_16x16x32_bf16 v[96:99], a[132:135], v[68:71], v[96:99]
    v_mfma_f32_16x16x32_bf16 v[100:103], a[164:167], v[68:71], v[100:103]
    v_mfma_f32_16x16x32_bf16 v[104:107], v[132:135], v[68:71], v[104:107]
    v_mfma_f32_16x16x32_bf16 v[108:111], v[164:167], v[68:71], v[108:111]
    ds_read_b128 v[68:71], v4 offset:832
    s_waitcnt lgkmcnt(6)
    v_mfma_f32_16x16x32_bf16 v[100:103], a[132:135], v[72:75], v[100:103]
    v_mfma_f32_16x16x32_bf16 v[104:107], a[228:231], v[72:75], v[104:107]
    v_mfma_f32_16x16x32_bf16 v[108:111], v[132:135], v[72:75], v[108:111]
    ds_read_b128 v[72:75], v4 offset:1344
    s_waitcnt lgkmcnt(6)
    v_mfma_f32_16x16x32_bf16 v[104:107], a[196:199], v[76:79], v[104:107]
    v_mfma_f32_16x16x32_bf16 v[108:111], a[228:231], v[76:79], v[108:111]
    ds_read_b128 v[76:79], v4 offset:1856
    s_waitcnt lgkmcnt(6)
    v_mfma_f32_16x16x32_bf16 v[104:107], a[164:167], v[80:83], v[104:107]
    v_mfma_f32_16x16x32_bf16 v[108:111], a[196:199], v[80:83], v[108:111]
    ds_read_b128 v[80:83], v4 offset:2368
    s_waitcnt lgkmcnt(6)
    v_mfma_f32_16x16x32_bf16 v[104:107], a[132:135], v[84:87], v[104:107]
    v_mfma_f32_16x16x32_bf16 v[108:111], a[164:167], v[84:87], v[108:111]
    ds_read_b128 v[84:87], v4 offset:2880
    s_waitcnt lgkmcnt(6)
    v_mfma_f32_16x16x32_bf16 v[108:111], a[132:135], v[88:91], v[108:111]
    ds_read_b128 v[88:91], v4 offset:3392
    s_waitcnt lgkmcnt(6)
    v_mfma_f32_16x16x32_bf16 v[96:99], a[168:171], v[64:67], v[96:99]
    v_mfma_f32_16x16x32_bf16 v[100:103], a[200:203], v[64:67], v[100:103]
    v_mfma_f32_16x16x32_bf16 v[104:107], v[168:171], v[64:67], v[104:107]
    v_mfma_f32_16x16x32_bf16 v[108:111], v[200:203], v[64:67], v[108:111]
    ds_read_b128 v[64:67], v4 offset:256
    s_waitcnt lgkmcnt(6)
    v_mfma_f32_16x16x32_bf16 v[96:99], a[136:139], v[68:71], v[96:99]
    v_mfma_f32_16x16x32_bf16 v[100:103], a[168:171], v[68:71], v[100:103]
    v_mfma_f32_16x16x32_bf16 v[104:107], v[136:139], v[68:71], v[104:107]
    v_mfma_f32_16x16x32_bf16 v[108:111], v[168:171], v[68:71], v[108:111]
    ds_read_b128 v[68:71], v4 offset:768
    s_waitcnt lgkmcnt(6)
    v_mfma_f32_16x16x32_bf16 v[100:103], a[136:139], v[72:75], v[100:103]
    v_mfma_f32_16x16x32_bf16 v[104:107], a[232:235], v[72:75], v[104:107]
    v_mfma_f32_16x16x32_bf16 v[108:111], v[136:139], v[72:75], v[108:111]
    ds_read_b128 v[72:75], v4 offset:1280
    s_waitcnt lgkmcnt(6)
    v_mfma_f32_16x16x32_bf16 v[104:107], a[200:203], v[76:79], v[104:107]
    v_mfma_f32_16x16x32_bf16 v[108:111], a[232:235], v[76:79], v[108:111]
    ds_read_b128 v[76:79], v4 offset:1792
    s_waitcnt lgkmcnt(6)
    v_mfma_f32_16x16x32_bf16 v[104:107], a[168:171], v[80:83], v[104:107]
    v_mfma_f32_16x16x32_bf16 v[108:111], a[200:203], v[80:83], v[108:111]
    ds_read_b128 v[80:83], v4 offset:2304
    s_waitcnt lgkmcnt(6)
    v_mfma_f32_16x16x32_bf16 v[104:107], a[136:139], v[84:87], v[104:107]
    v_mfma_f32_16x16x32_bf16 v[108:111], a[168:171], v[84:87], v[108:111]
    ds_read_b128 v[84:87], v4 offset:2816
    s_waitcnt lgkmcnt(6)
    v_mfma_f32_16x16x32_bf16 v[108:111], a[136:139], v[88:91], v[108:111]
    ds_read_b128 v[88:91], v4 offset:3328
    s_waitcnt lgkmcnt(6)
    v_mfma_f32_16x16x32_bf16 v[96:99], a[172:175], v[64:67], v[96:99]
    v_mfma_f32_16x16x32_bf16 v[100:103], a[204:207], v[64:67], v[100:103]
    v_mfma_f32_16x16x32_bf16 v[104:107], v[172:175], v[64:67], v[104:107]
    v_mfma_f32_16x16x32_bf16 v[108:111], v[204:207], v[64:67], v[108:111]
    ds_read_b128 v[64:67], v4 offset:192
    s_waitcnt lgkmcnt(6)
    v_mfma_f32_16x16x32_bf16 v[96:99], a[140:143], v[68:71], v[96:99]
    v_mfma_f32_16x16x32_bf16 v[100:103], a[172:175], v[68:71], v[100:103]
    v_mfma_f32_16x16x32_bf16 v[104:107], v[140:143], v[68:71], v[104:107]
    v_mfma_f32_16x16x32_bf16 v[108:111], v[172:175], v[68:71], v[108:111]
    ds_read_b128 v[68:71], v4 offset:704
    s_waitcnt lgkmcnt(6)
    v_mfma_f32_16x16x32_bf16 v[100:103], a[140:143], v[72:75], v[100:103]
    v_mfma_f32_16x16x32_bf16 v[104:107], a[236:239], v[72:75], v[104:107]
    v_mfma_f32_16x16x32_bf16 v[108:111], v[140:143], v[72:75], v[108:111]
    ds_read_b128 v[72:75], v4 offset:1216
    s_waitcnt lgkmcnt(6)
    v_mfma_f32_16x16x32_bf16 v[104:107], a[204:207], v[76:79], v[104:107]
    v_mfma_f32_16x16x32_bf16 v[108:111], a[236:239], v[76:79], v[108:111]
    ds_read_b128 v[76:79], v4 offset:1728
    s_waitcnt lgkmcnt(6)
    v_mfma_f32_16x16x32_bf16 v[104:107], a[172:175], v[80:83], v[104:107]
    v_mfma_f32_16x16x32_bf16 v[108:111], a[204:207], v[80:83], v[108:111]
    ds_read_b128 v[80:83], v4 offset:2240
    s_waitcnt lgkmcnt(6)
    v_mfma_f32_16x16x32_bf16 v[104:107], a[140:143], v[84:87], v[104:107]
    v_mfma_f32_16x16x32_bf16 v[108:111], a[172:175], v[84:87], v[108:111]
    ds_read_b128 v[84:87], v4 offset:2752
    s_waitcnt lgkmcnt(6)
    v_mfma_f32_16x16x32_bf16 v[108:111], a[140:143], v[88:91], v[108:111]
    ds_read_b128 v[88:91], v4 offset:3264
    s_waitcnt lgkmcnt(6)
    v_mfma_f32_16x16x32_bf16 v[96:99], a[176:179], v[64:67], v[96:99]
    v_mfma_f32_16x16x32_bf16 v[100:103], a[208:211], v[64:67], v[100:103]
    v_mfma_f32_16x16x32_bf16 v[104:107], v[176:179], v[64:67], v[104:107]
    v_mfma_f32_16x16x32_bf16 v[108:111], v[208:211], v[64:67], v[108:111]
    ds_read_b128 v[64:67], v4 offset:128
    s_waitcnt lgkmcnt(6)
    v_mfma_f32_16x16x32_bf16 v[96:99], a[144:147], v[68:71], v[96:99]
    v_mfma_f32_16x16x32_bf16 v[100:103], a[176:179], v[68:71], v[100:103]
    v_mfma_f32_16x16x32_bf16 v[104:107], v[144:147], v[68:71], v[104:107]
    v_mfma_f32_16x16x32_bf16 v[108:111], v[176:179], v[68:71], v[108:111]
    ds_read_b128 v[68:71], v4 offset:640
    s_waitcnt lgkmcnt(6)
    v_mfma_f32_16x16x32_bf16 v[100:103], a[144:147], v[72:75], v[100:103]
    v_mfma_f32_16x16x32_bf16 v[104:107], v[112:115], v[72:75], v[104:107]
    v_mfma_f32_16x16x32_bf16 v[108:111], v[144:147], v[72:75], v[108:111]
    ds_read_b128 v[72:75], v4 offset:1152
    s_waitcnt lgkmcnt(6)
    v_mfma_f32_16x16x32_bf16 v[104:107], a[208:211], v[76:79], v[104:107]
    v_mfma_f32_16x16x32_bf16 v[108:111], v[112:115], v[76:79], v[108:111]
    ds_read_b128 v[76:79], v4 offset:1664
    s_waitcnt lgkmcnt(6)
    v_mfma_f32_16x16x32_bf16 v[104:107], a[176:179], v[80:83], v[104:107]
    v_mfma_f32_16x16x32_bf16 v[108:111], a[208:211], v[80:83], v[108:111]
    ds_read_b128 v[80:83], v4 offset:2176
    s_waitcnt lgkmcnt(6)
    v_mfma_f32_16x16x32_bf16 v[104:107], a[144:147], v[84:87], v[104:107]
    v_mfma_f32_16x16x32_bf16 v[108:111], a[176:179], v[84:87], v[108:111]
    ds_read_b128 v[84:87], v4 offset:2688
    s_waitcnt lgkmcnt(6)
    v_mfma_f32_16x16x32_bf16 v[108:111], a[144:147], v[88:91], v[108:111]
    ds_read_b128 v[88:91], v4 offset:3200
    s_waitcnt lgkmcnt(6)
    v_mfma_f32_16x16x32_bf16 v[96:99], a[180:183], v[64:67], v[96:99]
    v_mfma_f32_16x16x32_bf16 v[100:103], a[212:215], v[64:67], v[100:103]
    v_mfma_f32_16x16x32_bf16 v[104:107], v[180:183], v[64:67], v[104:107]
    v_mfma_f32_16x16x32_bf16 v[108:111], v[212:215], v[64:67], v[108:111]
    ds_read_b128 v[64:67], v4 offset:64
    s_waitcnt lgkmcnt(6)
    v_mfma_f32_16x16x32_bf16 v[96:99], a[148:151], v[68:71], v[96:99]
    v_mfma_f32_16x16x32_bf16 v[100:103], a[180:183], v[68:71], v[100:103]
    v_mfma_f32_16x16x32_bf16 v[104:107], v[148:151], v[68:71], v[104:107]
    v_mfma_f32_16x16x32_bf16 v[108:111], v[180:183], v[68:71], v[108:111]
    ds_read_b128 v[68:71], v4 offset:576
    s_waitcnt lgkmcnt(6)
    v_mfma_f32_16x16x32_bf16 v[100:103], a[148:151], v[72:75], v[100:103]
    v_mfma_f32_16x16x32_bf16 v[104:107], v[116:119], v[72:75], v[104:107]
    v_mfma_f32_16x16x32_bf16 v[108:111], v[148:151], v[72:75], v[108:111]
    ds_read_b128 v[72:75], v4 offset:1088
    s_waitcnt lgkmcnt(6)
    v_mfma_f32_16x16x32_bf16 v[104:107], a[212:215], v[76:79], v[104:107]
    v_mfma_f32_16x16x32_bf16 v[108:111], v[116:119], v[76:79], v[108:111]
    ds_read_b128 v[76:79], v4 offset:1600
    s_waitcnt lgkmcnt(6)
    v_mfma_f32_16x16x32_bf16 v[104:107], a[180:183], v[80:83], v[104:107]
    v_mfma_f32_16x16x32_bf16 v[108:111], a[212:215], v[80:83], v[108:111]
    ds_read_b128 v[80:83], v4 offset:2112
    s_waitcnt lgkmcnt(6)
    v_mfma_f32_16x16x32_bf16 v[104:107], a[148:151], v[84:87], v[104:107]
    v_mfma_f32_16x16x32_bf16 v[108:111], a[180:183], v[84:87], v[108:111]
    ds_read_b128 v[84:87], v4 offset:2624
    s_waitcnt lgkmcnt(6)
    v_mfma_f32_16x16x32_bf16 v[108:111], a[148:151], v[88:91], v[108:111]
    ds_read_b128 v[88:91], v4 offset:3136
    s_waitcnt lgkmcnt(6)
    v_mfma_f32_16x16x32_bf16 v[96:99], a[184:187], v[64:67], v[96:99]
    v_mfma_f32_16x16x32_bf16 v[100:103], a[216:219], v[64:67], v[100:103]
    v_mfma_f32_16x16x32_bf16 v[104:107], v[184:187], v[64:67], v[104:107]
    v_mfma_f32_16x16x32_bf16 v[108:111], v[216:219], v[64:67], v[108:111]
    ds_read_b128 v[64:67], v4 offset:0
    s_waitcnt lgkmcnt(6)
    v_mfma_f32_16x16x32_bf16 v[96:99], a[152:155], v[68:71], v[96:99]
    v_mfma_f32_16x16x32_bf16 v[100:103], a[184:187], v[68:71], v[100:103]
    v_mfma_f32_16x16x32_bf16 v[104:107], v[152:155], v[68:71], v[104:107]
    v_mfma_f32_16x16x32_bf16 v[108:111], v[184:187], v[68:71], v[108:111]
    ds_read_b128 v[68:71], v4 offset:512
    s_waitcnt lgkmcnt(6)
    v_mfma_f32_16x16x32_bf16 v[100:103], a[152:155], v[72:75], v[100:103]
    v_mfma_f32_16x16x32_bf16 v[104:107], v[120:123], v[72:75], v[104:107]
    v_mfma_f32_16x16x32_bf16 v[108:111], v[152:155], v[72:75], v[108:111]
    ds_read_b128 v[72:75], v4 offset:1024
    s_waitcnt lgkmcnt(6)
    v_mfma_f32_16x16x32_bf16 v[104:107], a[216:219], v[76:79], v[104:107]
    v_mfma_f32_16x16x32_bf16 v[108:111], v[120:123], v[76:79], v[108:111]
    ds_read_b128 v[76:79], v4 offset:1536
    s_waitcnt lgkmcnt(6)
    v_mfma_f32_16x16x32_bf16 v[104:107], a[184:187], v[80:83], v[104:107]
    v_mfma_f32_16x16x32_bf16 v[108:111], a[216:219], v[80:83], v[108:111]
    ds_read_b128 v[80:83], v4 offset:2048
    s_waitcnt lgkmcnt(6)
    v_mfma_f32_16x16x32_bf16 v[104:107], a[152:155], v[84:87], v[104:107]
    v_mfma_f32_16x16x32_bf16 v[108:111], a[184:187], v[84:87], v[108:111]
    ds_read_b128 v[84:87], v4 offset:2560
    s_waitcnt lgkmcnt(6)
    v_mfma_f32_16x16x32_bf16 v[108:111], a[152:155], v[88:91], v[108:111]
    ds_read_b128 v[88:91], v4 offset:3072
    s_waitcnt lgkmcnt(6)
    v_mfma_f32_16x16x32_bf16 v[96:99], a[188:191], v[64:67], v[96:99]
    v_mfma_f32_16x16x32_bf16 v[100:103], a[220:223], v[64:67], v[100:103]
    v_mfma_f32_16x16x32_bf16 v[104:107], v[188:191], v[64:67], v[104:107]
    v_mfma_f32_16x16x32_bf16 v[108:111], v[220:223], v[64:67], v[108:111]
    s_waitcnt lgkmcnt(5)
    v_mfma_f32_16x16x32_bf16 v[96:99], a[156:159], v[68:71], v[96:99]
    v_mfma_f32_16x16x32_bf16 v[100:103], a[188:191], v[68:71], v[100:103]
    v_mfma_f32_16x16x32_bf16 v[104:107], v[156:159], v[68:71], v[104:107]
    v_mfma_f32_16x16x32_bf16 v[108:111], v[188:191], v[68:71], v[108:111]
    s_waitcnt lgkmcnt(4)
    v_mfma_f32_16x16x32_bf16 v[100:103], a[156:159], v[72:75], v[100:103]
    v_mfma_f32_16x16x32_bf16 v[104:107], v[124:127], v[72:75], v[104:107]
    v_mfma_f32_16x16x32_bf16 v[108:111], v[156:159], v[72:75], v[108:111]
    s_waitcnt lgkmcnt(3)
    v_mfma_f32_16x16x32_bf16 v[104:107], a[220:223], v[76:79], v[104:107]
    v_mfma_f32_16x16x32_bf16 v[108:111], v[124:127], v[76:79], v[108:111]
    s_waitcnt lgkmcnt(2)
    v_mfma_f32_16x16x32_bf16 v[104:107], a[188:191], v[80:83], v[104:107]
    v_mfma_f32_16x16x32_bf16 v[108:111], a[220:223], v[80:83], v[108:111]
    s_waitcnt lgkmcnt(1)
    v_mfma_f32_16x16x32_bf16 v[104:107], a[156:159], v[84:87], v[104:107]
    v_mfma_f32_16x16x32_bf16 v[108:111], a[188:191], v[84:87], v[108:111]
    s_waitcnt lgkmcnt(0)
    v_mfma_f32_16x16x32_bf16 v[108:111], a[156:159], v[88:91], v[108:111]
LhsE_26:
    s_nop 3
    ds_write_b128 v14, v[96:99] offset:0
    ds_write_b128 v14, v[100:103] offset:1024
    ds_write_b128 v14, v[104:107] offset:2048
    s_nop 0
    ds_write_b128 v14, v[108:111] offset:3072
    v_lshlrev_b32 v44, 16, v32
    v_and_b32 v45, s44, v32
    v_fma_f32 v16, v44, s97, v16
    v_fma_f32 v20, v45, s97, v20
    v_lshlrev_b32 v46, 16, v33
    v_and_b32 v47, s44, v33
    v_fma_f32 v17, v46, s98, v17
    v_fma_f32 v21, v47, s98, v21
    v_lshlrev_b32 v44, 16, v34
    v_and_b32 v45, s44, v34
    v_fma_f32 v18, v44, s99, v18
    v_fma_f32 v22, v45, s99, v22
    v_lshlrev_b32 v46, 16, v35
    v_and_b32 v47, s44, v35
    v_fma_f32 v19, v46, s100, v19
    v_fma_f32 v23, v47, s100, v23
    v_lshlrev_b32 v44, 16, v36
    v_and_b32 v45, s44, v36
    v_fma_f32 v24, v44, s97, v24
    v_fma_f32 v28, v45, s97, v28
    v_lshlrev_b32 v46, 16, v37
    v_and_b32 v47, s44, v37
    v_fma_f32 v25, v46, s98, v25
    v_fma_f32 v29, v47, s98, v29
    v_lshlrev_b32 v44, 16, v38
    v_and_b32 v45, s44, v38
    v_fma_f32 v26, v44, s99, v26
    v_fma_f32 v30, v45, s99, v30
    v_lshlrev_b32 v46, 16, v39
    v_and_b32 v47, s44, v39
    v_fma_f32 v27, v46, s100, v27
    v_fma_f32 v31, v47, s100, v31
    s_waitcnt lgkmcnt(0)
    s_barrier
    ds_read_b64 v[44:45], v15 offset:0
    ds_read_b64 v[46:47], v15 offset:4096
    ds_read_b64 v[48:49], v15 offset:8192
    ds_read_b64 v[50:51], v15 offset:12288
    ds_read_b64 v[56:57], v15 offset:2048
    ds_read_b64 v[58:59], v15 offset:6144
    ds_read_b64 v[60:61], v15 offset:10240
    ds_read_b64 v[62:63], v15 offset:14336
    s_waitcnt lgkmcnt(4)
    v_add_f32 v44, v44, v16
    v_add_f32 v45, v45, v20
    v_add_f32 v46, v46, v17
    v_add_f32 v47, v47, v21
    v_add_f32 v48, v48, v18
    v_add_f32 v49, v49, v22
    v_add_f32 v50, v50, v19
    v_add_f32 v51, v51, v23
    v_cvt_pk_bf16_f32 v52, v44, v46
    v_cvt_pk_bf16_f32 v53, v48, v50
    v_cvt_pk_bf16_f32 v54, v45, v47
    v_cvt_pk_bf16_f32 v55, v49, v51
    buffer_store_dwordx4 v[52:55], v8, s[8:11], s36 offen sc1
    s_waitcnt lgkmcnt(0)
    v_mov_b32 v44, v56
    v_mov_b32 v45, v57
    v_mov_b32 v46, v58
    v_mov_b32 v47, v59
    v_mov_b32 v48, v60
    v_mov_b32 v49, v61
    v_mov_b32 v50, v62
    v_mov_b32 v51, v63
    v_add_f32 v44, v44, v24
    v_add_f32 v45, v45, v28
    v_add_f32 v46, v46, v25
    v_add_f32 v47, v47, v29
    v_add_f32 v48, v48, v26
    v_add_f32 v49, v49, v30
    v_add_f32 v50, v50, v27
    v_add_f32 v51, v51, v31
    v_cvt_pk_bf16_f32 v52, v44, v46
    v_cvt_pk_bf16_f32 v53, v48, v50
    v_cvt_pk_bf16_f32 v54, v45, v47
    v_cvt_pk_bf16_f32 v55, v49, v51
    buffer_store_dwordx4 v[52:55], v8, s[8:11], s37 offen sc1
    v_lshlrev_b32 v64, 4, v1
    s_mul_i32 s38, s7, 98304
    s_mul_i32 s39, s3, 24576
    s_add_u32 s38, s38, s39
    s_add_u32 s38, s38, 1048576
    s_add_u32 m0, s39, 0
    s_add_u32 s74, s38, 0
    buffer_load_dwordx4 v64, s[8:11], s74 offen offset:0 sc1 lds
    buffer_load_dwordx4 v64, s[8:11], s74 offen offset:1024 sc1 lds
    buffer_load_dwordx4 v64, s[8:11], s74 offen offset:2048 sc1 lds
    buffer_load_dwordx4 v64, s[8:11], s74 offen offset:3072 sc1 lds
    s_waitcnt vmcnt(4)
    s_waitcnt lgkmcnt(0)
    s_barrier
    s_cmp_lg_u32 s3, 0
    s_cbranch_scc1 Larr_27
    s_add_u32 s72, s64, 3
    s_lshl_b32 s73, s2, 7
    v_mov_b32 v2, s72
    v_mov_b32 v3, s73
    s_mov_b64 exec, 1
    buffer_store_dword v2, v3, s[8:11], 0 offen sc0 sc1
    s_mov_b64 exec, -1
Larr_27:
    s_add_u32 m0, s39, 4096
    s_add_u32 s74, s38, 4096
    buffer_load_dwordx4 v64, s[8:11], s74 offen offset:0 sc1 lds
    buffer_load_dwordx4 v64, s[8:11], s74 offen offset:1024 sc1 lds
    buffer_load_dwordx4 v64, s[8:11], s74 offen offset:2048 sc1 lds
    buffer_load_dwordx4 v64, s[8:11], s74 offen offset:3072 sc1 lds
    s_add_u32 m0, s39, 8192
    s_add_u32 s74, s38, 8192
    buffer_load_dwordx4 v64, s[8:11], s74 offen offset:0 sc1 lds
    buffer_load_dwordx4 v64, s[8:11], s74 offen offset:1024 sc1 lds
    buffer_load_dwordx4 v64, s[8:11], s74 offen offset:2048 sc1 lds
    buffer_load_dwordx4 v64, s[8:11], s74 offen offset:3072 sc1 lds
    s_add_u32 m0, s39, 12288
    s_add_u32 s74, s38, 12288
    buffer_load_dwordx4 v64, s[8:11], s74 offen offset:0 sc1 lds
    buffer_load_dwordx4 v64, s[8:11], s74 offen offset:1024 sc1 lds
    buffer_load_dwordx4 v64, s[8:11], s74 offen offset:2048 sc1 lds
    buffer_load_dwordx4 v64, s[8:11], s74 offen offset:3072 sc1 lds
    s_add_u32 m0, s39, 16384
    s_add_u32 s74, s38, 16384
    buffer_load_dwordx4 v64, s[8:11], s74 offen offset:0 sc1 lds
    buffer_load_dwordx4 v64, s[8:11], s74 offen offset:1024 sc1 lds
    buffer_load_dwordx4 v64, s[8:11], s74 offen offset:2048 sc1 lds
    buffer_load_dwordx4 v64, s[8:11], s74 offen offset:3072 sc1 lds
    s_add_u32 m0, s39, 20480
    s_add_u32 s74, s38, 20480
    buffer_load_dwordx4 v64, s[8:11], s74 offen offset:0 sc1 lds
    buffer_load_dwordx4 v64, s[8:11], s74 offen offset:1024 sc1 lds
    buffer_load_dwordx4 v64, s[8:11], s74 offen offset:2048 sc1 lds
    buffer_load_dwordx4 v64, s[8:11], s74 offen offset:3072 sc1 lds
    v_lshlrev_b32 v100, 7, v0
    buffer_load_dword v101, v100, s[8:11], 0 offen sc1
    v_and_b32 v4, 31, v1
    s_lshl_b32 s72, s3, 5
    v_add_u32 v4, s72, v4
    v_lshlrev_b32 v4, 5, v4
    v_lshrrev_b32 v5, 5, v1
    v_lshl_add_u32 v40, v5, 13, v4
    v_add_u32 v40, 0, v40
    v_lshl_add_u32 v41, v5, 12, v4
    v_add_u32 v41, 16384, v41
    v_lshrrev_b32 v4, 4, v1
    v_bfe_u32 v5, v1, 2, 2
    v_lshl_add_u32 v5, v4, 2, v5
    v_lshlrev_b32 v5, 5, v5
    v_and_b32 v4, 3, v1
    v_lshl_add_u32 v5, v4, 3, v5
    s_lshr_b32 s72, s3, 1
    s_lshl_b32 s73, s72, 12
    s_add_u32 s73, s73, 16384
    v_add_u32 v27, s73, v5
    s_lshl_b32 s73, s3, 12
    s_add_u32 s73, s73, 0
    v_add_u32 v26, s73, v5
    v_and_b32 v4, 15, v1
    v_lshrrev_b32 v5, 5, v1
    v_lshl_add_u32 v4, v5, 4, v4
    v_lshlrev_b32 v4, 4, v4
    v_bfe_u32 v5, v1, 4, 1
    v_lshl_add_u32 v4, v5, 9, v4
    s_lshl_b32 s73, s3, 10
    s_add_u32 s73, s73, 24576
    v_add_u32 v36, s73, v4
    v_lshlrev_b32 v38, 2, v1
    v_add_u32 v37, s73, v38
    s_lshl_b32 s74, s7, 1
    s_lshr_b32 s75, s3, 1
    s_add_u32 s74, s74, s75
    s_lshl_b32 s76, s74, 11
    s_and_b32 s75, s3, 1
    s_lshl_b32 s77, s75, 9
    s_add_u32 s76, s76, s77
    s_add_u32 s58, s76, 196608
    s_lshl_b32 s76, s74, 7
    s_lshl_b32 s77, s75, 6
    s_add_u32 s76, s76, s77
    s_add_u32 s59, s76, 262144
    v_and_b32 v4, 15, v1
    v_lshlrev_b32 v4, 4, v4
    v_lshrrev_b32 v5, 4, v1
    v_lshl_add_u32 v39, v5, 10, v4
    s_lshl_b32 s74, s6, 2
    s_add_u32 s74, s74, s3
    s_lshl_b32 s74, s74, 16
    s_lshl_b32 s75, s7, 12
    s_add_u32 s74, s74, s75
    s_add_u32 s60, s74, 8388608
    v_lshrrev_b32 v43, 1, v0
    v_lshlrev_b32 v43, 14, v43
    v_and_b32 v4, 1, v0
    v_lshl_add_u32 v43, v4, 5, v43
    s_lshl_b32 s72, s6, 10
    s_lshl_b32 s73, s7, 6
    s_add_u32 s72, s72, s73
    s_add_u32 s61, s72, 14680064
    v_and_b32 v42, 15, v1
    v_lshlrev_b32 v42, 4, v42
    v_lshrrev_b32 v4, 4, v1
    v_lshl_add_u32 v42, v4, 14, v42
    s_lshl_b32 s72, s6, 10
    s_lshl_b32 s73, s3, 8
    s_add_u32 s72, s72, s73
    s_add_u32 s36, s72, 14680064
    v_lshlrev_b32 v6, 4, v1
    v_add_u32 v7, 49152, v6
    s_waitcnt vmcnt(0) lgkmcnt(0)
    v_lshlrev_b32 v2, 7, v0
    s_add_u32 s72, s64, 3
    s_mov_b32 s73, 0
    v_subrev_u32 v3, s72, v101
    v_cmpx_le_u32 vcc, 8, v3
    s_nop 4
    s_cbranch_execz Lgx_29
Lgw_28:
    buffer_load_dword v3, v2, s[8:11], 0 offen sc1
    s_add_u32 s73, s73, 1
    s_cmp_gt_u32 s73, 0x40000
    s_cbranch_scc1 Lgx_29
    s_waitcnt vmcnt(0)
    v_subrev_u32 v3, s72, v3
    v_cmpx_le_u32 vcc, 8, v3
    s_nop 4
    s_cbranch_execz Lgx_29
    s_branch Lgw_28
Lgx_29:
    s_waitcnt vmcnt(0)
    s_mov_b64 exec, -1
    s_barrier
    buffer_load_dwordx4 v[28:31], v43, s[8:11], s61 offen sc1
    buffer_load_dwordx4 v[32:35], v43, s[8:11], s61 offen offset:16 sc1
    v_mov_b32 v2, v42
    s_add_u32 s37, s36, 0
    buffer_load_dwordx4 v[128:131], v2, s[8:11], s37 offen sc1
    s_add_u32 s37, s36, 65536
    buffer_load_dwordx4 v[132:135], v2, s[8:11], s37 offen sc1
    s_add_u32 s37, s36, 131072
    buffer_load_dwordx4 v[136:139], v2, s[8:11], s37 offen sc1
    s_add_u32 s37, s36, 196608
    buffer_load_dwordx4 v[140:143], v2, s[8:11], s37 offen sc1
    s_add_u32 s37, s36, 262144
    buffer_load_dwordx4 v[144:147], v2, s[8:11], s37 offen sc1
    s_add_u32 s37, s36, 327680
    buffer_load_dwordx4 v[148:151], v2, s[8:11], s37 offen sc1
    s_waitcnt vmcnt(6)
    v_lshlrev_b32 v16, 16, v28
    v_and_b32 v17, s44, v28
    v_lshlrev_b32 v18, 16, v29
    s_add_u32 s37, s36, 393216
    buffer_load_dwordx4 v[152:155], v2, s[8:11], s37 offen sc1
    v_and_b32 v19, s44, v29
    v_pk_add_f32 v[20:21], v[16:17], v[18:19]
    v_pk_mul_f32 v[22:23], v[16:17], v[16:17]
    v_pk_fma_f32 v[22:23], v[18:19], v[18:19], v[22:23]
    v_add_f32 v8, v20, v21
    v_add_f32 v12, v22, v23
    v_lshlrev_b32 v16, 16, v30
    v_and_b32 v17, s44, v30
    v_lshlrev_b32 v18, 16, v31
    s_add_u32 s37, s36, 458752
    buffer_load_dwordx4 v[156:159], v2, s[8:11], s37 offen sc1
    v_and_b32 v19, s44, v31
    v_pk_add_f32 v[20:21], v[16:17], v[18:19]
    v_pk_mul_f32 v[22:23], v[16:17], v[16:17]
    v_pk_fma_f32 v[22:23], v[18:19], v[18:19], v[22:23]
    v_add_f32 v9, v20, v21
    v_add_f32 v13, v22, v23
    v_lshlrev_b32 v16, 16, v32
    v_and_b32 v17, s44, v32
    v_lshlrev_b32 v18, 16, v33
    s_add_u32 s37, s36, 524288
    buffer_load_dwordx4 v[160:163], v2, s[8:11], s37 offen sc1
    v_and_b32 v19, s44, v33
    v_pk_add_f32 v[20:21], v[16:17], v[18:19]
    v_pk_mul_f32 v[22:23], v[16:17], v[16:17]
    v_pk_fma_f32 v[22:23], v[18:19], v[18:19], v[22:23]
    v_add_f32 v10, v20, v21
    v_add_f32 v14, v22, v23
    v_lshlrev_b32 v16, 16, v34
    v_and_b32 v17, s44, v34
    v_lshlrev_b32 v18, 16, v35
    s_add_u32 s37, s36, 589824
    buffer_load_dwordx4 v[164:167], v2, s[8:11], s37 offen sc1
    v_and_b32 v19, s44, v35
    v_pk_add_f32 v[20:21], v[16:17], v[18:19]
    v_pk_mul_f32 v[22:23], v[16:17], v[16:17]
    v_pk_fma_f32 v[22:23], v[18:19], v[18:19], v[22:23]
    v_add_f32 v11, v20, v21
    v_add_f32 v15, v22, v23
    v_permlane32_swap_b32 v8, v12
    v_permlane32_swap_b32 v9, v13
    v_permlane32_swap_b32 v10, v14
    s_add_u32 s37, s36, 655360
    buffer_load_dwordx4 v[168:171], v2, s[8:11], s37 offen sc1
    v_permlane32_swap_b32 v11, v15
    v_add_f32 v8, v8, v12
    v_add_f32 v9, v9, v13
    v_add_f32 v10, v10, v14
    v_add_f32 v11, v11, v15
    v_permlane16_swap_b32 v8, v9
    s_nop 0
    v_permlane16_swap_b32 v10, v11
    v_add_f32 v8, v8, v9
    v_add_f32 v10, v10, v11
    s_add_u32 s37, s36, 720896
    buffer_load_dwordx4 v[172:175], v2, s[8:11], s37 offen sc1
    s_nop 0
    v_add_f32_dpp v8, v8, v8 row_ror:8 row_mask:0xf bank_mask:0xf
    v_add_f32_dpp v10, v10, v10 row_ror:8 row_mask:0xf bank_mask:0xf
    s_nop 0
    v_add_f32_dpp v8, v8, v8 row_ror:4 row_mask:0xf bank_mask:0xf
    v_add_f32_dpp v10, v10, v10 row_ror:4 row_mask:0xf bank_mask:0xf
    s_nop 0
    v_add_f32_dpp v8, v8, v8 row_ror:2 row_mask:0xf bank_mask:0xf
    v_add_f32_dpp v10, v10, v10 row_ror:2 row_mask:0xf bank_mask:0xf
    s_add_u32 s37, s36, 786432
    buffer_load_dwordx4 v[176:179], v2, s[8:11], s37 offen sc1
    v_lshrrev_b32 v16, 5, v1
    v_bfe_u32 v17, v1, 4, 1
    v_and_b32 v18, 1, v1
    v_lshl_add_u32 v17, v18, 2, v17
    v_lshl_add_u32 v16, v16, 3, v17
    s_lshl_b32 s72, s3, 6
    s_add_u32 s72, s72, 98304
    v_lshlrev_b32 v16, 2, v16
    v_add_u32 v16, s72, v16
    s_add_u32 s37, s36, 851968
    buffer_load_dwordx4 v[180:183], v2, s[8:11], s37 offen sc1
    ds_write_b32 v16, v8
    ds_write_b32 v16, v10 offset:8
    ds_read_b128 v[44:47], v6 offset:0
    ds_read_b128 v[48:51], v6 offset:1024
    ds_read_b128 v[52:55], v6 offset:2048
    ds_read_b128 v[56:59], v6 offset:3072
    ds_read_b128 v[60:63], v6 offset:4096
    ds_read_b128 v[64:67], v6 offset:5120
    v_and_b32 v16, 7, v1
    v_lshlrev_b32 v16, 2, v16
    v_add_u32 v16, 98304, v16
    s_waitcnt lgkmcnt(6)
    s_barrier
    ds_read_b32 v8, v16 offset:0
    ds_read_b32 v12, v16 offset:32
    ds_read_b32 v9, v16 offset:64
    ds_read_b32 v13, v16 offset:96
    ds_read_b32 v10, v16 offset:128
    ds_read_b32 v14, v16 offset:160
    ds_read_b32 v11, v16 offset:192
    ds_read_b32 v15, v16 offset:224
    s_lshl_b32 s72, s6, 10
    s_lshl_b32 s73, s7, 6
    s_add_u32 s72, s72, s73
    s_add_u32 s72, s72, 311296
    v_and_b32 v17, 7, v1
    v_lshlrev_b32 v17, 3, v17
    s_waitcnt lgkmcnt(0)
    v_add_f32 v8, v8, v9
    v_add_f32 v10, v10, v11
    v_add_f32 v12, v12, v13
    v_add_f32 v14, v14, v15
    v_add_f32 v8, v8, v10
    v_add_f32 v12, v12, v14
    v_mul_f32 v8, 0x3b000000, v8
    v_mul_f32 v12, 0x3b000000, v12
    v_fma_f32 v12, -v8, v8, v12
    v_add_f32 v12, 0x3727c5ac, v12
    v_rsq_f32 v9, v12
    s_cmp_lg_u32 s3, 0
    s_cbranch_scc1 Lstp_30
    s_mov_b32 exec_lo, 0xff
    s_mov_b32 exec_hi, 0
    buffer_store_dwordx2 v[8:9], v17, s[8:11], s72 offen sc1
    s_mov_b64 exec, -1
Lstp_30:
    v_and_b32 v10, 15, v1
    v_bfe_u32 v11, v1, 4, 1
    v_lshl_add_u32 v10, v10, 1, v11
    v_lshlrev_b32 v10, 3, v10
    s_lshl_b32 s72, s6, 10
    s_lshl_b32 s73, s3, 8
    s_add_u32 s72, s72, s73
    s_add_u32 s39, s72, 311296
    s_waitcnt vmcnt(13)
    v_permlane16_swap_b32 v128, v130
    v_permlane16_swap_b32 v129, v131
    s_waitcnt lgkmcnt(3)
    s_nop 0
    v_mfma_f32_32x32x16_bf16 v[80:95], v[44:47], v[128:131], 0
    ds_read_b128 v[68:71], v6 offset:6144
    s_add_u32 s37, s36, 917504
    buffer_load_dwordx4 v[184:187], v2, s[8:11], s37 offen sc1
    v_mfma_f32_32x32x16_bf16 v[96:111], v[48:51], v[128:131], 0
    ds_read_b128 v[72:75], v6 offset:7168
    s_waitcnt vmcnt(13)
    v_permlane16_swap_b32 v132, v134
    v_permlane16_swap_b32 v133, v135
    v_mfma_f32_32x32x16_bf16 v[112:127], v[52:55], v[128:131], 0
    ds_read_b128 v[76:79], v6 offset:8192
    s_waitcnt lgkmcnt(3)
    v_mfma_f32_32x32x16_bf16 v[80:95], v[56:59], v[132:135], v[80:95]
    ds_read_b128 v[44:47], v6 offset:9216
    s_add_u32 s37, s36, 983040
    buffer_load_dwordx4 v[188:191], v2, s[8:11], s37 offen sc1
    v_mfma_f32_32x32x16_bf16 v[96:111], v[60:63], v[132:135], v[96:111]
    ds_read_b128 v[48:51], v6 offset:10240
    s_waitcnt vmcnt(13)
    v_permlane16_swap_b32 v136, v138
    v_permlane16_swap_b32 v137, v139
    v_mfma_f32_32x32x16_bf16 v[112:127], v[64:67], v[132:135], v[112:127]
    ds_read_b128 v[52:55], v6 offset:11264
    s_waitcnt lgkmcnt(3)
    v_mfma_f32_32x32x16_bf16 v[80:95], v[68:71], v[136:139], v[80:95]
    ds_read_b128 v[56:59], v6 offset:12288
    s_add_u32 s37, s36, 1048576
    buffer_load_dwordx4 v[192:195], v2, s[8:11], s37 offen sc1
    v_mfma_f32_32x32x16_bf16 v[96:111], v[72:75], v[136:139], v[96:111]
    ds_read_b128 v[60:63], v6 offset:13312
    s_waitcnt vmcnt(13)
    v_permlane16_swap_b32 v140, v142
    v_permlane16_swap_b32 v141, v143
    v_mfma_f32_32x32x16_bf16 v[112:127], v[76:79], v[136:139], v[112:127]
    ds_read_b128 v[64:67], v6 offset:14336
    s_waitcnt lgkmcnt(3)
    v_mfma_f32_32x32x16_bf16 v[80:95], v[44:47], v[140:143], v[80:95]
    ds_read_b128 v[68:71], v6 offset:15360
    s_add_u32 s37, s36, 1114112
    buffer_load_dwordx4 v[196:199], v2, s[8:11], s37 offen sc1
    v_mfma_f32_32x32x16_bf16 v[96:111], v[48:51], v[140:143], v[96:111]
    ds_read_b128 v[72:75], v6 offset:16384
    s_waitcnt vmcnt(13)
    v_permlane16_swap_b32 v144, v146
    v_permlane16_swap_b32 v145, v147
    v_mfma_f32_32x32x16_bf16 v[112:127], v[52:55], v[140:143], v[112:127]
    ds_read_b128 v[76:79], v6 offset:17408
    s_waitcnt lgkmcnt(3)
    v_mfma_f32_32x32x16_bf16 v[80:95], v[56:59], v[144:147], v[80:95]
    ds_read_b128 v[44:47], v6 offset:18432
    s_add_u32 s37, s36, 1179648
    buffer_load_dwordx4 v[200:203], v2, s[8:11], s37 offen sc1
    v_mfma_f32_32x32x16_bf16 v[96:111], v[60:63], v[144:147], v[96:111]
    ds_read_b128 v[48:51], v6 offset:19456
    s_waitcnt vmcnt(13)
    v_permlane16_swap_b32 v148, v150
    v_permlane16_swap_b32 v149, v151
    v_mfma_f32_32x32x16_bf16 v[112:127], v[64:67], v[144:147], v[112:127]
    ds_read_b128 v[52:55], v6 offset:20480
    s_waitcnt lgkmcnt(3)
    v_mfma_f32_32x32x16_bf16 v[80:95], v[68:71], v[148:151], v[80:95]
    ds_read_b128 v[56:59], v6 offset:21504
    s_add_u32 s37, s36, 1245184
    buffer_load_dwordx4 v[204:207], v2, s[8:11], s37 offen sc1
    v_mfma_f32_32x32x16_bf16 v[96:111], v[72:75], v[148:151], v[96:111]
    ds_read_b128 v[60:63], v6 offset:22528
    s_waitcnt vmcnt(13)
    v_permlane16_swap_b32 v152, v154
    v_permlane16_swap_b32 v153, v155
    v_mfma_f32_32x32x16_bf16 v[112:127], v[76:79], v[148:151], v[112:127]
    ds_read_b128 v[64:67], v6 offset:23552
    s_waitcnt lgkmcnt(3)
    v_mfma_f32_32x32x16_bf16 v[80:95], v[44:47], v[152:155], v[80:95]
    ds_read_b128 v[68:71], v6 offset:24576
    s_add_u32 s37, s36, 1310720
    buffer_load_dwordx4 v[208:211], v2, s[8:11], s37 offen sc1
    v_mfma_f32_32x32x16_bf16 v[96:111], v[48:51], v[152:155], v[96:111]
    ds_read_b128 v[72:75], v6 offset:25600
    s_waitcnt vmcnt(13)
    v_permlane16_swap_b32 v156, v158
    v_permlane16_swap_b32 v157, v159
    v_mfma_f32_32x32x16_bf16 v[112:127], v[52:55], v[152:155], v[112:127]
    ds_read_b128 v[76:79], v6 offset:26624
    s_waitcnt lgkmcnt(3)
    v_mfma_f32_32x32x16_bf16 v[80:95], v[56:59], v[156:159], v[80:95]
    ds_read_b128 v[44:47], v6 offset:27648
    s_add_u32 s37, s36, 1376256
    buffer_load_dwordx4 v[212:215], v2, s[8:11], s37 offen sc1
    v_mfma_f32_32x32x16_bf16 v[96:111], v[60:63], v[156:159], v[96:111]
    ds_read_b128 v[48:51], v6 offset:28672
    s_waitcnt vmcnt(13)
    v_permlane16_swap_b32 v160, v162
    v_permlane16_swap_b32 v161, v163
    v_mfma_f32_32x32x16_bf16 v[112:127], v[64:67], v[156:159], v[112:127]
    ds_read_b128 v[52:55], v6 offset:29696
    s_waitcnt lgkmcnt(3)
    v_mfma_f32_32x32x16_bf16 v[80:95], v[68:71], v[160:163], v[80:95]
    ds_read_b128 v[56:59], v6 offset:30720
    s_add_u32 s37, s36, 1441792
    buffer_load_dwordx4 v[216:219], v2, s[8:11], s37 offen sc1
    v_mfma_f32_32x32x16_bf16 v[96:111], v[72:75], v[160:163], v[96:111]
    ds_read_b128 v[60:63], v6 offset:31744
    s_waitcnt vmcnt(13)
    v_permlane16_swap_b32 v164, v166
    v_permlane16_swap_b32 v165, v167
    v_mfma_f32_32x32x16_bf16 v[112:127], v[76:79], v[160:163], v[112:127]
    ds_read_b128 v[64:67], v6 offset:32768
    s_waitcnt lgkmcnt(3)
    v_mfma_f32_32x32x16_bf16 v[80:95], v[44:47], v[164:167], v[80:95]
    ds_read_b128 v[68:71], v6 offset:33792
    s_add_u32 s37, s36, 1507328
    buffer_load_dwordx4 v[220:223], v2, s[8:11], s37 offen sc1
    v_mfma_f32_32x32x16_bf16 v[96:111], v[48:51], v[164:167], v[96:111]
    ds_read_b128 v[72:75], v6 offset:34816
    s_waitcnt vmcnt(13)
    v_permlane16_swap_b32 v168, v170
    v_permlane16_swap_b32 v169, v171
    v_mfma_f32_32x32x16_bf16 v[112:127], v[52:55], v[164:167], v[112:127]
    ds_read_b128 v[76:79], v6 offset:35840
    s_waitcnt lgkmcnt(3)
    v_mfma_f32_32x32x16_bf16 v[80:95], v[56:59], v[168:171], v[80:95]
    ds_read_b128 v[44:47], v6 offset:36864
    s_add_u32 s37, s36, 1572864
    buffer_load_dwordx4 v[224:227], v2, s[8:11], s37 offen sc1
    v_mfma_f32_32x32x16_bf16 v[96:111], v[60:63], v[168:171], v[96:111]
    ds_read_b128 v[48:51], v6 offset:37888
    s_waitcnt vmcnt(13)
    v_permlane16_swap_b32 v172, v174
    v_permlane16_swap_b32 v173, v175
    v_mfma_f32_32x32x16_bf16 v[112:127], v[64:67], v[168:171], v[112:127]
    ds_read_b128 v[52:55], v6 offset:38912
    s_waitcnt lgkmcnt(3)
    v_mfma_f32_32x32x16_bf16 v[80:95], v[68:71], v[172:175], v[80:95]
    ds_read_b128 v[56:59], v6 offset:39936
    s_add_u32 s37, s36, 1638400
    buffer_load_dwordx4 v[228:231], v2, s[8:11], s37 offen sc1
    v_mfma_f32_32x32x16_bf16 v[96:111], v[72:75], v[172:175], v[96:111]
    ds_read_b128 v[60:63], v6 offset:40960
    s_waitcnt vmcnt(13)
    v_permlane16_swap_b32 v176, v178
    v_permlane16_swap_b32 v177, v179
    v_mfma_f32_32x32x16_bf16 v[112:127], v[76:79], v[172:175], v[112:127]
    ds_read_b128 v[64:67], v6 offset:41984
    s_waitcnt lgkmcnt(3)
    v_mfma_f32_32x32x16_bf16 v[80:95], v[44:47], v[176:179], v[80:95]
    ds_read_b128 v[68:71], v6 offset:43008
    s_add_u32 s37, s36, 1703936
    buffer_load_dwordx4 v[232:235], v2, s[8:11], s37 offen sc1
    v_mfma_f32_32x32x16_bf16 v[96:111], v[48:51], v[176:179], v[96:111]
    ds_read_b128 v[72:75], v6 offset:44032
    s_waitcnt vmcnt(13)
    v_permlane16_swap_b32 v180, v182
    v_permlane16_swap_b32 v181, v183
    v_mfma_f32_32x32x16_bf16 v[112:127], v[52:55], v[176:179], v[112:127]
    ds_read_b128 v[76:79], v6 offset:45056
    s_waitcnt lgkmcnt(3)
    v_mfma_f32_32x32x16_bf16 v[80:95], v[56:59], v[180:183], v[80:95]
    ds_read_b128 v[44:47], v6 offset:46080
    s_add_u32 s37, s36, 1769472
    buffer_load_dwordx4 v[236:239], v2, s[8:11], s37 offen sc1
    v_mfma_f32_32x32x16_bf16 v[96:111], v[60:63], v[180:183], v[96:111]
    ds_read_b128 v[48:51], v6 offset:47104
    s_waitcnt vmcnt(13)
    v_permlane16_swap_b32 v184, v186
    v_permlane16_swap_b32 v185, v187
    v_mfma_f32_32x32x16_bf16 v[112:127], v[64:67], v[180:183], v[112:127]
    ds_read_b128 v[52:55], v6 offset:48128
    s_waitcnt lgkmcnt(3)
    v_mfma_f32_32x32x16_bf16 v[80:95], v[68:71], v[184:187], v[80:95]
    ds_read_b128 v[56:59], v7 offset:0
    s_add_u32 s37, s36, 1835008
    buffer_load_dwordx4 v[240:243], v2, s[8:11], s37 offen sc1
    v_mfma_f32_32x32x16_bf16 v[96:111], v[72:75], v[184:187], v[96:111]
    ds_read_b128 v[60:63], v7 offset:1024
    s_waitcnt vmcnt(13)
    v_permlane16_swap_b32 v188, v190
    v_permlane16_swap_b32 v189, v191
    v_mfma_f32_32x32x16_bf16 v[112:127], v[76:79], v[184:187], v[112:127]
    ds_read_b128 v[64:67], v7 offset:2048
    s_waitcnt lgkmcnt(3)
    v_mfma_f32_32x32x16_bf16 v[80:95], v[44:47], v[188:191], v[80:95]
    ds_read_b128 v[68:71], v7 offset:3072
    s_add_u32 s37, s36, 1900544
    buffer_load_dwordx4 v[244:247], v2, s[8:11], s37 offen sc1
    v_mfma_f32_32x32x16_bf16 v[96:111], v[48:51], v[188:191], v[96:111]
    ds_read_b128 v[72:75], v7 offset:4096
    s_waitcnt vmcnt(13)
    v_permlane16_swap_b32 v192, v194
    v_permlane16_swap_b32 v193, v195
    v_mfma_f32_32x32x16_bf16 v[112:127], v[52:55], v[188:191], v[112:127]
    ds_read_b128 v[76:79], v7 offset:5120
    s_waitcnt lgkmcnt(3)
    v_mfma_f32_32x32x16_bf16 v[80:95], v[56:59], v[192:195], v[80:95]
    ds_read_b128 v[44:47], v7 offset:6144
    s_add_u32 s37, s36, 1966080
    buffer_load_dwordx4 v[248:251], v2, s[8:11], s37 offen sc1
    v_mfma_f32_32x32x16_bf16 v[96:111], v[60:63], v[192:195], v[96:111]
    ds_read_b128 v[48:51], v7 offset:7168
    s_waitcnt vmcnt(13)
    v_permlane16_swap_b32 v196, v198
    v_permlane16_swap_b32 v197, v199
    v_mfma_f32_32x32x16_bf16 v[112:127], v[64:67], v[192:195], v[112:127]
    ds_read_b128 v[52:55], v7 offset:8192
    s_waitcnt lgkmcnt(3)
    v_mfma_f32_32x32x16_bf16 v[80:95], v[68:71], v[196:199], v[80:95]
    ds_read_b128 v[56:59], v7 offset:9216
    s_add_u32 s37, s36, 2031616
    buffer_load_dwordx4 v[252:255], v2, s[8:11], s37 offen sc1
    v_mfma_f32_32x32x16_bf16 v[96:111], v[72:75], v[196:199], v[96:111]
    ds_read_b128 v[60:63], v7 offset:10240
    s_waitcnt vmcnt(13)
    v_permlane16_swap_b32 v200, v202
    v_permlane16_swap_b32 v201, v203
    v_mfma_f32_32x32x16_bf16 v[112:127], v[76:79], v[196:199], v[112:127]
    ds_read_b128 v[64:67], v7 offset:11264
    s_waitcnt lgkmcnt(3)
    v_mfma_f32_32x32x16_bf16 v[80:95], v[44:47], v[200:203], v[80:95]
    ds_read_b128 v[68:71], v7 offset:12288
    v_mfma_f32_32x32x16_bf16 v[96:111], v[48:51], v[200:203], v[96:111]
    ds_read_b128 v[72:75], v7 offset:13312
    s_waitcnt vmcnt(12)
    v_permlane16_swap_b32 v204, v206
    v_permlane16_swap_b32 v205, v207
    v_mfma_f32_32x32x16_bf16 v[112:127], v[52:55], v[200:203], v[112:127]
    ds_read_b128 v[76:79], v7 offset:14336
    s_waitcnt lgkmcnt(3)
    v_mfma_f32_32x32x16_bf16 v[80:95], v[56:59], v[204:207], v[80:95]
    ds_read_b128 v[44:47], v7 offset:15360
    v_mfma_f32_32x32x16_bf16 v[96:111], v[60:63], v[204:207], v[96:111]
    ds_read_b128 v[48:51], v7 offset:16384
    s_waitcnt vmcnt(11)
    v_permlane16_swap_b32 v208, v210
    v_permlane16_swap_b32 v209, v211
    v_mfma_f32_32x32x16_bf16 v[112:127], v[64:67], v[204:207], v[112:127]
    ds_read_b128 v[52:55], v7 offset:17408
    s_waitcnt lgkmcnt(3)
    v_mfma_f32_32x32x16_bf16 v[80:95], v[68:71], v[208:211], v[80:95]
    ds_read_b128 v[56:59], v7 offset:18432
    v_mfma_f32_32x32x16_bf16 v[96:111], v[72:75], v[208:211], v[96:111]
    ds_read_b128 v[60:63], v7 offset:19456
    s_waitcnt vmcnt(10)
    v_permlane16_swap_b32 v212, v214
    v_permlane16_swap_b32 v213, v215
    v_mfma_f32_32x32x16_bf16 v[112:127], v[76:79], v[208:211], v[112:127]
    ds_read_b128 v[64:67], v7 offset:20480
    s_waitcnt lgkmcnt(3)
    v_mfma_f32_32x32x16_bf16 v[80:95], v[44:47], v[212:215], v[80:95]
    ds_read_b128 v[68:71], v7 offset:21504
    v_mfma_f32_32x32x16_bf16 v[96:111], v[48:51], v[212:215], v[96:111]
    ds_read_b128 v[72:75], v7 offset:22528
    s_waitcnt vmcnt(9)
    v_permlane16_swap_b32 v216, v218
    v_permlane16_swap_b32 v217, v219
    v_mfma_f32_32x32x16_bf16 v[112:127], v[52:55], v[212:215], v[112:127]
    ds_read_b128 v[76:79], v7 offset:23552
    s_waitcnt lgkmcnt(3)
    v_mfma_f32_32x32x16_bf16 v[80:95], v[56:59], v[216:219], v[80:95]
    ds_read_b128 v[44:47], v7 offset:24576
    v_mfma_f32_32x32x16_bf16 v[96:111], v[60:63], v[216:219], v[96:111]
    ds_read_b128 v[48:51], v7 offset:25600
    s_waitcnt vmcnt(8)
    v_permlane16_swap_b32 v220, v222
    v_permlane16_swap_b32 v221, v223
    v_mfma_f32_32x32x16_bf16 v[112:127], v[64:67], v[216:219], v[112:127]
    ds_read_b128 v[52:55], v7 offset:26624
    s_waitcnt lgkmcnt(3)
    v_mfma_f32_32x32x16_bf16 v[80:95], v[68:71], v[220:223], v[80:95]
    ds_read_b128 v[56:59], v7 offset:27648
    v_mfma_f32_32x32x16_bf16 v[96:111], v[72:75], v[220:223], v[96:111]
    ds_read_b128 v[60:63], v7 offset:28672
    s_waitcnt vmcnt(7)
    v_permlane16_swap_b32 v224, v226
    v_permlane16_swap_b32 v225, v227
    v_mfma_f32_32x32x16_bf16 v[112:127], v[76:79], v[220:223], v[112:127]
    ds_read_b128 v[64:67], v7 offset:29696
    s_waitcnt lgkmcnt(3)
    v_mfma_f32_32x32x16_bf16 v[80:95], v[44:47], v[224:227], v[80:95]
    ds_read_b128 v[68:71], v7 offset:30720
    v_mfma_f32_32x32x16_bf16 v[96:111], v[48:51], v[224:227], v[96:111]
    ds_read_b128 v[72:75], v7 offset:31744
    buffer_load_dwordx2 v[8:9], v10, s[8:11], s39 offen sc1
    s_waitcnt vmcnt(7)
    v_permlane16_swap_b32 v228, v230
    v_permlane16_swap_b32 v229, v231
    v_mfma_f32_32x32x16_bf16 v[112:127], v[52:55], v[224:227], v[112:127]
    ds_read_b128 v[76:79], v7 offset:32768
    s_waitcnt lgkmcnt(3)
    v_mfma_f32_32x32x16_bf16 v[80:95], v[56:59], v[228:231], v[80:95]
    ds_read_b128 v[44:47], v7 offset:33792
    v_mfma_f32_32x32x16_bf16 v[96:111], v[60:63], v[228:231], v[96:111]
    ds_read_b128 v[48:51], v7 offset:34816
    s_waitcnt vmcnt(6)
    v_permlane16_swap_b32 v232, v234
    v_permlane16_swap_b32 v233, v235
    v_mfma_f32_32x32x16_bf16 v[112:127], v[64:67], v[228:231], v[112:127]
    ds_read_b128 v[52:55], v7 offset:35840
    s_waitcnt lgkmcnt(3)
    v_mfma_f32_32x32x16_bf16 v[80:95], v[68:71], v[232:235], v[80:95]
    ds_read_b128 v[56:59], v7 offset:36864
    v_mfma_f32_32x32x16_bf16 v[96:111], v[72:75], v[232:235], v[96:111]
    ds_read_b128 v[60:63], v7 offset:37888
    s_waitcnt vmcnt(5)
    v_permlane16_swap_b32 v236, v238
    v_permlane16_swap_b32 v237, v239
    v_mfma_f32_32x32x16_bf16 v[112:127], v[76:79], v[232:235], v[112:127]
    ds_read_b128 v[64:67], v7 offset:38912
    s_waitcnt lgkmcnt(3)
    v_mfma_f32_32x32x16_bf16 v[80:95], v[44:47], v[236:239], v[80:95]
    ds_read_b128 v[68:71], v7 offset:39936
    v_mfma_f32_32x32x16_bf16 v[96:111], v[48:51], v[236:239], v[96:111]
    ds_read_b128 v[72:75], v7 offset:40960
    s_waitcnt vmcnt(4)
    v_permlane16_swap_b32 v240, v242
    v_permlane16_swap_b32 v241, v243
    v_mfma_f32_32x32x16_bf16 v[112:127], v[52:55], v[236:239], v[112:127]
    ds_read_b128 v[76:79], v7 offset:41984
    s_waitcnt lgkmcnt(3)
    v_mfma_f32_32x32x16_bf16 v[80:95], v[56:59], v[240:243], v[80:95]
    ds_read_b128 v[44:47], v7 offset:43008
    v_mfma_f32_32x32x16_bf16 v[96:111], v[60:63], v[240:243], v[96:111]
    ds_read_b128 v[48:51], v7 offset:44032
    s_waitcnt vmcnt(3)
    v_permlane16_swap_b32 v244, v246
    v_permlane16_swap_b32 v245, v247
    v_mfma_f32_32x32x16_bf16 v[112:127], v[64:67], v[240:243], v[112:127]
    ds_read_b128 v[52:55], v7 offset:45056
    s_waitcnt lgkmcnt(3)
    v_mfma_f32_32x32x16_bf16 v[80:95], v[68:71], v[244:247], v[80:95]
    ds_read_b128 v[56:59], v7 offset:46080
    v_mfma_f32_32x32x16_bf16 v[96:111], v[72:75], v[244:247], v[96:111]
    ds_read_b128 v[60:63], v7 offset:47104
    s_waitcnt vmcnt(2)
    v_permlane16_swap_b32 v248, v250
    v_permlane16_swap_b32 v249, v251
    v_mfma_f32_32x32x16_bf16 v[112:127], v[76:79], v[244:247], v[112:127]
    ds_read_b128 v[64:67], v7 offset:48128
    s_waitcnt lgkmcnt(3)
    v_mfma_f32_32x32x16_bf16 v[80:95], v[44:47], v[248:251], v[80:95]
    v_mfma_f32_32x32x16_bf16 v[96:111], v[48:51], v[248:251], v[96:111]
    s_waitcnt vmcnt(1)
    v_permlane16_swap_b32 v252, v254
    v_permlane16_swap_b32 v253, v255
    v_mfma_f32_32x32x16_bf16 v[112:127], v[52:55], v[248:251], v[112:127]
    s_waitcnt lgkmcnt(0)
    v_mfma_f32_32x32x16_bf16 v[80:95], v[56:59], v[252:255], v[80:95]
    v_mfma_f32_32x32x16_bf16 v[96:111], v[60:63], v[252:255], v[96:111]
    v_mfma_f32_32x32x16_bf16 v[112:127], v[64:67], v[252:255], v[112:127]
    s_waitcnt vmcnt(0)
    v_cmp_eq_u32 vcc, 0, v9
    s_nop 4
    s_cbranch_vccz Lstx_32
    s_mov_b32 s73, 0
Lstw_31:
    buffer_load_dwordx2 v[8:9], v10, s[8:11], s39 offen sc1
    s_add_u32 s73, s73, 1
    s_cmp_gt_u32 s73, 0x40000
    s_cbranch_scc1 Lstx_32
    s_waitcnt vmcnt(0)
    v_cmp_eq_u32 vcc, 0, v9
    s_nop 4
    s_cbranch_vccnz Lstw_31
Lstx_32:
    s_waitcnt vmcnt(0)
    v_mov_b32 v4, v8
    v_mov_b32 v6, v9
    s_barrier
    v_sub_f32 v7, 0, v4
    v_cvt_pk_bf16_f32 v10, v7, v7
    v_and_b32 v8, 0xffff0000, v10
    v_sub_f32 v9, v7, v8
    v_cvt_pk_bf16_f32 v12, v8, v9
    v_cvt_pk_bf16_f32 v13, v8, 0
    v_mov_b32 v14, 0
    v_mov_b32 v15, 0
    v_cmp_gt_u32 vcc, 32, v1
    v_mul_f32 v16, s66, v6
    s_nop 0
    v_cndmask_b32 v12, 0, v12, vcc
    v_cndmask_b32 v13, 0, v13, vcc
    s_nop 1
    v_mfma_f32_32x32x16_bf16 v[96:111], a[250:253], v[12:15], v[96:111]
    v_mfma_f32_32x32x16_bf16 v[112:127], a[252:255], v[12:15], v[112:127]
    v_mfma_f32_32x32x16_bf16 v[80:95], a[248:251], v[12:15], v[80:95]
    s_nop 9
    v_cvt_pk_bf16_f32 v128, v96, v97
    v_cvt_pk_bf16_f32 v129, v98, v99
    v_cvt_pk_bf16_f32 v130, v100, v101
    v_cvt_pk_bf16_f32 v131, v102, v103
    v_cvt_pk_bf16_f32 v132, v104, v105
    v_cvt_pk_bf16_f32 v133, v106, v107
    v_cvt_pk_bf16_f32 v134, v108, v109
    v_cvt_pk_bf16_f32 v135, v110, v111
    v_mfma_f32_32x32x16_bf16 v[144:159], a[240:243], v[128:131], 0
    s_nop 0
    v_mfma_f32_32x32x16_bf16 v[144:159], a[244:247], v[132:135], v[144:159]
    v_mul_f32 v112, v112, v6
    v_mul_f32 v113, v113, v6
    v_mul_f32 v114, v114, v6
    v_mul_f32 v115, v115, v6
    v_mul_f32 v116, v116, v6
    v_mul_f32 v117, v117, v6
    v_mul_f32 v118, v118, v6
    v_mul_f32 v119, v119, v6
    v_mul_f32 v120, v120, v6
    v_mul_f32 v121, v121, v6
    v_mul_f32 v122, v122, v6
    v_mul_f32 v123, v123, v6
    v_mul_f32 v124, v124, v6
    v_mul_f32 v125, v125, v6
    v_mul_f32 v126, v126, v6
    v_mul_f32 v127, v127, v6
    v_cvt_pk_bf16_f32 v192, v112, v113
    v_cvt_pk_bf16_f32 v193, v114, v115
    v_cvt_pk_bf16_f32 v194, v116, v117
    v_cvt_pk_bf16_f32 v195, v118, v119
    v_cvt_pk_bf16_f32 v196, v120, v121
    v_cvt_pk_bf16_f32 v197, v122, v123
    v_cvt_pk_bf16_f32 v198, v124, v125
    v_cvt_pk_bf16_f32 v199, v126, v127
    ds_write_b128 v41, v[192:195]
    ds_write_b128 v41, v[196:199] offset:16
    v_cvt_pk_bf16_f32 v136, v80, v81
    v_cvt_pk_bf16_f32 v137, v82, v83
    v_cvt_pk_bf16_f32 v138, v84, v85
    v_cvt_pk_bf16_f32 v139, v86, v87
    v_cvt_pk_bf16_f32 v140, v88, v89
    v_cvt_pk_bf16_f32 v141, v90, v91
    v_cvt_pk_bf16_f32 v142, v92, v93
    v_cvt_pk_bf16_f32 v143, v94, v95
    v_mfma_f32_32x32x16_bf16 v[208:223], a[240:243], v[136:139], 0
    s_nop 0
    v_mfma_f32_32x32x16_bf16 v[208:223], a[244:247], v[140:143], v[208:223]
    v_max3_f32 v20, v144, v145, v146
    v_min3_f32 v21, v144, v145, v146
    v_max3_f32 v20, v20, v147, v148
    v_min3_f32 v21, v21, v147, v148
    v_max3_f32 v20, v20, v149, v150
    v_min3_f32 v21, v21, v149, v150
    v_max3_f32 v20, v20, v151, v152
    v_min3_f32 v21, v21, v151, v152
    v_max3_f32 v20, v20, v153, v154
    v_min3_f32 v21, v21, v153, v154
    v_max3_f32 v20, v20, v155, v156
    v_min3_f32 v21, v21, v155, v156
    v_max3_f32 v20, v20, v157, v158
    v_min3_f32 v21, v21, v157, v158
    v_max_f32 v20, v20, v159
    v_min_f32 v21, v21, v159
    v_mov_b32 v22, v16
    v_mov_b32 v24, v16
    v_mul_f32 v23, v20, v16
    v_mul_f32 v25, v21, v16
    v_pk_fma_f32 v[160:161], v[144:145], v[22:23], v[22:23] op_sel:[0,0,1] op_sel_hi:[1,0,1] neg_lo:[0,0,1] neg_hi:[0,0,1]
    v_pk_fma_f32 v[176:177], v[144:145], v[24:25], v[24:25] op_sel:[0,0,1] op_sel_hi:[1,0,1] neg_lo:[1,0,0] neg_hi:[1,0,0]
    v_pk_fma_f32 v[162:163], v[146:147], v[22:23], v[22:23] op_sel:[0,0,1] op_sel_hi:[1,0,1] neg_lo:[0,0,1] neg_hi:[0,0,1]
    v_pk_fma_f32 v[178:179], v[146:147], v[24:25], v[24:25] op_sel:[0,0,1] op_sel_hi:[1,0,1] neg_lo:[1,0,0] neg_hi:[1,0,0]
    v_pk_fma_f32 v[164:165], v[148:149], v[22:23], v[22:23] op_sel:[0,0,1] op_sel_hi:[1,0,1] neg_lo:[0,0,1] neg_hi:[0,0,1]
    v_pk_fma_f32 v[180:181], v[148:149], v[24:25], v[24:25] op_sel:[0,0,1] op_sel_hi:[1,0,1] neg_lo:[1,0,0] neg_hi:[1,0,0]
    v_pk_fma_f32 v[166:167], v[150:151], v[22:23], v[22:23] op_sel:[0,0,1] op_sel_hi:[1,0,1] neg_lo:[0,0,1] neg_hi:[0,0,1]
    v_pk_fma_f32 v[182:183], v[150:151], v[24:25], v[24:25] op_sel:[0,0,1] op_sel_hi:[1,0,1] neg_lo:[1,0,0] neg_hi:[1,0,0]
    v_pk_fma_f32 v[168:169], v[152:153], v[22:23], v[22:23] op_sel:[0,0,1] op_sel_hi:[1,0,1] neg_lo:[0,0,1] neg_hi:[0,0,1]
    v_pk_fma_f32 v[184:185], v[152:153], v[24:25], v[24:25] op_sel:[0,0,1] op_sel_hi:[1,0,1] neg_lo:[1,0,0] neg_hi:[1,0,0]
    v_pk_fma_f32 v[170:171], v[154:155], v[22:23], v[22:23] op_sel:[0,0,1] op_sel_hi:[1,0,1] neg_lo:[0,0,1] neg_hi:[0,0,1]
    v_pk_fma_f32 v[186:187], v[154:155], v[24:25], v[24:25] op_sel:[0,0,1] op_sel_hi:[1,0,1] neg_lo:[1,0,0] neg_hi:[1,0,0]
    v_pk_fma_f32 v[172:173], v[156:157], v[22:23], v[22:23] op_sel:[0,0,1] op_sel_hi:[1,0,1] neg_lo:[0,0,1] neg_hi:[0,0,1]
    v_pk_fma_f32 v[188:189], v[156:157], v[24:25], v[24:25] op_sel:[0,0,1] op_sel_hi:[1,0,1] neg_lo:[1,0,0] neg_hi:[1,0,0]
    v_pk_fma_f32 v[174:175], v[158:159], v[22:23], v[22:23] op_sel:[0,0,1] op_sel_hi:[1,0,1] neg_lo:[0,0,1] neg_hi:[0,0,1]
    v_pk_fma_f32 v[190:191], v[158:159], v[24:25], v[24:25] op_sel:[0,0,1] op_sel_hi:[1,0,1] neg_lo:[1,0,0] neg_hi:[1,0,0]
    v_exp_f32 v160, v160
    v_exp_f32 v161, v161
    v_exp_f32 v162, v162
    v_exp_f32 v163, v163
    v_exp_f32 v164, v164
    v_exp_f32 v165, v165
    v_exp_f32 v166, v166
    v_exp_f32 v167, v167
    v_exp_f32 v168, v168
    v_exp_f32 v169, v169
    v_exp_f32 v170, v170
    v_exp_f32 v171, v171
    v_exp_f32 v172, v172
    v_exp_f32 v173, v173
    v_exp_f32 v174, v174
    v_exp_f32 v175, v175
    v_exp_f32 v176, v176
    v_exp_f32 v177, v177
    v_exp_f32 v178, v178
    v_exp_f32 v179, v179
    v_exp_f32 v180, v180
    v_exp_f32 v181, v181
    v_exp_f32 v182, v182
    v_exp_f32 v183, v183
    v_exp_f32 v184, v184
    v_exp_f32 v185, v185
    v_exp_f32 v186, v186
    v_exp_f32 v187, v187
    v_exp_f32 v188, v188
    v_exp_f32 v189, v189
    v_exp_f32 v190, v190
    v_exp_f32 v191, v191
    v_pk_add_f32 v[224:225], v[160:161], v[162:163]
    v_pk_add_f32 v[226:227], v[164:165], v[166:167]
    v_pk_add_f32 v[228:229], v[168:169], v[170:171]
    v_pk_add_f32 v[230:231], v[172:173], v[174:175]
    v_pk_add_f32 v[232:233], v[176:177], v[178:179]
    v_pk_add_f32 v[234:235], v[180:181], v[182:183]
    v_pk_add_f32 v[236:237], v[184:185], v[186:187]
    v_pk_add_f32 v[238:239], v[188:189], v[190:191]
    v_pk_add_f32 v[224:225], v[224:225], v[226:227]
    v_pk_add_f32 v[228:229], v[228:229], v[230:231]
    v_pk_add_f32 v[232:233], v[232:233], v[234:235]
    v_pk_add_f32 v[236:237], v[236:237], v[238:239]
    v_pk_add_f32 v[224:225], v[224:225], v[228:229]
    v_pk_add_f32 v[232:233], v[232:233], v[236:237]
    v_add_f32 v224, v224, v225
    v_add_f32 v232, v232, v233
    v_rcp_f32 v20, v224
    v_rcp_f32 v22, v232
    s_nop 0
    v_pk_mul_f32 v[160:161], v[160:161], v[20:21] op_sel_hi:[1,0]
    v_pk_mul_f32 v[162:163], v[162:163], v[20:21] op_sel_hi:[1,0]
    v_pk_mul_f32 v[164:165], v[164:165], v[20:21] op_sel_hi:[1,0]
    v_pk_mul_f32 v[166:167], v[166:167], v[20:21] op_sel_hi:[1,0]
    v_pk_mul_f32 v[168:169], v[168:169], v[20:21] op_sel_hi:[1,0]
    v_pk_mul_f32 v[170:171], v[170:171], v[20:21] op_sel_hi:[1,0]
    v_pk_mul_f32 v[172:173], v[172:173], v[20:21] op_sel_hi:[1,0]
    v_pk_mul_f32 v[174:175], v[174:175], v[20:21] op_sel_hi:[1,0]
    v_pk_mul_f32 v[176:177], v[176:177], v[22:23] op_sel_hi:[1,0]
    v_pk_mul_f32 v[178:179], v[178:179], v[22:23] op_sel_hi:[1,0]
    v_pk_mul_f32 v[180:181], v[180:181], v[22:23] op_sel_hi:[1,0]
    v_pk_mul_f32 v[182:183], v[182:183], v[22:23] op_sel_hi:[1,0]
    v_pk_mul_f32 v[184:185], v[184:185], v[22:23] op_sel_hi:[1,0]
    v_pk_mul_f32 v[186:187], v[186:187], v[22:23] op_sel_hi:[1,0]
    v_pk_mul_f32 v[188:189], v[188:189], v[22:23] op_sel_hi:[1,0]
    v_pk_mul_f32 v[190:191], v[190:191], v[22:23] op_sel_hi:[1,0]
    v_cvt_pk_bf16_f32 v224, v160, v161
    v_cvt_pk_bf16_f32 v225, v162, v163
    v_cvt_pk_bf16_f32 v226, v164, v165
    v_cvt_pk_bf16_f32 v227, v166, v167
    v_cvt_pk_bf16_f32 v228, v168, v169
    v_cvt_pk_bf16_f32 v229, v170, v171
    v_cvt_pk_bf16_f32 v230, v172, v173
    v_cvt_pk_bf16_f32 v231, v174, v175
    v_cvt_pk_bf16_f32 v232, v176, v177
    v_cvt_pk_bf16_f32 v233, v178, v179
    v_cvt_pk_bf16_f32 v234, v180, v181
    v_cvt_pk_bf16_f32 v235, v182, v183
    v_cvt_pk_bf16_f32 v236, v184, v185
    v_cvt_pk_bf16_f32 v237, v186, v187
    v_cvt_pk_bf16_f32 v238, v188, v189
    v_cvt_pk_bf16_f32 v239, v190, v191
    ds_write_b128 v40, v[224:227]
    ds_write_b128 v40, v[228:231] offset:16
    ds_write_b128 v40, v[232:235] offset:4096
    ds_write_b128 v40, v[236:239] offset:4112
    s_waitcnt lgkmcnt(0)
    s_barrier
    ds_read_b64_tr_b16 v[96:97], v26 offset:0
    ds_read_b64_tr_b16 v[98:99], v26 offset:512
    ds_read_b64_tr_b16 v[100:101], v27 offset:0
    ds_read_b64_tr_b16 v[102:103], v27 offset:512
    ds_read_b64_tr_b16 v[104:105], v26 offset:1024
    ds_read_b64_tr_b16 v[106:107], v26 offset:1536
    ds_read_b64_tr_b16 v[108:109], v27 offset:1024
    ds_read_b64_tr_b16 v[110:111], v27 offset:1536
    ds_read_b64_tr_b16 v[112:113], v26 offset:2048
    ds_read_b64_tr_b16 v[114:115], v26 offset:2560
    ds_read_b64_tr_b16 v[116:117], v27 offset:2048
    ds_read_b64_tr_b16 v[118:119], v27 offset:2560
    s_waitcnt lgkmcnt(8)
    ds_read_b64_tr_b16 v[120:121], v26 offset:3072
    ds_read_b64_tr_b16 v[122:123], v26 offset:3584
    ds_read_b64_tr_b16 v[124:125], v27 offset:3072
    ds_read_b64_tr_b16 v[126:127], v27 offset:3584
    v_mov_b32 v136, s65
    v_mov_b32 v137, s65
    v_mov_b32 v138, s65
    v_mov_b32 v139, s65
    s_waitcnt lgkmcnt(8)
    v_mfma_f32_16x16x32_bf16 v[128:131], v[96:99], v[100:103], 0
    v_mfma_f32_16x16x32_bf16 v[132:135], v[136:139], v[96:99], 0
    s_waitcnt lgkmcnt(8)
    v_mfma_f32_16x16x32_bf16 v[128:131], v[104:107], v[108:111], v[128:131]
    v_mfma_f32_16x16x32_bf16 v[132:135], v[136:139], v[104:107], v[132:135]
    s_waitcnt lgkmcnt(4)
    v_mfma_f32_16x16x32_bf16 v[128:131], v[112:115], v[116:119], v[128:131]
    v_mfma_f32_16x16x32_bf16 v[132:135], v[136:139], v[112:115], v[132:135]
    s_waitcnt lgkmcnt(0)
    v_mfma_f32_16x16x32_bf16 v[128:131], v[120:123], v[124:127], v[128:131]
    v_mfma_f32_16x16x32_bf16 v[132:135], v[136:139], v[120:123], v[132:135]
    v_max3_f32 v20, v208, v209, v210
    v_min3_f32 v21, v208, v209, v210
    v_max3_f32 v20, v20, v211, v212
    v_min3_f32 v21, v21, v211, v212
    v_max3_f32 v20, v20, v213, v214
    v_min3_f32 v21, v21, v213, v214
    v_max3_f32 v20, v20, v215, v216
    v_min3_f32 v21, v21, v215, v216
    v_max3_f32 v20, v20, v217, v218
    v_min3_f32 v21, v21, v217, v218
    v_max3_f32 v20, v20, v219, v220
    v_min3_f32 v21, v21, v219, v220
    v_max3_f32 v20, v20, v221, v222
    v_min3_f32 v21, v21, v221, v222
    v_max_f32 v20, v20, v223
    v_min_f32 v21, v21, v223
    v_mov_b32 v22, v16
    v_mov_b32 v24, v16
    ds_write_b128 v36, v[128:131]
    v_mul_f32 v23, v20, v16
    v_mul_f32 v25, v21, v16
    v_pk_fma_f32 v[160:161], v[208:209], v[22:23], v[22:23] op_sel:[0,0,1] op_sel_hi:[1,0,1] neg_lo:[0,0,1] neg_hi:[0,0,1]
    v_pk_fma_f32 v[176:177], v[208:209], v[24:25], v[24:25] op_sel:[0,0,1] op_sel_hi:[1,0,1] neg_lo:[1,0,0] neg_hi:[1,0,0]
    v_pk_fma_f32 v[162:163], v[210:211], v[22:23], v[22:23] op_sel:[0,0,1] op_sel_hi:[1,0,1] neg_lo:[0,0,1] neg_hi:[0,0,1]
    v_pk_fma_f32 v[178:179], v[210:211], v[24:25], v[24:25] op_sel:[0,0,1] op_sel_hi:[1,0,1] neg_lo:[1,0,0] neg_hi:[1,0,0]
    v_pk_fma_f32 v[164:165], v[212:213], v[22:23], v[22:23] op_sel:[0,0,1] op_sel_hi:[1,0,1] neg_lo:[0,0,1] neg_hi:[0,0,1]
    v_pk_fma_f32 v[180:181], v[212:213], v[24:25], v[24:25] op_sel:[0,0,1] op_sel_hi:[1,0,1] neg_lo:[1,0,0] neg_hi:[1,0,0]
    v_pk_fma_f32 v[166:167], v[214:215], v[22:23], v[22:23] op_sel:[0,0,1] op_sel_hi:[1,0,1] neg_lo:[0,0,1] neg_hi:[0,0,1]
    v_pk_fma_f32 v[182:183], v[214:215], v[24:25], v[24:25] op_sel:[0,0,1] op_sel_hi:[1,0,1] neg_lo:[1,0,0] neg_hi:[1,0,0]
    v_pk_fma_f32 v[168:169], v[216:217], v[22:23], v[22:23] op_sel:[0,0,1] op_sel_hi:[1,0,1] neg_lo:[0,0,1] neg_hi:[0,0,1]
    v_pk_fma_f32 v[184:185], v[216:217], v[24:25], v[24:25] op_sel:[0,0,1] op_sel_hi:[1,0,1] neg_lo:[1,0,0] neg_hi:[1,0,0]
    v_pk_fma_f32 v[170:171], v[218:219], v[22:23], v[22:23] op_sel:[0,0,1] op_sel_hi:[1,0,1] neg_lo:[0,0,1] neg_hi:[0,0,1]
    v_pk_fma_f32 v[186:187], v[218:219], v[24:25], v[24:25] op_sel:[0,0,1] op_sel_hi:[1,0,1] neg_lo:[1,0,0] neg_hi:[1,0,0]
    v_pk_fma_f32 v[172:173], v[220:221], v[22:23], v[22:23] op_sel:[0,0,1] op_sel_hi:[1,0,1] neg_lo:[0,0,1] neg_hi:[0,0,1]
    v_pk_fma_f32 v[188:189], v[220:221], v[24:25], v[24:25] op_sel:[0,0,1] op_sel_hi:[1,0,1] neg_lo:[1,0,0] neg_hi:[1,0,0]
    v_pk_fma_f32 v[174:175], v[222:223], v[22:23], v[22:23] op_sel:[0,0,1] op_sel_hi:[1,0,1] neg_lo:[0,0,1] neg_hi:[0,0,1]
    v_pk_fma_f32 v[190:191], v[222:223], v[24:25], v[24:25] op_sel:[0,0,1] op_sel_hi:[1,0,1] neg_lo:[1,0,0] neg_hi:[1,0,0]
    s_waitcnt lgkmcnt(0)
    ds_read_b32 v140, v37 offset:0
    ds_read_b32 v141, v37 offset:256
    ds_read_b32 v142, v37 offset:512
    ds_read_b32 v143, v37 offset:768
    v_exp_f32 v160, v160
    v_exp_f32 v161, v161
    v_exp_f32 v162, v162
    v_exp_f32 v163, v163
    v_exp_f32 v164, v164
    v_exp_f32 v165, v165
    v_exp_f32 v166, v166
    v_exp_f32 v167, v167
    v_exp_f32 v168, v168
    v_exp_f32 v169, v169
    v_exp_f32 v170, v170
    v_exp_f32 v171, v171
    v_exp_f32 v172, v172
    v_exp_f32 v173, v173
    v_exp_f32 v174, v174
    v_exp_f32 v175, v175
    s_waitcnt lgkmcnt(0)
    buffer_atomic_add_f32 v140, v38, s[8:11], s58 offen offset:0
    buffer_atomic_add_f32 v141, v38, s[8:11], s58 offen offset:256
    buffer_atomic_add_f32 v142, v38, s[8:11], s58 offen offset:1024
    buffer_atomic_add_f32 v143, v38, s[8:11], s58 offen offset:1280
    s_mov_b32 exec_lo, 0xffff
    s_mov_b32 exec_hi, 0
    buffer_atomic_add_f32 v132, v38, s[8:11], s59 offen
    s_mov_b64 exec, -1
    v_exp_f32 v176, v176
    v_exp_f32 v177, v177
    v_exp_f32 v178, v178
    v_exp_f32 v179, v179
    v_exp_f32 v180, v180
    v_exp_f32 v181, v181
    v_exp_f32 v182, v182
    v_exp_f32 v183, v183
    v_exp_f32 v184, v184
    v_exp_f32 v185, v185
    v_exp_f32 v186, v186
    v_exp_f32 v187, v187
    v_exp_f32 v188, v188
    v_exp_f32 v189, v189
    v_exp_f32 v190, v190
    v_exp_f32 v191, v191
    v_pk_add_f32 v[224:225], v[160:161], v[162:163]
    v_pk_add_f32 v[226:227], v[164:165], v[166:167]
    v_pk_add_f32 v[228:229], v[168:169], v[170:171]
    v_pk_add_f32 v[230:231], v[172:173], v[174:175]
    v_pk_add_f32 v[232:233], v[176:177], v[178:179]
    v_pk_add_f32 v[234:235], v[180:181], v[182:183]
    v_pk_add_f32 v[236:237], v[184:185], v[186:187]
    v_pk_add_f32 v[238:239], v[188:189], v[190:191]
    v_pk_add_f32 v[224:225], v[224:225], v[226:227]
    v_pk_add_f32 v[228:229], v[228:229], v[230:231]
    v_pk_add_f32 v[232:233], v[232:233], v[234:235]
    v_pk_add_f32 v[236:237], v[236:237], v[238:239]
    v_pk_add_f32 v[224:225], v[224:225], v[228:229]
    v_pk_add_f32 v[232:233], v[232:233], v[236:237]
    v_add_f32 v224, v224, v225
    v_add_f32 v232, v232, v233
    v_rcp_f32 v20, v224
    v_rcp_f32 v22, v232
    s_nop 0
    v_pk_mul_f32 v[160:161], v[160:161], v[20:21] op_sel_hi:[1,0]
    v_pk_mul_f32 v[162:163], v[162:163], v[20:21] op_sel_hi:[1,0]
    v_pk_mul_f32 v[164:165], v[164:165], v[20:21] op_sel_hi:[1,0]
    v_pk_mul_f32 v[166:167], v[166:167], v[20:21] op_sel_hi:[1,0]
    v_pk_mul_f32 v[168:169], v[168:169], v[20:21] op_sel_hi:[1,0]
    v_pk_mul_f32 v[170:171], v[170:171], v[20:21] op_sel_hi:[1,0]
    v_pk_mul_f32 v[172:173], v[172:173], v[20:21] op_sel_hi:[1,0]
    v_pk_mul_f32 v[174:175], v[174:175], v[20:21] op_sel_hi:[1,0]
    v_pk_mul_f32 v[176:177], v[176:177], v[22:23] op_sel_hi:[1,0]
    v_pk_mul_f32 v[178:179], v[178:179], v[22:23] op_sel_hi:[1,0]
    v_pk_mul_f32 v[180:181], v[180:181], v[22:23] op_sel_hi:[1,0]
    v_pk_mul_f32 v[182:183], v[182:183], v[22:23] op_sel_hi:[1,0]
    v_pk_mul_f32 v[184:185], v[184:185], v[22:23] op_sel_hi:[1,0]
    v_pk_mul_f32 v[186:187], v[186:187], v[22:23] op_sel_hi:[1,0]
    v_pk_mul_f32 v[188:189], v[188:189], v[22:23] op_sel_hi:[1,0]
    v_pk_mul_f32 v[190:191], v[190:191], v[22:23] op_sel_hi:[1,0]
    v_cvt_pk_bf16_f32 v224, v160, v161
    v_cvt_pk_bf16_f32 v225, v162, v163
    v_cvt_pk_bf16_f32 v226, v164, v165
    v_cvt_pk_bf16_f32 v227, v166, v167
    v_cvt_pk_bf16_f32 v228, v168, v169
    v_cvt_pk_bf16_f32 v229, v170, v171
    v_cvt_pk_bf16_f32 v230, v172, v173
    v_cvt_pk_bf16_f32 v231, v174, v175
    v_cvt_pk_bf16_f32 v232, v176, v177
    v_cvt_pk_bf16_f32 v233, v178, v179
    v_cvt_pk_bf16_f32 v234, v180, v181
    v_cvt_pk_bf16_f32 v235, v182, v183
    v_cvt_pk_bf16_f32 v236, v184, v185
    v_cvt_pk_bf16_f32 v237, v186, v187
    v_cvt_pk_bf16_f32 v238, v188, v189
    v_cvt_pk_bf16_f32 v239, v190, v191
    buffer_store_dwordx4 v[224:227], v39, s[8:11], s60 offen offset:0 sc1
    buffer_store_dwordx4 v[228:231], v39, s[8:11], s60 offen offset:256 sc1
    buffer_store_dwordx4 v[232:235], v39, s[8:11], s60 offen offset:512 sc1
    buffer_store_dwordx4 v[236:239], v39, s[8:11], s60 offen offset:768 sc1
    s_waitcnt vmcnt(0)
    s_waitcnt lgkmcnt(0)
    s_barrier
    s_cmp_lg_u32 s3, 0
    s_cbranch_scc1 Larr_33
    s_add_u32 s72, s64, 4
    s_lshl_b32 s73, s2, 7
    v_mov_b32 v2, s72
    v_mov_b32 v3, s73
    s_mov_b64 exec, 1
    buffer_store_dword v2, v3, s[8:11], 0 offen sc0 sc1
    s_mov_b64 exec, -1
Larr_33:
    v_and_b32 v2, 15, v1
    v_lshlrev_b32 v2, 4, v2
    v_lshrrev_b32 v3, 4, v1
    v_lshl_add_u32 v2, v3, 14, v2
    s_lshl_b32 s72, s68, 5
    s_lshl_b32 s73, s3, 3
    s_add_u32 s72, s72, s73
    s_add_u32 s72, s72, 0
    s_lshl_b32 s72, s72, 14
    s_lshl_b32 s73, s67, 8
    s_add_u32 s72, s72, s73
    s_add_u32 s72, s72, 14680064
    buffer_load_dwordx4 v[104:107], v2, s[8:11], s72 offen sc1
    s_lshl_b32 s72, s68, 5
    s_lshl_b32 s73, s3, 3
    s_add_u32 s72, s72, s73
    s_add_u32 s72, s72, 4
    s_lshl_b32 s72, s72, 14
    s_lshl_b32 s73, s67, 8
    s_add_u32 s72, s72, s73
    s_add_u32 s72, s72, 14680064
    buffer_load_dwordx4 v[108:111], v2, s[8:11], s72 offen sc1
    v_lshlrev_b32 v60, 4, v0
    v_add_u32 v61, 147328, v60
    s_mov_b32 s74, 0
    s_mov_b32 s75, 0
    v_add_u32 v3, s74, v61
    ds_read_b128 v[8:11], v3 offset:0
    ds_read_b64 v[12:13], v3 offset:16
    ds_read_b128 v[16:19], v3 offset:4128
    ds_read_b64 v[20:21], v3 offset:4144
    v_add_u32 v5, s75, v60
    s_waitcnt lgkmcnt(2)
    v_alignbyte_b32 v44, v9, v8, 2
    v_alignbyte_b32 v48, v10, v9, 2
    v_alignbyte_b32 v45, v10, v9, 2
    v_alignbyte_b32 v49, v11, v10, 2
    v_alignbyte_b32 v46, v11, v10, 2
    v_alignbyte_b32 v50, v12, v11, 2
    v_alignbyte_b32 v47, v12, v11, 2
    v_alignbyte_b32 v51, v13, v12, 2
    v_mov_b32 v52, v9
    v_mov_b32 v53, v10
    v_mov_b32 v54, v11
    v_mov_b32 v55, v12
    ds_write_b128 v5, v[8:11] offset:12480
    ds_write_b128 v5, v[44:47] offset:8320
    ds_write_b128 v5, v[48:51] offset:0
    ds_write_b128 v5, v[52:55] offset:4160
    s_waitcnt lgkmcnt(4)
    v_alignbyte_b32 v44, v17, v16, 2
    v_alignbyte_b32 v48, v18, v17, 2
    v_alignbyte_b32 v45, v18, v17, 2
    v_alignbyte_b32 v49, v19, v18, 2
    v_alignbyte_b32 v46, v19, v18, 2
    v_alignbyte_b32 v50, v20, v19, 2
    v_alignbyte_b32 v47, v20, v19, 2
    v_alignbyte_b32 v51, v21, v20, 2
    v_mov_b32 v52, v17
    v_mov_b32 v53, v18
    v_mov_b32 v54, v19
    v_mov_b32 v55, v20
    ds_write_b128 v5, v[16:19] offset:29120
    ds_write_b128 v5, v[44:47] offset:24960
    ds_write_b128 v5, v[48:51] offset:16640
    ds_write_b128 v5, v[52:55] offset:20800
    s_mov_b32 s74, 8256
    s_mov_b32 s75, 33280
    v_add_u32 v3, s74, v61
    ds_read_b128 v[8:11], v3 offset:0
    ds_read_b64 v[12:13], v3 offset:16
    ds_read_b128 v[16:19], v3 offset:4128
    ds_read_b64 v[20:21], v3 offset:4144
    v_add_u32 v5, s75, v60
    s_waitcnt lgkmcnt(2)
    v_alignbyte_b32 v44, v9, v8, 2
    v_alignbyte_b32 v48, v10, v9, 2
    v_alignbyte_b32 v45, v10, v9, 2
    v_alignbyte_b32 v49, v11, v10, 2
    v_alignbyte_b32 v46, v11, v10, 2
    v_alignbyte_b32 v50, v12, v11, 2
    v_alignbyte_b32 v47, v12, v11, 2
    v_alignbyte_b32 v51, v13, v12, 2
    v_mov_b32 v52, v9
    v_mov_b32 v53, v10
    v_mov_b32 v54, v11
    v_mov_b32 v55, v12
    ds_write_b128 v5, v[8:11] offset:12480
    ds_write_b128 v5, v[44:47] offset:8320
    ds_write_b128 v5, v[48:51] offset:0
    ds_write_b128 v5, v[52:55] offset:4160
    s_waitcnt lgkmcnt(4)
    v_alignbyte_b32 v44, v17, v16, 2
    v_alignbyte_b32 v48, v18, v17, 2
    v_alignbyte_b32 v45, v18, v17, 2
    v_alignbyte_b32 v49, v19, v18, 2
    v_alignbyte_b32 v46, v19, v18, 2
    v_alignbyte_b32 v50, v20, v19, 2
    v_alignbyte_b32 v47, v20, v19, 2
    v_alignbyte_b32 v51, v21, v20, 2
    v_mov_b32 v52, v17
    v_mov_b32 v53, v18
    v_mov_b32 v54, v19
    v_mov_b32 v55, v20
    ds_write_b128 v5, v[16:19] offset:29120
    ds_write_b128 v5, v[44:47] offset:24960
    ds_write_b128 v5, v[48:51] offset:16640
    ds_write_b128 v5, v[52:55] offset:20800
    v_mov_b32 v56, 0
    v_mov_b32 v57, 0
    v_mov_b32 v58, 0
    v_mov_b32 v59, 0
    v_lshrrev_b32 v62, 1, v0
    v_mul_u32_u24 v62, 4160, v62
    v_and_b32 v63, 1, v0
    v_lshl_add_u32 v62, v63, 4, v62
    v_add_u32 v62, 4096, v62
    v_cmp_gt_u32 vcc, 32, v0
    s_nop 3
    s_and_saveexec_b64 s[76:77], vcc
    s_cbranch_execz Lcz_34
    ds_write_b128 v62, v[56:59]
Lcz_34:
    s_mov_b64 exec, s[76:77]
    v_lshlrev_b32 v100, 7, v0
    buffer_load_dword v101, v100, s[8:11], 0 offen sc1
    v_lshlrev_b32 v10, 4, v1
    s_lshl_b32 s61, s3, 10
    s_add_u32 s61, s61, 262144
    s_lshl_b32 s36, s3, 14
    s_add_u32 s36, s36, 196608
    s_lshl_b32 s37, s67, 16
    s_lshl_b32 s74, s3, 14
    s_add_u32 s37, s37, s74
    s_add_u32 s37, s37, 8388608
    s_lshl_b32 s74, s3, 9
    s_add_u32 s74, s74, 131072
    v_lshlrev_b32 v11, 3, v1
    v_add_u32 v11, s74, v11
    v_lshrrev_b32 v8, 4, v1
    v_lshlrev_b32 v8, 4, v8
    v_add_u32 v8, s74, v8
    v_add_u32 v9, 98304, v10
    s_lshl_b32 s74, s3, 13
    v_add_u32 v9, s74, v9
    v_and_b32 v4, 15, v1
    v_lshlrev_b32 v4, 4, v4
    v_lshrrev_b32 v5, 4, v1
    v_lshl_add_u32 v38, v5, 14, v4
    v_lshl_add_u32 v39, v5, 2, v4
    s_lshl_b32 s72, s68, 5
    s_lshl_b32 s73, s3, 3
    s_add_u32 s72, s72, s73
    s_add_u32 s72, s72, 0
    s_lshl_b32 s72, s72, 14
    s_lshl_b32 s73, s67, 8
    s_add_u32 s72, s72, s73
    s_add_u32 s62, s72, 16777216
    s_lshl_b32 s72, s68, 5
    s_lshl_b32 s73, s3, 3
    s_add_u32 s72, s72, s73
    s_add_u32 s72, s72, 4
    s_lshl_b32 s72, s72, 14
    s_lshl_b32 s73, s67, 8
    s_add_u32 s72, s72, s73
    s_add_u32 s63, s72, 16777216
    s_lshl_b32 s72, s67, 8
    s_add_u32 s45, s72, 294912
    s_waitcnt vmcnt(0) lgkmcnt(0)
    v_lshlrev_b32 v2, 7, v0
    s_add_u32 s72, s64, 4
    s_mov_b32 s73, 0
    v_subrev_u32 v3, s72, v101
    v_cmpx_le_u32 vcc, 8, v3
    s_nop 4
    s_cbranch_execz Lgx_36
Lgw_35:
    buffer_load_dword v3, v2, s[8:11], 0 offen sc1
    s_add_u32 s73, s73, 1
    s_cmp_gt_u32 s73, 0x40000
    s_cbranch_scc1 Lgx_36
    s_waitcnt vmcnt(0)
    v_subrev_u32 v3, s72, v3
    v_cmpx_le_u32 vcc, 8, v3
    s_nop 4
    s_cbranch_execz Lgx_36
    s_branch Lgw_35
Lgx_36:
    s_waitcnt vmcnt(0)
    s_mov_b64 exec, -1
    s_barrier
    buffer_load_dwordx4 v[4:7], v10, s[8:11], s61 offen sc1
    s_add_u32 s38, s36, 0
    s_add_u32 s39, s37, 0
    buffer_load_dwordx4 v[128:131], v10, s[8:11], s38 offen sc1
    buffer_load_dwordx4 v[192:195], v10, s[8:11], s39 offen sc1
    buffer_load_dwordx4 v[132:135], v10, s[8:11], s38 offen offset:1024 sc1
    buffer_load_dwordx4 v[196:199], v10, s[8:11], s39 offen offset:1024 sc1
    s_add_u32 s38, s36, 2048
    s_add_u32 s39, s37, 2048
    buffer_load_dwordx4 v[136:139], v10, s[8:11], s38 offen sc1
    buffer_load_dwordx4 v[200:203], v10, s[8:11], s39 offen sc1
    buffer_load_dwordx4 v[140:143], v10, s[8:11], s38 offen offset:1024 sc1
    buffer_load_dwordx4 v[204:207], v10, s[8:11], s39 offen offset:1024 sc1
    s_add_u32 s38, s36, 4096
    s_add_u32 s39, s37, 4096
    buffer_load_dwordx4 v[144:147], v10, s[8:11], s38 offen sc1
    buffer_load_dwordx4 v[208:211], v10, s[8:11], s39 offen sc1
    buffer_load_dwordx4 v[148:151], v10, s[8:11], s38 offen offset:1024 sc1
    buffer_load_dwordx4 v[212:215], v10, s[8:11], s39 offen offset:1024 sc1
    s_add_u32 s38, s36, 6144
    s_add_u32 s39, s37, 6144
    buffer_load_dwordx4 v[152:155], v10, s[8:11], s38 offen sc1
    buffer_load_dwordx4 v[216:219], v10, s[8:11], s39 offen sc1
    buffer_load_dwordx4 v[156:159], v10, s[8:11], s38 offen offset:1024 sc1
    buffer_load_dwordx4 v[220:223], v10, s[8:11], s39 offen offset:1024 sc1
    s_waitcnt vmcnt(16)
    v_cvt_pk_bf16_f32 v4, v4, v5
    v_cvt_pk_bf16_f32 v5, v6, v7
    ds_write_b64 v11, v[4:5]
    s_waitcnt lgkmcnt(0)
    ds_read_b128 v[72:75], v8 offset:0
    ds_read_b128 v[76:79], v8 offset:64
    ds_read_b128 v[80:83], v8 offset:128
    ds_read_b128 v[84:87], v8 offset:192
    ds_read_b128 v[88:91], v8 offset:256
    ds_read_b128 v[92:95], v8 offset:320
    ds_read_b128 v[96:99], v8 offset:384
    ds_read_b128 v[100:103], v8 offset:448
    s_waitcnt vmcnt(12)
    v_cvt_pk_bf16_f32 v40, v128, v129
    v_cvt_pk_bf16_f32 v41, v130, v131
    v_cvt_pk_bf16_f32 v42, v132, v133
    v_cvt_pk_bf16_f32 v43, v134, v135
    s_waitcnt lgkmcnt(0)
    v_mfma_f32_16x16x32_bf16 v[16:19], v[72:75], v[192:195], 0
    v_mfma_f32_16x16x32_bf16 v[24:27], v[72:75], v[196:199], 0
    v_mfma_f32_16x16x32_bf16 v[12:15], v[40:43], v[192:195], 0
    v_mfma_f32_16x16x32_bf16 v[20:23], v[40:43], v[196:199], 0
    s_add_u32 s38, s36, 8192
    s_add_u32 s39, s37, 8192
    buffer_load_dwordx4 v[160:163], v10, s[8:11], s38 offen sc1
    buffer_load_dwordx4 v[224:227], v10, s[8:11], s39 offen sc1
    buffer_load_dwordx4 v[164:167], v10, s[8:11], s38 offen offset:1024 sc1
    buffer_load_dwordx4 v[228:231], v10, s[8:11], s39 offen offset:1024 sc1
    s_waitcnt vmcnt(12)
    v_cvt_pk_bf16_f32 v44, v136, v137
    v_cvt_pk_bf16_f32 v45, v138, v139
    v_cvt_pk_bf16_f32 v46, v140, v141
    v_cvt_pk_bf16_f32 v47, v142, v143
    s_nop 0
    v_mfma_f32_16x16x32_bf16 v[116:119], v[76:79], v[200:203], 0
    v_mfma_f32_16x16x32_bf16 v[124:127], v[76:79], v[204:207], 0
    v_mfma_f32_16x16x32_bf16 v[112:115], v[44:47], v[200:203], 0
    v_mfma_f32_16x16x32_bf16 v[120:123], v[44:47], v[204:207], 0
    v_add_f32 v16, 0x358637bd, v16
    v_add_f32 v24, 0x358637bd, v24
    v_rcp_f32 v16, v16
    v_rcp_f32 v24, v24
    v_mul_f32 v12, v12, v16
    v_mul_f32 v13, v13, v16
    v_mul_f32 v14, v14, v16
    v_mul_f32 v15, v15, v16
    v_mul_f32 v20, v20, v24
    v_mul_f32 v21, v21, v24
    v_mul_f32 v22, v22, v24
    v_mul_f32 v23, v23, v24
    v_cvt_pk_bf16_f32 v28, v12, v13
    v_cvt_pk_bf16_f32 v29, v14, v15
    v_cvt_pk_bf16_f32 v32, v20, v21
    v_cvt_pk_bf16_f32 v33, v22, v23
    s_add_u32 s38, s36, 10240
    s_add_u32 s39, s37, 10240
    buffer_load_dwordx4 v[168:171], v10, s[8:11], s38 offen sc1
    buffer_load_dwordx4 v[232:235], v10, s[8:11], s39 offen sc1
    buffer_load_dwordx4 v[172:175], v10, s[8:11], s38 offen offset:1024 sc1
    buffer_load_dwordx4 v[236:239], v10, s[8:11], s39 offen offset:1024 sc1
    s_waitcnt vmcnt(12)
    v_cvt_pk_bf16_f32 v48, v144, v145
    v_cvt_pk_bf16_f32 v49, v146, v147
    v_cvt_pk_bf16_f32 v50, v148, v149
    v_cvt_pk_bf16_f32 v51, v150, v151
    s_nop 0
    v_mfma_f32_16x16x32_bf16 v[16:19], v[80:83], v[208:211], 0
    v_mfma_f32_16x16x32_bf16 v[24:27], v[80:83], v[212:215], 0
    v_mfma_f32_16x16x32_bf16 v[12:15], v[48:51], v[208:211], 0
    v_mfma_f32_16x16x32_bf16 v[20:23], v[48:51], v[212:215], 0
    v_add_f32 v116, 0x358637bd, v116
    v_add_f32 v124, 0x358637bd, v124
    v_rcp_f32 v116, v116
    v_rcp_f32 v124, v124
    v_mul_f32 v112, v112, v116
    v_mul_f32 v113, v113, v116
    v_mul_f32 v114, v114, v116
    v_mul_f32 v115, v115, v116
    v_mul_f32 v120, v120, v124
    v_mul_f32 v121, v121, v124
    v_mul_f32 v122, v122, v124
    v_mul_f32 v123, v123, v124
    v_cvt_pk_bf16_f32 v30, v112, v113
    v_cvt_pk_bf16_f32 v31, v114, v115
    v_cvt_pk_bf16_f32 v34, v120, v121
    v_cvt_pk_bf16_f32 v35, v122, v123
    ds_write_b128 v9, v[28:31] offset:0
    ds_write_b128 v9, v[32:35] offset:1024
    s_add_u32 s38, s36, 12288
    s_add_u32 s39, s37, 12288
    buffer_load_dwordx4 v[176:179], v10, s[8:11], s38 offen sc1
    buffer_load_dwordx4 v[240:243], v10, s[8:11], s39 offen sc1
    buffer_load_dwordx4 v[180:183], v10, s[8:11], s38 offen offset:1024 sc1
    buffer_load_dwordx4 v[244:247], v10, s[8:11], s39 offen offset:1024 sc1
    s_waitcnt vmcnt(12)
    v_cvt_pk_bf16_f32 v52, v152, v153
    v_cvt_pk_bf16_f32 v53, v154, v155
    v_cvt_pk_bf16_f32 v54, v156, v157
    v_cvt_pk_bf16_f32 v55, v158, v159
    s_nop 0
    v_mfma_f32_16x16x32_bf16 v[116:119], v[84:87], v[216:219], 0
    v_mfma_f32_16x16x32_bf16 v[124:127], v[84:87], v[220:223], 0
    v_mfma_f32_16x16x32_bf16 v[112:115], v[52:55], v[216:219], 0
    v_mfma_f32_16x16x32_bf16 v[120:123], v[52:55], v[220:223], 0
    v_add_f32 v16, 0x358637bd, v16
    v_add_f32 v24, 0x358637bd, v24
    v_rcp_f32 v16, v16
    v_rcp_f32 v24, v24
    v_mul_f32 v12, v12, v16
    v_mul_f32 v13, v13, v16
    v_mul_f32 v14, v14, v16
    v_mul_f32 v15, v15, v16
    v_mul_f32 v20, v20, v24
    v_mul_f32 v21, v21, v24
    v_mul_f32 v22, v22, v24
    v_mul_f32 v23, v23, v24
    v_cvt_pk_bf16_f32 v28, v12, v13
    v_cvt_pk_bf16_f32 v29, v14, v15
    v_cvt_pk_bf16_f32 v32, v20, v21
    v_cvt_pk_bf16_f32 v33, v22, v23
    s_add_u32 s38, s36, 14336
    s_add_u32 s39, s37, 14336
    buffer_load_dwordx4 v[184:187], v10, s[8:11], s38 offen sc1
    buffer_load_dwordx4 v[248:251], v10, s[8:11], s39 offen sc1
    buffer_load_dwordx4 v[188:191], v10, s[8:11], s38 offen offset:1024 sc1
    buffer_load_dwordx4 v[252:255], v10, s[8:11], s39 offen offset:1024 sc1
    s_waitcnt vmcnt(12)
    v_cvt_pk_bf16_f32 v56, v160, v161
    v_cvt_pk_bf16_f32 v57, v162, v163
    v_cvt_pk_bf16_f32 v58, v164, v165
    v_cvt_pk_bf16_f32 v59, v166, v167
    s_nop 0
    v_mfma_f32_16x16x32_bf16 v[16:19], v[88:91], v[224:227], 0
    v_mfma_f32_16x16x32_bf16 v[24:27], v[88:91], v[228:231], 0
    v_mfma_f32_16x16x32_bf16 v[12:15], v[56:59], v[224:227], 0
    v_mfma_f32_16x16x32_bf16 v[20:23], v[56:59], v[228:231], 0
    v_add_f32 v116, 0x358637bd, v116
    v_add_f32 v124, 0x358637bd, v124
    v_rcp_f32 v116, v116
    v_rcp_f32 v124, v124
    v_mul_f32 v112, v112, v116
    v_mul_f32 v113, v113, v116
    v_mul_f32 v114, v114, v116
    v_mul_f32 v115, v115, v116
    v_mul_f32 v120, v120, v124
    v_mul_f32 v121, v121, v124
    v_mul_f32 v122, v122, v124
    v_mul_f32 v123, v123, v124
    v_cvt_pk_bf16_f32 v30, v112, v113
    v_cvt_pk_bf16_f32 v31, v114, v115
    v_cvt_pk_bf16_f32 v34, v120, v121
    v_cvt_pk_bf16_f32 v35, v122, v123
    ds_write_b128 v9, v[28:31] offset:2048
    ds_write_b128 v9, v[32:35] offset:3072
    s_waitcnt vmcnt(8)
    v_cvt_pk_bf16_f32 v60, v168, v169
    v_cvt_pk_bf16_f32 v61, v170, v171
    v_cvt_pk_bf16_f32 v62, v172, v173
    v_cvt_pk_bf16_f32 v63, v174, v175
    s_nop 0
    v_mfma_f32_16x16x32_bf16 v[116:119], v[92:95], v[232:235], 0
    v_mfma_f32_16x16x32_bf16 v[124:127], v[92:95], v[236:239], 0
    v_mfma_f32_16x16x32_bf16 v[112:115], v[60:63], v[232:235], 0
    v_mfma_f32_16x16x32_bf16 v[120:123], v[60:63], v[236:239], 0
    v_add_f32 v16, 0x358637bd, v16
    v_add_f32 v24, 0x358637bd, v24
    v_rcp_f32 v16, v16
    v_rcp_f32 v24, v24
    v_mul_f32 v12, v12, v16
    v_mul_f32 v13, v13, v16
    v_mul_f32 v14, v14, v16
    v_mul_f32 v15, v15, v16
    v_mul_f32 v20, v20, v24
    v_mul_f32 v21, v21, v24
    v_mul_f32 v22, v22, v24
    v_mul_f32 v23, v23, v24
    v_cvt_pk_bf16_f32 v28, v12, v13
    v_cvt_pk_bf16_f32 v29, v14, v15
    v_cvt_pk_bf16_f32 v32, v20, v21
    v_cvt_pk_bf16_f32 v33, v22, v23
    s_waitcnt vmcnt(4)
    v_cvt_pk_bf16_f32 v64, v176, v177
    v_cvt_pk_bf16_f32 v65, v178, v179
    v_cvt_pk_bf16_f32 v66, v180, v181
    v_cvt_pk_bf16_f32 v67, v182, v183
    s_nop 0
    v_mfma_f32_16x16x32_bf16 v[16:19], v[96:99], v[240:243], 0
    v_mfma_f32_16x16x32_bf16 v[24:27], v[96:99], v[244:247], 0
    v_mfma_f32_16x16x32_bf16 v[12:15], v[64:67], v[240:243], 0
    v_mfma_f32_16x16x32_bf16 v[20:23], v[64:67], v[244:247], 0
    v_add_f32 v116, 0x358637bd, v116
    v_add_f32 v124, 0x358637bd, v124
    v_rcp_f32 v116, v116
    v_rcp_f32 v124, v124
    v_mul_f32 v112, v112, v116
    v_mul_f32 v113, v113, v116
    v_mul_f32 v114, v114, v116
    v_mul_f32 v115, v115, v116
    v_mul_f32 v120, v120, v124
    v_mul_f32 v121, v121, v124
    v_mul_f32 v122, v122, v124
    v_mul_f32 v123, v123, v124
    v_cvt_pk_bf16_f32 v30, v112, v113
    v_cvt_pk_bf16_f32 v31, v114, v115
    v_cvt_pk_bf16_f32 v34, v120, v121
    v_cvt_pk_bf16_f32 v35, v122, v123
    ds_write_b128 v9, v[28:31] offset:4096
    ds_write_b128 v9, v[32:35] offset:5120
    s_waitcnt vmcnt(0)
    v_cvt_pk_bf16_f32 v68, v184, v185
    v_cvt_pk_bf16_f32 v69, v186, v187
    v_cvt_pk_bf16_f32 v70, v188, v189
    v_cvt_pk_bf16_f32 v71, v190, v191
    s_nop 0
    v_mfma_f32_16x16x32_bf16 v[116:119], v[100:103], v[248:251], 0
    v_mfma_f32_16x16x32_bf16 v[124:127], v[100:103], v[252:255], 0
    v_mfma_f32_16x16x32_bf16 v[112:115], v[68:71], v[248:251], 0
    v_mfma_f32_16x16x32_bf16 v[120:123], v[68:71], v[252:255], 0
    v_add_f32 v16, 0x358637bd, v16
    v_add_f32 v24, 0x358637bd, v24
    v_rcp_f32 v16, v16
    v_rcp_f32 v24, v24
    v_mul_f32 v12, v12, v16
    v_mul_f32 v13, v13, v16
    v_mul_f32 v14, v14, v16
    v_mul_f32 v15, v15, v16
    v_mul_f32 v20, v20, v24
    v_mul_f32 v21, v21, v24
    v_mul_f32 v22, v22, v24
    v_mul_f32 v23, v23, v24
    v_cvt_pk_bf16_f32 v28, v12, v13
    v_cvt_pk_bf16_f32 v29, v14, v15
    v_cvt_pk_bf16_f32 v32, v20, v21
    v_cvt_pk_bf16_f32 v33, v22, v23
    v_add_f32 v116, 0x358637bd, v116
    v_add_f32 v124, 0x358637bd, v124
    v_rcp_f32 v116, v116
    v_rcp_f32 v124, v124
    v_mul_f32 v112, v112, v116
    v_mul_f32 v113, v113, v116
    v_mul_f32 v114, v114, v116
    v_mul_f32 v115, v115, v116
    v_mul_f32 v120, v120, v124
    v_mul_f32 v121, v121, v124
    v_mul_f32 v122, v122, v124
    v_mul_f32 v123, v123, v124
    v_cvt_pk_bf16_f32 v30, v112, v113
    v_cvt_pk_bf16_f32 v31, v114, v115
    v_cvt_pk_bf16_f32 v34, v120, v121
    v_cvt_pk_bf16_f32 v35, v122, v123
    ds_write_b128 v9, v[28:31] offset:6144
    ds_write_b128 v9, v[32:35] offset:7168
    s_waitcnt lgkmcnt(0)
    s_barrier
    v_add_u32 v9, 98304, v10
    ds_read_b128 v[128:131], v9 offset:0
    ds_read_b128 v[132:135], v9 offset:1024
    ds_read_b128 v[136:139], v9 offset:2048
    ds_read_b128 v[140:143], v9 offset:3072
    ds_read_b128 v[144:147], v9 offset:4096
    ds_read_b128 v[148:151], v9 offset:5120
    ds_read_b128 v[152:155], v9 offset:6144
    ds_read_b128 v[156:159], v9 offset:7168
    s_waitcnt lgkmcnt(6)
    v_mfma_f32_16x16x32_bf16 v[12:15], a[0:3], v[128:131], 0
    v_mfma_f32_16x16x32_bf16 v[16:19], a[0:3], v[132:135], 0
    v_mfma_f32_16x16x32_bf16 v[20:23], a[4:7], v[128:131], 0
    v_mfma_f32_16x16x32_bf16 v[24:27], a[4:7], v[132:135], 0
    ds_read_b128 v[160:163], v9 offset:8192
    ds_read_b128 v[164:167], v9 offset:9216
    s_waitcnt lgkmcnt(6)
    v_mfma_f32_16x16x32_bf16 v[12:15], a[8:11], v[136:139], v[12:15]
    v_mfma_f32_16x16x32_bf16 v[16:19], a[8:11], v[140:143], v[16:19]
    v_mfma_f32_16x16x32_bf16 v[20:23], a[12:15], v[136:139], v[20:23]
    v_mfma_f32_16x16x32_bf16 v[24:27], a[12:15], v[140:143], v[24:27]
    ds_read_b128 v[168:171], v9 offset:10240
    ds_read_b128 v[172:175], v9 offset:11264
    s_waitcnt lgkmcnt(6)
    v_mfma_f32_16x16x32_bf16 v[12:15], a[16:19], v[144:147], v[12:15]
    v_mfma_f32_16x16x32_bf16 v[16:19], a[16:19], v[148:151], v[16:19]
    v_mfma_f32_16x16x32_bf16 v[20:23], a[20:23], v[144:147], v[20:23]
    v_mfma_f32_16x16x32_bf16 v[24:27], a[20:23], v[148:151], v[24:27]
    ds_read_b128 v[176:179], v9 offset:12288
    ds_read_b128 v[180:183], v9 offset:13312
    s_waitcnt lgkmcnt(6)
    v_mfma_f32_16x16x32_bf16 v[12:15], a[24:27], v[152:155], v[12:15]
    v_mfma_f32_16x16x32_bf16 v[16:19], a[24:27], v[156:159], v[16:19]
    v_mfma_f32_16x16x32_bf16 v[20:23], a[28:31], v[152:155], v[20:23]
    v_mfma_f32_16x16x32_bf16 v[24:27], a[28:31], v[156:159], v[24:27]
    ds_read_b128 v[184:187], v9 offset:14336
    ds_read_b128 v[188:191], v9 offset:15360
    s_waitcnt lgkmcnt(6)
    v_mfma_f32_16x16x32_bf16 v[12:15], a[32:35], v[160:163], v[12:15]
    v_mfma_f32_16x16x32_bf16 v[16:19], a[32:35], v[164:167], v[16:19]
    v_mfma_f32_16x16x32_bf16 v[20:23], a[36:39], v[160:163], v[20:23]
    v_mfma_f32_16x16x32_bf16 v[24:27], a[36:39], v[164:167], v[24:27]
    ds_read_b128 v[192:195], v9 offset:16384
    ds_read_b128 v[196:199], v9 offset:17408
    s_waitcnt lgkmcnt(6)
    v_mfma_f32_16x16x32_bf16 v[12:15], a[40:43], v[168:171], v[12:15]
    v_mfma_f32_16x16x32_bf16 v[16:19], a[40:43], v[172:175], v[16:19]
    v_mfma_f32_16x16x32_bf16 v[20:23], a[44:47], v[168:171], v[20:23]
    v_mfma_f32_16x16x32_bf16 v[24:27], a[44:47], v[172:175], v[24:27]
    ds_read_b128 v[200:203], v9 offset:18432
    ds_read_b128 v[204:207], v9 offset:19456
    s_waitcnt lgkmcnt(6)
    v_mfma_f32_16x16x32_bf16 v[12:15], a[48:51], v[176:179], v[12:15]
    v_mfma_f32_16x16x32_bf16 v[16:19], a[48:51], v[180:183], v[16:19]
    v_mfma_f32_16x16x32_bf16 v[20:23], a[52:55], v[176:179], v[20:23]
    v_mfma_f32_16x16x32_bf16 v[24:27], a[52:55], v[180:183], v[24:27]
    ds_read_b128 v[208:211], v9 offset:20480
    ds_read_b128 v[212:215], v9 offset:21504
    s_waitcnt lgkmcnt(6)
    v_mfma_f32_16x16x32_bf16 v[12:15], a[56:59], v[184:187], v[12:15]
    v_mfma_f32_16x16x32_bf16 v[16:19], a[56:59], v[188:191], v[16:19]
    v_mfma_f32_16x16x32_bf16 v[20:23], a[60:63], v[184:187], v[20:23]
    v_mfma_f32_16x16x32_bf16 v[24:27], a[60:63], v[188:191], v[24:27]
    ds_read_b128 v[216:219], v9 offset:22528
    ds_read_b128 v[220:223], v9 offset:23552
    s_waitcnt lgkmcnt(6)
    v_mfma_f32_16x16x32_bf16 v[12:15], a[64:67], v[192:195], v[12:15]
    v_mfma_f32_16x16x32_bf16 v[16:19], a[64:67], v[196:199], v[16:19]
    v_mfma_f32_16x16x32_bf16 v[20:23], a[68:71], v[192:195], v[20:23]
    v_mfma_f32_16x16x32_bf16 v[24:27], a[68:71], v[196:199], v[24:27]
    ds_read_b128 v[224:227], v9 offset:24576
    ds_read_b128 v[228:231], v9 offset:25600
    s_waitcnt lgkmcnt(6)
    v_mfma_f32_16x16x32_bf16 v[12:15], a[72:75], v[200:203], v[12:15]
    v_mfma_f32_16x16x32_bf16 v[16:19], a[72:75], v[204:207], v[16:19]
    v_mfma_f32_16x16x32_bf16 v[20:23], a[76:79], v[200:203], v[20:23]
    v_mfma_f32_16x16x32_bf16 v[24:27], a[76:79], v[204:207], v[24:27]
    ds_read_b128 v[232:235], v9 offset:26624
    ds_read_b128 v[236:239], v9 offset:27648
    s_waitcnt lgkmcnt(6)
    v_mfma_f32_16x16x32_bf16 v[12:15], a[80:83], v[208:211], v[12:15]
    v_mfma_f32_16x16x32_bf16 v[16:19], a[80:83], v[212:215], v[16:19]
    v_mfma_f32_16x16x32_bf16 v[20:23], a[84:87], v[208:211], v[20:23]
    v_mfma_f32_16x16x32_bf16 v[24:27], a[84:87], v[212:215], v[24:27]
    ds_read_b128 v[240:243], v9 offset:28672
    ds_read_b128 v[244:247], v9 offset:29696
    s_waitcnt lgkmcnt(6)
    v_mfma_f32_16x16x32_bf16 v[12:15], a[88:91], v[216:219], v[12:15]
    v_mfma_f32_16x16x32_bf16 v[16:19], a[88:91], v[220:223], v[16:19]
    v_mfma_f32_16x16x32_bf16 v[20:23], a[92:95], v[216:219], v[20:23]
    v_mfma_f32_16x16x32_bf16 v[24:27], a[92:95], v[220:223], v[24:27]
    ds_read_b128 v[248:251], v9 offset:30720
    ds_read_b128 v[252:255], v9 offset:31744
    s_waitcnt lgkmcnt(6)
    v_mfma_f32_16x16x32_bf16 v[12:15], a[96:99], v[224:227], v[12:15]
    v_mfma_f32_16x16x32_bf16 v[16:19], a[96:99], v[228:231], v[16:19]
    v_mfma_f32_16x16x32_bf16 v[20:23], a[100:103], v[224:227], v[20:23]
    v_mfma_f32_16x16x32_bf16 v[24:27], a[100:103], v[228:231], v[24:27]
    s_waitcnt lgkmcnt(4)
    v_mfma_f32_16x16x32_bf16 v[12:15], a[104:107], v[232:235], v[12:15]
    v_mfma_f32_16x16x32_bf16 v[16:19], a[104:107], v[236:239], v[16:19]
    v_mfma_f32_16x16x32_bf16 v[20:23], a[108:111], v[232:235], v[20:23]
    v_mfma_f32_16x16x32_bf16 v[24:27], a[108:111], v[236:239], v[24:27]
    s_waitcnt lgkmcnt(2)
    v_mfma_f32_16x16x32_bf16 v[12:15], a[112:115], v[240:243], v[12:15]
    v_mfma_f32_16x16x32_bf16 v[16:19], a[112:115], v[244:247], v[16:19]
    v_mfma_f32_16x16x32_bf16 v[20:23], a[116:119], v[240:243], v[20:23]
    v_mfma_f32_16x16x32_bf16 v[24:27], a[116:119], v[244:247], v[24:27]
    s_waitcnt lgkmcnt(0)
    v_mfma_f32_16x16x32_bf16 v[12:15], a[120:123], v[248:251], v[12:15]
    v_mfma_f32_16x16x32_bf16 v[16:19], a[120:123], v[252:255], v[16:19]
    v_mfma_f32_16x16x32_bf16 v[20:23], a[124:127], v[248:251], v[20:23]
    v_mfma_f32_16x16x32_bf16 v[24:27], a[124:127], v[252:255], v[24:27]
    v_lshlrev_b32 v40, 16, v104
    v_and_b32 v41, s44, v104
    v_lshlrev_b32 v42, 16, v105
    v_and_b32 v43, s44, v105
    v_lshlrev_b32 v44, 16, v106
    v_and_b32 v45, s44, v106
    v_lshlrev_b32 v46, 16, v107
    v_and_b32 v47, s44, v107
    v_lshlrev_b32 v48, 16, v108
    v_and_b32 v49, s44, v108
    v_lshlrev_b32 v50, 16, v109
    v_and_b32 v51, s44, v109
    v_lshlrev_b32 v52, 16, v110
    v_and_b32 v53, s44, v110
    v_lshlrev_b32 v54, 16, v111
    v_and_b32 v55, s44, v111
    v_pk_add_f32 v[12:13], v[12:13], v[40:41]
    v_pk_add_f32 v[14:15], v[14:15], v[42:43]
    v_pk_add_f32 v[16:17], v[16:17], v[44:45]
    v_pk_add_f32 v[18:19], v[18:19], v[46:47]
    v_pk_add_f32 v[20:21], v[20:21], v[48:49]
    v_pk_add_f32 v[22:23], v[22:23], v[50:51]
    v_pk_add_f32 v[24:25], v[24:25], v[52:53]
    v_pk_add_f32 v[26:27], v[26:27], v[54:55]
    v_cvt_pk_bf16_f32 v56, v12, v13
    v_cvt_pk_bf16_f32 v57, v14, v15
    v_cvt_pk_bf16_f32 v58, v16, v17
    v_cvt_pk_bf16_f32 v59, v18, v19
    buffer_store_dwordx4 v[56:59], v38, s[8:11], s62 offen sc1
    v_cvt_pk_bf16_f32 v60, v20, v21
    v_cvt_pk_bf16_f32 v61, v22, v23
    v_cvt_pk_bf16_f32 v62, v24, v25
    v_cvt_pk_bf16_f32 v63, v26, v27
    buffer_store_dwordx4 v[60:63], v38, s[8:11], s63 offen sc1
    v_pk_add_f32 v[48:49], v[12:13], v[14:15]
    v_pk_add_f32 v[50:51], v[20:21], v[22:23]
    v_pk_mul_f32 v[52:53], v[12:13], v[12:13]
    v_pk_fma_f32 v[52:53], v[14:15], v[14:15], v[52:53]
    v_pk_add_f32 v[48:49], v[48:49], v[50:51]
    v_pk_fma_f32 v[52:53], v[20:21], v[20:21], v[52:53]
    v_pk_fma_f32 v[52:53], v[22:23], v[22:23], v[52:53]
    v_add_f32 v44, v48, v49
    v_add_f32 v45, v52, v53
    v_pk_add_f32 v[48:49], v[16:17], v[18:19]
    v_pk_add_f32 v[50:51], v[24:25], v[26:27]
    v_pk_mul_f32 v[52:53], v[16:17], v[16:17]
    v_pk_fma_f32 v[52:53], v[18:19], v[18:19], v[52:53]
    v_pk_add_f32 v[48:49], v[48:49], v[50:51]
    v_pk_fma_f32 v[52:53], v[24:25], v[24:25], v[52:53]
    v_pk_fma_f32 v[52:53], v[26:27], v[26:27], v[52:53]
    v_add_f32 v46, v48, v49
    v_add_f32 v47, v52, v53
    s_nop 0
    v_permlane32_swap_b32 v44, v46
    v_permlane32_swap_b32 v45, v47
    v_add_f32 v44, v44, v46
    v_add_f32 v45, v45, v47
    s_nop 1
    v_permlane16_swap_b32 v44, v45
    v_add_f32 v44, v44, v45
    buffer_atomic_add_f32 v44, v39, s[8:11], s45 offen
    v_and_b32 v32, 3, v1
    v_mul_u32_u24 v32, 4160, v32
    v_and_b32 v33, 12, v1
    v_sub_u32 v33, 28, v33
    v_lshrrev_b32 v31, 5, v1
    v_lshlrev_b32 v31, 4, v31
    v_sub_u32 v33, v33, v31
    v_bfe_u32 v31, v1, 4, 1
    v_lshl_add_u32 v33, v31, 3, v33
    v_lshl_add_u32 v32, v33, 1, v32
    s_mul_i32 s72, s3, 16640
    s_add_u32 s72, s72, 0
    v_add_u32 v32, s72, v32
    v_lshrrev_b32 v5, 7, v0
    v_and_b32 v14, 127, v0
    v_lshlrev_b32 v14, 1, v14
    s_xor_b32 s72, s96, 0
    s_cmp_eq_u32 s72, 0
    s_cselect_b32 s73, 3, 1
    v_mul_u32_u24 v4, s73, v5
    v_add_u32 v4, s72, v4
    v_lshl_add_u32 v6, v4, 8, v14
    s_xor_b32 s72, s96, 1
    s_cmp_eq_u32 s72, 0
    s_cselect_b32 s73, 3, 1
    v_mul_u32_u24 v4, s73, v5
    v_add_u32 v4, s72, v4
    v_lshl_add_u32 v7, v4, 8, v14
    s_lshl_b32 s36, s69, 14
    s_add_u32 s36, s36, 16777216
    s_mov_b32 s37, 294912
    v_lshlrev_b32 v8, 3, v6
    v_lshlrev_b32 v9, 3, v7
    v_add_u32 v10, 8192, v8
    v_add_u32 v11, 8192, v9
    v_lshlrev_b32 v12, 1, v6
    v_add_u32 v12, 98816, v12
    v_lshlrev_b32 v13, 1, v7
    v_add_u32 v13, 98816, v13
    v_and_b32 v4, 15, v1
    v_lshrrev_b32 v5, 5, v1
    v_sub_u32 v4, v4, v5
    v_lshlrev_b32 v4, 5, v4
    v_bfe_u32 v5, v1, 4, 1
    v_lshl_add_u32 v4, v5, 4, v4
    s_mul_i32 s72, s3, 4608
    s_add_u32 s72, s72, 98368
    v_add_u32 v4, s72, v4
    v_and_b32 v14, 15, v1
    v_lshlrev_b32 v14, 6, v14
    v_lshrrev_b32 v5, 4, v1
    v_lshl_add_u32 v14, v5, 4, v14
    s_lshl_b32 s72, s3, 12
    s_add_u32 s72, s72, 118784
    v_add_u32 v14, s72, v14
    v_lshrrev_b32 v15, 7, v0
    v_and_b32 v5, 127, v0
    v_lshlrev_b32 v5, 3, v5
    v_lshl_add_u32 v15, v15, 10, v5
    v_add_u32 v15, 118784, v15
    s_waitcnt vmcnt(0)
    s_waitcnt lgkmcnt(0)
    s_barrier
    s_cmp_lg_u32 s3, 0
    s_cbranch_scc1 Larr_37
    s_add_u32 s72, s64, 5
    s_lshl_b32 s73, s2, 7
    v_mov_b32 v2, s72
    v_mov_b32 v3, s73
    s_mov_b64 exec, 1
    buffer_store_dword v2, v3, s[8:11], 0 offen sc0 sc1
    s_mov_b64 exec, -1
Larr_37:
    v_mov_b32 v56, 0
    v_mov_b32 v57, 0
    v_mov_b32 v58, 0
    v_mov_b32 v59, 0
    v_lshrrev_b32 v30, 5, v0
    v_mul_u32_u24 v30, 4608, v30
    v_and_b32 v33, 31, v0
    v_lshl_add_u32 v30, v33, 4, v30
    v_add_u32 v30, 98304, v30
    v_cmp_gt_u32 vcc, 128, v0
    s_nop 3
    s_and_saveexec_b64 s[76:77], vcc
    s_cbranch_execz Luz_38
    ds_write_b128 v30, v[56:59]
Luz_38:
    s_mov_b64 exec, s[76:77]
    s_waitcnt lgkmcnt(0)
    s_barrier
    ds_read_b64 a[128:129], v32 offset:4032
    ds_read_b64 a[130:131], v32 offset:4040
    ds_read_b64 a[132:133], v32 offset:3968
    ds_read_b64 a[134:135], v32 offset:3976
    ds_read_b64 a[136:137], v32 offset:3904
    ds_read_b64 a[138:139], v32 offset:3912
    ds_read_b64 a[140:141], v32 offset:3840
    ds_read_b64 a[142:143], v32 offset:3848
    s_waitcnt lgkmcnt(6)
    ds_read_b64 a[144:145], v32 offset:3776
    ds_read_b64 a[146:147], v32 offset:3784
    ds_read_b64 a[148:149], v32 offset:3712
    ds_read_b64 a[150:151], v32 offset:3720
    ds_read_b64 a[152:153], v32 offset:3648
    ds_read_b64 a[154:155], v32 offset:3656
    ds_read_b64 a[156:157], v32 offset:3584
    ds_read_b64 a[158:159], v32 offset:3592
    s_waitcnt lgkmcnt(6)
    ds_read_b64 a[160:161], v32 offset:3520
    ds_read_b64 a[162:163], v32 offset:3528
    ds_read_b64 a[164:165], v32 offset:3456
    ds_read_b64 a[166:167], v32 offset:3464
    ds_read_b64 a[168:169], v32 offset:3392
    ds_read_b64 a[170:171], v32 offset:3400
    ds_read_b64 a[172:173], v32 offset:3328
    ds_read_b64 a[174:175], v32 offset:3336
    s_waitcnt lgkmcnt(6)
    ds_read_b64 a[176:177], v32 offset:3264
    ds_read_b64 a[178:179], v32 offset:3272
    ds_read_b64 a[180:181], v32 offset:3200
    ds_read_b64 a[182:183], v32 offset:3208
    ds_read_b64 a[184:185], v32 offset:3136
    ds_read_b64 a[186:187], v32 offset:3144
    ds_read_b64 a[188:189], v32 offset:3072
    ds_read_b64 a[190:191], v32 offset:3080
    s_waitcnt lgkmcnt(6)
    ds_read_b64 a[192:193], v32 offset:3008
    ds_read_b64 a[194:195], v32 offset:3016
    ds_read_b64 a[196:197], v32 offset:2944
    ds_read_b64 a[198:199], v32 offset:2952
    ds_read_b64 a[200:201], v32 offset:2880
    ds_read_b64 a[202:203], v32 offset:2888
    ds_read_b64 a[204:205], v32 offset:2816
    ds_read_b64 a[206:207], v32 offset:2824
    s_waitcnt lgkmcnt(6)
    ds_read_b64 a[208:209], v32 offset:2752
    ds_read_b64 a[210:211], v32 offset:2760
    ds_read_b64 a[212:213], v32 offset:2688
    ds_read_b64 a[214:215], v32 offset:2696
    ds_read_b64 a[216:217], v32 offset:2624
    ds_read_b64 a[218:219], v32 offset:2632
    ds_read_b64 a[220:221], v32 offset:2560
    ds_read_b64 a[222:223], v32 offset:2568
    s_waitcnt lgkmcnt(6)
    ds_read_b64 a[224:225], v32 offset:2496
    ds_read_b64 a[226:227], v32 offset:2504
    ds_read_b64 a[228:229], v32 offset:2432
    ds_read_b64 a[230:231], v32 offset:2440
    ds_read_b64 a[232:233], v32 offset:2368
    ds_read_b64 a[234:235], v32 offset:2376
    ds_read_b64 a[236:237], v32 offset:2304
    ds_read_b64 a[238:239], v32 offset:2312
    s_waitcnt lgkmcnt(6)
    ds_read_b64 v[112:113], v32 offset:2240
    ds_read_b64 v[114:115], v32 offset:2248
    ds_read_b64 v[116:117], v32 offset:2176
    ds_read_b64 v[118:119], v32 offset:2184
    ds_read_b64 v[120:121], v32 offset:2112
    ds_read_b64 v[122:123], v32 offset:2120
    ds_read_b64 v[124:125], v32 offset:2048
    ds_read_b64 v[126:127], v32 offset:2056
    s_waitcnt lgkmcnt(6)
    ds_read_b64 v[128:129], v32 offset:1984
    ds_read_b64 v[130:131], v32 offset:1992
    ds_read_b64 v[132:133], v32 offset:1920
    ds_read_b64 v[134:135], v32 offset:1928
    ds_read_b64 v[136:137], v32 offset:1856
    ds_read_b64 v[138:139], v32 offset:1864
    ds_read_b64 v[140:141], v32 offset:1792
    ds_read_b64 v[142:143], v32 offset:1800
    s_waitcnt lgkmcnt(6)
    v_lshlrev_b32 v100, 7, v0
    buffer_load_dword v101, v100, s[8:11], 0 offen sc1
    ds_read_b64 v[144:145], v32 offset:1728
    ds_read_b64 v[146:147], v32 offset:1736
    ds_read_b64 v[148:149], v32 offset:1664
    ds_read_b64 v[150:151], v32 offset:1672
    ds_read_b64 v[152:153], v32 offset:1600
    ds_read_b64 v[154:155], v32 offset:1608
    ds_read_b64 v[156:157], v32 offset:1536
    ds_read_b64 v[158:159], v32 offset:1544
    s_waitcnt lgkmcnt(6)
    ds_read_b64 v[160:161], v32 offset:1472
    ds_read_b64 v[162:163], v32 offset:1480
    ds_read_b64 v[164:165], v32 offset:1408
    ds_read_b64 v[166:167], v32 offset:1416
    ds_read_b64 v[168:169], v32 offset:1344
    ds_read_b64 v[170:171], v32 offset:1352
    ds_read_b64 v[172:173], v32 offset:1280
    ds_read_b64 v[174:175], v32 offset:1288
    s_waitcnt lgkmcnt(6)
    ds_read_b64 v[176:177], v32 offset:1216
    ds_read_b64 v[178:179], v32 offset:1224
    ds_read_b64 v[180:181], v32 offset:1152
    ds_read_b64 v[182:183], v32 offset:1160
    ds_read_b64 v[184:185], v32 offset:1088
    ds_read_b64 v[186:187], v32 offset:1096
    ds_read_b64 v[188:189], v32 offset:1024
    ds_read_b64 v[190:191], v32 offset:1032
    s_waitcnt lgkmcnt(6)
    ds_read_b64 v[192:193], v32 offset:960
    ds_read_b64 v[194:195], v32 offset:968
    ds_read_b64 v[196:197], v32 offset:896
    ds_read_b64 v[198:199], v32 offset:904
    ds_read_b64 v[200:201], v32 offset:832
    ds_read_b64 v[202:203], v32 offset:840
    ds_read_b64 v[204:205], v32 offset:768
    ds_read_b64 v[206:207], v32 offset:776
    s_waitcnt lgkmcnt(6)
    ds_read_b64 v[208:209], v32 offset:704
    ds_read_b64 v[210:211], v32 offset:712
    ds_read_b64 v[212:213], v32 offset:640
    ds_read_b64 v[214:215], v32 offset:648
    ds_read_b64 v[216:217], v32 offset:576
    ds_read_b64 v[218:219], v32 offset:584
    ds_read_b64 v[220:221], v32 offset:512
    ds_read_b64 v[222:223], v32 offset:520
    s_waitcnt lgkmcnt(6)
    ds_read_b64 v[224:225], v32 offset:448
    ds_read_b64 v[226:227], v32 offset:456
    ds_read_b64 v[228:229], v32 offset:384
    ds_read_b64 v[230:231], v32 offset:392
    ds_read_b64 v[232:233], v32 offset:320
    ds_read_b64 v[234:235], v32 offset:328
    ds_read_b64 v[236:237], v32 offset:256
    ds_read_b64 v[238:239], v32 offset:264
    s_waitcnt lgkmcnt(6)
    ds_read_b64 v[240:241], v32 offset:192
    ds_read_b64 v[242:243], v32 offset:200
    ds_read_b64 v[244:245], v32 offset:128
    ds_read_b64 v[246:247], v32 offset:136
    ds_read_b64 v[248:249], v32 offset:64
    ds_read_b64 v[250:251], v32 offset:72
    ds_read_b64 v[252:253], v32 offset:0
    ds_read_b64 v[254:255], v32 offset:8
    s_waitcnt lgkmcnt(6)
    s_waitcnt lgkmcnt(0)
    s_waitcnt vmcnt(0) lgkmcnt(0)
    v_lshlrev_b32 v2, 7, v0
    s_add_u32 s72, s64, 5
    s_mov_b32 s73, 0
    v_subrev_u32 v3, s72, v101
    v_cmpx_le_u32 vcc, 8, v3
    s_nop 4
    s_cbranch_execz Lgx_40
Lgw_39:
    buffer_load_dword v3, v2, s[8:11], 0 offen sc1
    s_add_u32 s73, s73, 1
    s_cmp_gt_u32 s73, 0x40000
    s_cbranch_scc1 Lgx_40
    s_waitcnt vmcnt(0)
    v_subrev_u32 v3, s72, v3
    v_cmpx_le_u32 vcc, 8, v3
    s_nop 4
    s_cbranch_execz Lgx_40
    s_branch Lgw_39
Lgx_40:
    s_waitcnt vmcnt(0)
    s_mov_b64 exec, -1
    s_barrier
    buffer_load_dwordx4 v[80:83], v8, s[8:11], s37 offen sc1
    buffer_load_dwordx4 v[64:67], v8, s[8:11], s36 offen sc1
    buffer_load_dwordx4 v[84:87], v10, s[8:11], s37 offen sc1
    buffer_load_dwordx4 v[68:71], v10, s[8:11], s36 offen sc1
    buffer_load_dwordx4 v[88:91], v9, s[8:11], s37 offen sc1
    buffer_load_dwordx4 v[72:75], v9, s[8:11], s36 offen sc1
    buffer_load_dwordx4 v[92:95], v11, s[8:11], s37 offen sc1
    buffer_load_dwordx4 v[76:79], v11, s[8:11], s36 offen sc1
    s_waitcnt vmcnt(7)
    v_mul_f32 v80, 0x3b000000, v80
    v_mul_f32 v81, 0x3b000000, v81
    v_mul_f32 v82, 0x3b000000, v82
    v_mul_f32 v83, 0x3b000000, v83
    v_fma_f32 v81, -v80, v80, v81
    v_fma_f32 v83, -v82, v82, v83
    v_add_f32 v81, 0x3727c5ac, v81
    v_add_f32 v83, 0x3727c5ac, v83
    v_rsq_f32 v44, v81
    v_rsq_f32 v46, v83
    s_waitcnt vmcnt(6)
    v_lshlrev_b32 v16, 16, v64
    v_and_b32 v17, s44, v64
    v_lshlrev_b32 v18, 16, v65
    v_and_b32 v19, s44, v65
    v_lshlrev_b32 v20, 16, v66
    v_and_b32 v21, s44, v66
    v_lshlrev_b32 v22, 16, v67
    v_and_b32 v23, s44, v67
    v_mul_f32 v45, v80, v44
    v_mul_f32 v47, v82, v46
    v_pk_fma_f32 v[56:57], v[16:17], v[44:45], v[44:45] op_sel:[0,0,1] op_sel_hi:[1,0,1] neg_lo:[0,0,1] neg_hi:[0,0,1]
    v_pk_fma_f32 v[58:59], v[18:19], v[44:45], v[44:45] op_sel:[0,0,1] op_sel_hi:[1,0,1] neg_lo:[0,0,1] neg_hi:[0,0,1]
    v_pk_fma_f32 v[60:61], v[20:21], v[46:47], v[46:47] op_sel:[0,0,1] op_sel_hi:[1,0,1] neg_lo:[0,0,1] neg_hi:[0,0,1]
    v_pk_fma_f32 v[62:63], v[22:23], v[46:47], v[46:47] op_sel:[0,0,1] op_sel_hi:[1,0,1] neg_lo:[0,0,1] neg_hi:[0,0,1]
    v_cvt_pk_bf16_f32 v32, v56, v60
    v_cvt_pk_bf16_f32 v33, v57, v61
    v_cvt_pk_bf16_f32 v34, v58, v62
    v_cvt_pk_bf16_f32 v35, v59, v63
    ds_write_b32 v12, v32 offset:0
    ds_write_b32 v12, v33 offset:4608
    ds_write_b32 v12, v34 offset:9216
    ds_write_b32 v12, v35 offset:13824
    s_waitcnt vmcnt(5)
    v_mul_f32 v84, 0x3b000000, v84
    v_mul_f32 v85, 0x3b000000, v85
    v_mul_f32 v86, 0x3b000000, v86
    v_mul_f32 v87, 0x3b000000, v87
    v_fma_f32 v85, -v84, v84, v85
    v_fma_f32 v87, -v86, v86, v87
    v_add_f32 v85, 0x3727c5ac, v85
    v_add_f32 v87, 0x3727c5ac, v87
    v_rsq_f32 v44, v85
    v_rsq_f32 v46, v87
    s_waitcnt vmcnt(4)
    v_lshlrev_b32 v24, 16, v68
    v_and_b32 v25, s44, v68
    v_lshlrev_b32 v26, 16, v69
    v_and_b32 v27, s44, v69
    v_lshlrev_b32 v28, 16, v70
    v_and_b32 v29, s44, v70
    v_lshlrev_b32 v30, 16, v71
    v_and_b32 v31, s44, v71
    v_mul_f32 v45, v84, v44
    v_mul_f32 v47, v86, v46
    v_pk_fma_f32 v[56:57], v[24:25], v[44:45], v[44:45] op_sel:[0,0,1] op_sel_hi:[1,0,1] neg_lo:[0,0,1] neg_hi:[0,0,1]
    v_pk_fma_f32 v[58:59], v[26:27], v[44:45], v[44:45] op_sel:[0,0,1] op_sel_hi:[1,0,1] neg_lo:[0,0,1] neg_hi:[0,0,1]
    v_pk_fma_f32 v[60:61], v[28:29], v[46:47], v[46:47] op_sel:[0,0,1] op_sel_hi:[1,0,1] neg_lo:[0,0,1] neg_hi:[0,0,1]
    v_pk_fma_f32 v[62:63], v[30:31], v[46:47], v[46:47] op_sel:[0,0,1] op_sel_hi:[1,0,1] neg_lo:[0,0,1] neg_hi:[0,0,1]
    v_cvt_pk_bf16_f32 v36, v56, v60
    v_cvt_pk_bf16_f32 v37, v57, v61
    v_cvt_pk_bf16_f32 v38, v58, v62
    v_cvt_pk_bf16_f32 v39, v59, v63
    ds_write_b32 v12, v36 offset:2048
    ds_write_b32 v12, v37 offset:6656
    ds_write_b32 v12, v38 offset:11264
    ds_write_b32 v12, v39 offset:15872
    s_waitcnt vmcnt(3)
    v_mul_f32 v88, 0x3b000000, v88
    v_mul_f32 v89, 0x3b000000, v89
    v_mul_f32 v90, 0x3b000000, v90
    v_mul_f32 v91, 0x3b000000, v91
    v_fma_f32 v89, -v88, v88, v89
    v_fma_f32 v91, -v90, v90, v91
    v_add_f32 v89, 0x3727c5ac, v89
    v_add_f32 v91, 0x3727c5ac, v91
    v_rsq_f32 v44, v89
    v_rsq_f32 v46, v91
    s_waitcnt vmcnt(2)
    v_lshlrev_b32 v48, 16, v72
    v_and_b32 v49, s44, v72
    v_lshlrev_b32 v50, 16, v73
    v_and_b32 v51, s44, v73
    v_lshlrev_b32 v52, 16, v74
    v_and_b32 v53, s44, v74
    v_lshlrev_b32 v54, 16, v75
    v_and_b32 v55, s44, v75
    v_mul_f32 v45, v88, v44
    v_mul_f32 v47, v90, v46
    v_pk_fma_f32 v[56:57], v[48:49], v[44:45], v[44:45] op_sel:[0,0,1] op_sel_hi:[1,0,1] neg_lo:[0,0,1] neg_hi:[0,0,1]
    v_pk_fma_f32 v[58:59], v[50:51], v[44:45], v[44:45] op_sel:[0,0,1] op_sel_hi:[1,0,1] neg_lo:[0,0,1] neg_hi:[0,0,1]
    v_pk_fma_f32 v[60:61], v[52:53], v[46:47], v[46:47] op_sel:[0,0,1] op_sel_hi:[1,0,1] neg_lo:[0,0,1] neg_hi:[0,0,1]
    v_pk_fma_f32 v[62:63], v[54:55], v[46:47], v[46:47] op_sel:[0,0,1] op_sel_hi:[1,0,1] neg_lo:[0,0,1] neg_hi:[0,0,1]
    v_cvt_pk_bf16_f32 v40, v56, v60
    v_cvt_pk_bf16_f32 v41, v57, v61
    v_cvt_pk_bf16_f32 v42, v58, v62
    v_cvt_pk_bf16_f32 v43, v59, v63
    ds_write_b32 v13, v40 offset:0
    ds_write_b32 v13, v41 offset:4608
    ds_write_b32 v13, v42 offset:9216
    ds_write_b32 v13, v43 offset:13824
    s_waitcnt vmcnt(1)
    v_mul_f32 v92, 0x3b000000, v92
    v_mul_f32 v93, 0x3b000000, v93
    v_mul_f32 v94, 0x3b000000, v94
    v_mul_f32 v95, 0x3b000000, v95
    v_fma_f32 v93, -v92, v92, v93
    v_fma_f32 v95, -v94, v94, v95
    v_add_f32 v93, 0x3727c5ac, v93
    v_add_f32 v95, 0x3727c5ac, v95
    v_rsq_f32 v44, v93
    v_rsq_f32 v46, v95
    s_waitcnt vmcnt(0)
    v_lshlrev_b32 v48, 16, v76
    v_and_b32 v49, s44, v76
    v_lshlrev_b32 v50, 16, v77
    v_and_b32 v51, s44, v77
    v_lshlrev_b32 v52, 16, v78
    v_and_b32 v53, s44, v78
    v_lshlrev_b32 v54, 16, v79
    v_and_b32 v55, s44, v79
    v_mul_f32 v45, v92, v44
    v_mul_f32 v47, v94, v46
    v_pk_fma_f32 v[56:57], v[48:49], v[44:45], v[44:45] op_sel:[0,0,1] op_sel_hi:[1,0,1] neg_lo:[0,0,1] neg_hi:[0,0,1]
    v_pk_fma_f32 v[58:59], v[50:51], v[44:45], v[44:45] op_sel:[0,0,1] op_sel_hi:[1,0,1] neg_lo:[0,0,1] neg_hi:[0,0,1]
    v_pk_fma_f32 v[60:61], v[52:53], v[46:47], v[46:47] op_sel:[0,0,1] op_sel_hi:[1,0,1] neg_lo:[0,0,1] neg_hi:[0,0,1]
    v_pk_fma_f32 v[62:63], v[54:55], v[46:47], v[46:47] op_sel:[0,0,1] op_sel_hi:[1,0,1] neg_lo:[0,0,1] neg_hi:[0,0,1]
    v_cvt_pk_bf16_f32 v40, v56, v60
    v_cvt_pk_bf16_f32 v41, v57, v61
    v_cvt_pk_bf16_f32 v42, v58, v62
    v_cvt_pk_bf16_f32 v43, v59, v63
    ds_write_b32 v13, v40 offset:2048
    ds_write_b32 v13, v41 offset:6656
    ds_write_b32 v13, v42 offset:11264
    ds_write_b32 v13, v43 offset:15872
    s_waitcnt lgkmcnt(0)
    s_barrier
    v_lshlrev_b32 v10, 10, v6
    s_lshl_b32 s36, s69, 3
    s_add_u32 s37, s36, 1048576
    s_cmp_eq_u32 s96, 0
    s_cbranch_scc0 LhsB_41
    ds_read_b128 v[64:67], v4 offset:448
    ds_read_b128 v[68:71], v4 offset:960
    ds_read_b128 v[72:75], v4 offset:1472
    ds_read_b128 v[76:79], v4 offset:1984
    s_waitcnt lgkmcnt(3)
    v_mfma_f32_16x16x32_bf16 v[96:99], a[128:131], v[64:67], 0
    v_mfma_f32_16x16x32_bf16 v[100:103], a[224:227], v[64:67], 0
    ds_read_b128 v[64:67], v4 offset:384
    s_waitcnt lgkmcnt(3)
    v_mfma_f32_16x16x32_bf16 v[100:103], a[192:195], v[68:71], v[100:103]
    ds_read_b128 v[68:71], v4 offset:896
    s_waitcnt lgkmcnt(3)
    v_mfma_f32_16x16x32_bf16 v[100:103], a[160:163], v[72:75], v[100:103]
    ds_read_b128 v[72:75], v4 offset:1408
    s_waitcnt lgkmcnt(3)
    v_mfma_f32_16x16x32_bf16 v[100:103], a[128:131], v[76:79], v[100:103]
    ds_read_b128 v[76:79], v4 offset:1920
    s_waitcnt lgkmcnt(3)
    v_mfma_f32_16x16x32_bf16 v[96:99], a[132:135], v[64:67], v[96:99]
    v_mfma_f32_16x16x32_bf16 v[100:103], a[228:231], v[64:67], v[100:103]
    ds_read_b128 v[64:67], v4 offset:320
    s_waitcnt lgkmcnt(3)
    v_mfma_f32_16x16x32_bf16 v[100:103], a[196:199], v[68:71], v[100:103]
    ds_read_b128 v[68:71], v4 offset:832
    s_waitcnt lgkmcnt(3)
    v_mfma_f32_16x16x32_bf16 v[100:103], a[164:167], v[72:75], v[100:103]
    ds_read_b128 v[72:75], v4 offset:1344
    s_waitcnt lgkmcnt(3)
    v_mfma_f32_16x16x32_bf16 v[100:103], a[132:135], v[76:79], v[100:103]
    ds_read_b128 v[76:79], v4 offset:1856
    s_waitcnt lgkmcnt(3)
    v_mfma_f32_16x16x32_bf16 v[96:99], a[136:139], v[64:67], v[96:99]
    v_mfma_f32_16x16x32_bf16 v[100:103], a[232:235], v[64:67], v[100:103]
    ds_read_b128 v[64:67], v4 offset:256
    s_waitcnt lgkmcnt(3)
    v_mfma_f32_16x16x32_bf16 v[100:103], a[200:203], v[68:71], v[100:103]
    ds_read_b128 v[68:71], v4 offset:768
    s_waitcnt lgkmcnt(3)
    v_mfma_f32_16x16x32_bf16 v[100:103], a[168:171], v[72:75], v[100:103]
    ds_read_b128 v[72:75], v4 offset:1280
    s_waitcnt lgkmcnt(3)
    v_mfma_f32_16x16x32_bf16 v[100:103], a[136:139], v[76:79], v[100:103]
    ds_read_b128 v[76:79], v4 offset:1792
    s_waitcnt lgkmcnt(3)
    v_mfma_f32_16x16x32_bf16 v[96:99], a[140:143], v[64:67], v[96:99]
    v_mfma_f32_16x16x32_bf16 v[100:103], a[236:239], v[64:67], v[100:103]
    ds_read_b128 v[64:67], v4 offset:192
    s_waitcnt lgkmcnt(3)
    v_mfma_f32_16x16x32_bf16 v[100:103], a[204:207], v[68:71], v[100:103]
    ds_read_b128 v[68:71], v4 offset:704
    s_waitcnt lgkmcnt(3)
    v_mfma_f32_16x16x32_bf16 v[100:103], a[172:175], v[72:75], v[100:103]
    ds_read_b128 v[72:75], v4 offset:1216
    s_waitcnt lgkmcnt(3)
    v_mfma_f32_16x16x32_bf16 v[100:103], a[140:143], v[76:79], v[100:103]
    ds_read_b128 v[76:79], v4 offset:1728
    s_waitcnt lgkmcnt(3)
    v_mfma_f32_16x16x32_bf16 v[96:99], a[144:147], v[64:67], v[96:99]
    v_mfma_f32_16x16x32_bf16 v[100:103], v[112:115], v[64:67], v[100:103]
    ds_read_b128 v[64:67], v4 offset:128
    s_waitcnt lgkmcnt(3)
    v_mfma_f32_16x16x32_bf16 v[100:103], a[208:211], v[68:71], v[100:103]
    ds_read_b128 v[68:71], v4 offset:640
    s_waitcnt lgkmcnt(3)
    v_mfma_f32_16x16x32_bf16 v[100:103], a[176:179], v[72:75], v[100:103]
    ds_read_b128 v[72:75], v4 offset:1152
    s_waitcnt lgkmcnt(3)
    v_mfma_f32_16x16x32_bf16 v[100:103], a[144:147], v[76:79], v[100:103]
    ds_read_b128 v[76:79], v4 offset:1664
    s_waitcnt lgkmcnt(3)
    v_mfma_f32_16x16x32_bf16 v[96:99], a[148:151], v[64:67], v[96:99]
    v_mfma_f32_16x16x32_bf16 v[100:103], v[116:119], v[64:67], v[100:103]
    ds_read_b128 v[64:67], v4 offset:64
    s_waitcnt lgkmcnt(3)
    v_mfma_f32_16x16x32_bf16 v[100:103], a[212:215], v[68:71], v[100:103]
    ds_read_b128 v[68:71], v4 offset:576
    s_waitcnt lgkmcnt(3)
    v_mfma_f32_16x16x32_bf16 v[100:103], a[180:183], v[72:75], v[100:103]
    ds_read_b128 v[72:75], v4 offset:1088
    s_waitcnt lgkmcnt(3)
    v_mfma_f32_16x16x32_bf16 v[100:103], a[148:151], v[76:79], v[100:103]
    ds_read_b128 v[76:79], v4 offset:1600
    s_waitcnt lgkmcnt(3)
    v_mfma_f32_16x16x32_bf16 v[96:99], a[152:155], v[64:67], v[96:99]
    v_mfma_f32_16x16x32_bf16 v[100:103], v[120:123], v[64:67], v[100:103]
    ds_read_b128 v[64:67], v4 offset:0
    s_waitcnt lgkmcnt(3)
    v_mfma_f32_16x16x32_bf16 v[100:103], a[216:219], v[68:71], v[100:103]
    ds_read_b128 v[68:71], v4 offset:512
    s_waitcnt lgkmcnt(3)
    v_mfma_f32_16x16x32_bf16 v[100:103], a[184:187], v[72:75], v[100:103]
    ds_read_b128 v[72:75], v4 offset:1024
    s_waitcnt lgkmcnt(3)
    v_mfma_f32_16x16x32_bf16 v[100:103], a[152:155], v[76:79], v[100:103]
    ds_read_b128 v[76:79], v4 offset:1536
    s_waitcnt lgkmcnt(3)
    v_mfma_f32_16x16x32_bf16 v[96:99], a[156:159], v[64:67], v[96:99]
    v_mfma_f32_16x16x32_bf16 v[100:103], v[124:127], v[64:67], v[100:103]
    s_waitcnt lgkmcnt(2)
    v_mfma_f32_16x16x32_bf16 v[100:103], a[220:223], v[68:71], v[100:103]
    s_waitcnt lgkmcnt(1)
    v_mfma_f32_16x16x32_bf16 v[100:103], a[188:191], v[72:75], v[100:103]
    s_waitcnt lgkmcnt(0)
    v_mfma_f32_16x16x32_bf16 v[100:103], a[156:159], v[76:79], v[100:103]
    ds_read_b128 v[64:67], v4 offset:448
    ds_read_b128 v[68:71], v4 offset:960
    ds_read_b128 v[72:75], v4 offset:1472
    ds_read_b128 v[76:79], v4 offset:1984
    ds_read_b128 v[80:83], v4 offset:2496
    ds_read_b128 v[84:87], v4 offset:3008
    ds_read_b128 v[88:91], v4 offset:3520
    ds_read_b128 v[92:95], v4 offset:4032
    v_lshlrev_b32 v44, 16, v32
    v_and_b32 v45, s44, v32
    v_fma_f32 v16, v44, s97, v16
    v_fma_f32 v20, v45, s97, v20
    v_lshlrev_b32 v46, 16, v33
    v_and_b32 v47, s44, v33
    v_fma_f32 v17, v46, s98, v17
    v_fma_f32 v21, v47, s98, v21
    v_lshlrev_b32 v44, 16, v34
    v_and_b32 v45, s44, v34
    v_fma_f32 v18, v44, s99, v18
    v_fma_f32 v22, v45, s99, v22
    v_lshlrev_b32 v46, 16, v35
    v_and_b32 v47, s44, v35
    v_fma_f32 v19, v46, s100, v19
    v_fma_f32 v23, v47, s100, v23
    ds_write_b128 v14, v[96:99] offset:0
    ds_write_b128 v14, v[100:103] offset:1024
    s_waitcnt lgkmcnt(7)
    v_mfma_f32_16x16x32_bf16 v[104:107], v[128:131], v[64:67], 0
    v_mfma_f32_16x16x32_bf16 v[108:111], v[224:227], v[64:67], 0
    ds_read_b128 v[64:67], v4 offset:384
    s_waitcnt lgkmcnt(7)
    v_mfma_f32_16x16x32_bf16 v[104:107], a[224:227], v[68:71], v[104:107]
    v_mfma_f32_16x16x32_bf16 v[108:111], v[192:195], v[68:71], v[108:111]
    ds_read_b128 v[68:71], v4 offset:896
    s_waitcnt lgkmcnt(7)
    v_mfma_f32_16x16x32_bf16 v[104:107], a[192:195], v[72:75], v[104:107]
    v_mfma_f32_16x16x32_bf16 v[108:111], v[160:163], v[72:75], v[108:111]
    ds_read_b128 v[72:75], v4 offset:1408
    s_waitcnt lgkmcnt(7)
    v_mfma_f32_16x16x32_bf16 v[104:107], a[160:163], v[76:79], v[104:107]
    v_mfma_f32_16x16x32_bf16 v[108:111], v[128:131], v[76:79], v[108:111]
    ds_read_b128 v[76:79], v4 offset:1920
    s_waitcnt lgkmcnt(7)
    v_mfma_f32_16x16x32_bf16 v[104:107], a[128:131], v[80:83], v[104:107]
    v_mfma_f32_16x16x32_bf16 v[108:111], a[224:227], v[80:83], v[108:111]
    ds_read_b128 v[80:83], v4 offset:2432
    s_waitcnt lgkmcnt(7)
    v_mfma_f32_16x16x32_bf16 v[108:111], a[192:195], v[84:87], v[108:111]
    ds_read_b128 v[84:87], v4 offset:2944
    s_waitcnt lgkmcnt(7)
    v_mfma_f32_16x16x32_bf16 v[108:111], a[160:163], v[88:91], v[108:111]
    ds_read_b128 v[88:91], v4 offset:3456
    s_waitcnt lgkmcnt(7)
    v_mfma_f32_16x16x32_bf16 v[108:111], a[128:131], v[92:95], v[108:111]
    ds_read_b128 v[92:95], v4 offset:3968
    s_barrier
    ds_read_b64 v[44:45], v15 offset:0
    ds_read_b64 v[46:47], v15 offset:4096
    ds_read_b64 v[48:49], v15 offset:8192
    ds_read_b64 v[50:51], v15 offset:12288
    s_waitcnt lgkmcnt(7)
    v_mfma_f32_16x16x32_bf16 v[104:107], v[132:135], v[64:67], v[104:107]
    v_mfma_f32_16x16x32_bf16 v[108:111], v[228:231], v[64:67], v[108:111]
    ds_read_b128 v[64:67], v4 offset:320
    s_waitcnt lgkmcnt(7)
    v_mfma_f32_16x16x32_bf16 v[104:107], a[228:231], v[68:71], v[104:107]
    v_mfma_f32_16x16x32_bf16 v[108:111], v[196:199], v[68:71], v[108:111]
    ds_read_b128 v[68:71], v4 offset:832
    s_waitcnt lgkmcnt(7)
    v_mfma_f32_16x16x32_bf16 v[104:107], a[196:199], v[72:75], v[104:107]
    v_mfma_f32_16x16x32_bf16 v[108:111], v[164:167], v[72:75], v[108:111]
    ds_read_b128 v[72:75], v4 offset:1344
    s_waitcnt lgkmcnt(7)
    v_mfma_f32_16x16x32_bf16 v[104:107], a[164:167], v[76:79], v[104:107]
    v_mfma_f32_16x16x32_bf16 v[108:111], v[132:135], v[76:79], v[108:111]
    ds_read_b128 v[76:79], v4 offset:1856
    s_waitcnt lgkmcnt(7)
    v_mfma_f32_16x16x32_bf16 v[104:107], a[132:135], v[80:83], v[104:107]
    v_mfma_f32_16x16x32_bf16 v[108:111], a[228:231], v[80:83], v[108:111]
    ds_read_b128 v[80:83], v4 offset:2368
    s_waitcnt lgkmcnt(7)
    v_mfma_f32_16x16x32_bf16 v[108:111], a[196:199], v[84:87], v[108:111]
    ds_read_b128 v[84:87], v4 offset:2880
    s_waitcnt lgkmcnt(7)
    v_mfma_f32_16x16x32_bf16 v[108:111], a[164:167], v[88:91], v[108:111]
    ds_read_b128 v[88:91], v4 offset:3392
    s_waitcnt lgkmcnt(7)
    v_mfma_f32_16x16x32_bf16 v[108:111], a[132:135], v[92:95], v[108:111]
    ds_read_b128 v[92:95], v4 offset:3904
    s_waitcnt lgkmcnt(7)
    v_mfma_f32_16x16x32_bf16 v[104:107], v[136:139], v[64:67], v[104:107]
    v_mfma_f32_16x16x32_bf16 v[108:111], v[232:235], v[64:67], v[108:111]
    ds_read_b128 v[64:67], v4 offset:256
    s_waitcnt lgkmcnt(7)
    v_mfma_f32_16x16x32_bf16 v[104:107], a[232:235], v[68:71], v[104:107]
    v_mfma_f32_16x16x32_bf16 v[108:111], v[200:203], v[68:71], v[108:111]
    ds_read_b128 v[68:71], v4 offset:768
    s_waitcnt lgkmcnt(7)
    v_mfma_f32_16x16x32_bf16 v[104:107], a[200:203], v[72:75], v[104:107]
    v_mfma_f32_16x16x32_bf16 v[108:111], v[168:171], v[72:75], v[108:111]
    ds_read_b128 v[72:75], v4 offset:1280
    s_waitcnt lgkmcnt(7)
    v_mfma_f32_16x16x32_bf16 v[104:107], a[168:171], v[76:79], v[104:107]
    v_mfma_f32_16x16x32_bf16 v[108:111], v[136:139], v[76:79], v[108:111]
    ds_read_b128 v[76:79], v4 offset:1792
    s_waitcnt lgkmcnt(7)
    v_mfma_f32_16x16x32_bf16 v[104:107], a[136:139], v[80:83], v[104:107]
    v_mfma_f32_16x16x32_bf16 v[108:111], a[232:235], v[80:83], v[108:111]
    ds_read_b128 v[80:83], v4 offset:2304
    s_waitcnt lgkmcnt(7)
    v_mfma_f32_16x16x32_bf16 v[108:111], a[200:203], v[84:87], v[108:111]
    ds_read_b128 v[84:87], v4 offset:2816
    s_waitcnt lgkmcnt(7)
    v_mfma_f32_16x16x32_bf16 v[108:111], a[168:171], v[88:91], v[108:111]
    ds_read_b128 v[88:91], v4 offset:3328
    s_waitcnt lgkmcnt(7)
    v_mfma_f32_16x16x32_bf16 v[108:111], a[136:139], v[92:95], v[108:111]
    ds_read_b128 v[92:95], v4 offset:3840
    v_add_f32 v44, v44, v16
    v_add_f32 v45, v45, v20
    v_add_f32 v46, v46, v17
    v_add_f32 v47, v47, v21
    v_add_f32 v48, v48, v18
    v_add_f32 v49, v49, v22
    v_add_f32 v50, v50, v19
    v_add_f32 v51, v51, v23
    s_waitcnt lgkmcnt(7)
    v_mfma_f32_16x16x32_bf16 v[104:107], v[140:143], v[64:67], v[104:107]
    v_mfma_f32_16x16x32_bf16 v[108:111], v[236:239], v[64:67], v[108:111]
    ds_read_b128 v[64:67], v4 offset:192
    s_waitcnt lgkmcnt(7)
    v_mfma_f32_16x16x32_bf16 v[104:107], a[236:239], v[68:71], v[104:107]
    v_mfma_f32_16x16x32_bf16 v[108:111], v[204:207], v[68:71], v[108:111]
    ds_read_b128 v[68:71], v4 offset:704
    s_waitcnt lgkmcnt(7)
    v_mfma_f32_16x16x32_bf16 v[104:107], a[204:207], v[72:75], v[104:107]
    v_mfma_f32_16x16x32_bf16 v[108:111], v[172:175], v[72:75], v[108:111]
    ds_read_b128 v[72:75], v4 offset:1216
    s_waitcnt lgkmcnt(7)
    v_mfma_f32_16x16x32_bf16 v[104:107], a[172:175], v[76:79], v[104:107]
    v_mfma_f32_16x16x32_bf16 v[108:111], v[140:143], v[76:79], v[108:111]
    ds_read_b128 v[76:79], v4 offset:1728
    s_waitcnt lgkmcnt(7)
    v_mfma_f32_16x16x32_bf16 v[104:107], a[140:143], v[80:83], v[104:107]
    v_mfma_f32_16x16x32_bf16 v[108:111], a[236:239], v[80:83], v[108:111]
    ds_read_b128 v[80:83], v4 offset:2240
    s_waitcnt lgkmcnt(7)
    v_mfma_f32_16x16x32_bf16 v[108:111], a[204:207], v[84:87], v[108:111]
    ds_read_b128 v[84:87], v4 offset:2752
    s_waitcnt lgkmcnt(7)
    v_mfma_f32_16x16x32_bf16 v[108:111], a[172:175], v[88:91], v[108:111]
    ds_read_b128 v[88:91], v4 offset:3264
    s_waitcnt lgkmcnt(7)
    v_mfma_f32_16x16x32_bf16 v[108:111], a[140:143], v[92:95], v[108:111]
    ds_read_b128 v[92:95], v4 offset:3776
    v_cvt_pk_bf16_f32 v52, v44, v46
    v_cvt_pk_bf16_f32 v53, v48, v50
    v_cvt_pk_bf16_f32 v54, v45, v47
    v_cvt_pk_bf16_f32 v55, v49, v51
    buffer_store_dwordx2 v[52:53], v10, s[24:27], s36 offen
    buffer_store_dwordx2 v[54:55], v10, s[24:27], s36 offen offset:1024
    s_waitcnt lgkmcnt(7)
    v_mfma_f32_16x16x32_bf16 v[104:107], v[144:147], v[64:67], v[104:107]
    v_mfma_f32_16x16x32_bf16 v[108:111], v[240:243], v[64:67], v[108:111]
    ds_read_b128 v[64:67], v4 offset:128
    s_waitcnt lgkmcnt(7)
    v_mfma_f32_16x16x32_bf16 v[104:107], v[112:115], v[68:71], v[104:107]
    v_mfma_f32_16x16x32_bf16 v[108:111], v[208:211], v[68:71], v[108:111]
    ds_read_b128 v[68:71], v4 offset:640
    s_waitcnt lgkmcnt(7)
    v_mfma_f32_16x16x32_bf16 v[104:107], a[208:211], v[72:75], v[104:107]
    v_mfma_f32_16x16x32_bf16 v[108:111], v[176:179], v[72:75], v[108:111]
    ds_read_b128 v[72:75], v4 offset:1152
    s_waitcnt lgkmcnt(7)
    v_mfma_f32_16x16x32_bf16 v[104:107], a[176:179], v[76:79], v[104:107]
    v_mfma_f32_16x16x32_bf16 v[108:111], v[144:147], v[76:79], v[108:111]
    ds_read_b128 v[76:79], v4 offset:1664
    s_waitcnt lgkmcnt(7)
    v_mfma_f32_16x16x32_bf16 v[104:107], a[144:147], v[80:83], v[104:107]
    v_mfma_f32_16x16x32_bf16 v[108:111], v[112:115], v[80:83], v[108:111]
    ds_read_b128 v[80:83], v4 offset:2176
    s_waitcnt lgkmcnt(7)
    v_mfma_f32_16x16x32_bf16 v[108:111], a[208:211], v[84:87], v[108:111]
    ds_read_b128 v[84:87], v4 offset:2688
    s_waitcnt lgkmcnt(7)
    v_mfma_f32_16x16x32_bf16 v[108:111], a[176:179], v[88:91], v[108:111]
    ds_read_b128 v[88:91], v4 offset:3200
    s_waitcnt lgkmcnt(7)
    v_mfma_f32_16x16x32_bf16 v[108:111], a[144:147], v[92:95], v[108:111]
    ds_read_b128 v[92:95], v4 offset:3712
    s_waitcnt lgkmcnt(7)
    v_mfma_f32_16x16x32_bf16 v[104:107], v[148:151], v[64:67], v[104:107]
    v_mfma_f32_16x16x32_bf16 v[108:111], v[244:247], v[64:67], v[108:111]
    ds_read_b128 v[64:67], v4 offset:64
    s_waitcnt lgkmcnt(7)
    v_mfma_f32_16x16x32_bf16 v[104:107], v[116:119], v[68:71], v[104:107]
    v_mfma_f32_16x16x32_bf16 v[108:111], v[212:215], v[68:71], v[108:111]
    ds_read_b128 v[68:71], v4 offset:576
    s_waitcnt lgkmcnt(7)
    v_mfma_f32_16x16x32_bf16 v[104:107], a[212:215], v[72:75], v[104:107]
    v_mfma_f32_16x16x32_bf16 v[108:111], v[180:183], v[72:75], v[108:111]
    ds_read_b128 v[72:75], v4 offset:1088
    s_waitcnt lgkmcnt(7)
    v_mfma_f32_16x16x32_bf16 v[104:107], a[180:183], v[76:79], v[104:107]
    v_mfma_f32_16x16x32_bf16 v[108:111], v[148:151], v[76:79], v[108:111]
    ds_read_b128 v[76:79], v4 offset:1600
    s_waitcnt lgkmcnt(7)
    v_mfma_f32_16x16x32_bf16 v[104:107], a[148:151], v[80:83], v[104:107]
    v_mfma_f32_16x16x32_bf16 v[108:111], v[116:119], v[80:83], v[108:111]
    ds_read_b128 v[80:83], v4 offset:2112
    s_waitcnt lgkmcnt(7)
    v_mfma_f32_16x16x32_bf16 v[108:111], a[212:215], v[84:87], v[108:111]
    ds_read_b128 v[84:87], v4 offset:2624
    s_waitcnt lgkmcnt(7)
    v_mfma_f32_16x16x32_bf16 v[108:111], a[180:183], v[88:91], v[108:111]
    ds_read_b128 v[88:91], v4 offset:3136
    s_waitcnt lgkmcnt(7)
    v_mfma_f32_16x16x32_bf16 v[108:111], a[148:151], v[92:95], v[108:111]
    ds_read_b128 v[92:95], v4 offset:3648
    s_waitcnt lgkmcnt(7)
    v_mfma_f32_16x16x32_bf16 v[104:107], v[152:155], v[64:67], v[104:107]
    v_mfma_f32_16x16x32_bf16 v[108:111], v[248:251], v[64:67], v[108:111]
    ds_read_b128 v[64:67], v4 offset:0
    s_waitcnt lgkmcnt(7)
    v_mfma_f32_16x16x32_bf16 v[104:107], v[120:123], v[68:71], v[104:107]
    v_mfma_f32_16x16x32_bf16 v[108:111], v[216:219], v[68:71], v[108:111]
    ds_read_b128 v[68:71], v4 offset:512
    s_waitcnt lgkmcnt(7)
    v_mfma_f32_16x16x32_bf16 v[104:107], a[216:219], v[72:75], v[104:107]
    v_mfma_f32_16x16x32_bf16 v[108:111], v[184:187], v[72:75], v[108:111]
    ds_read_b128 v[72:75], v4 offset:1024
    s_waitcnt lgkmcnt(7)
    v_mfma_f32_16x16x32_bf16 v[104:107], a[184:187], v[76:79], v[104:107]
    v_mfma_f32_16x16x32_bf16 v[108:111], v[152:155], v[76:79], v[108:111]
    ds_read_b128 v[76:79], v4 offset:1536
    s_waitcnt lgkmcnt(7)
    v_mfma_f32_16x16x32_bf16 v[104:107], a[152:155], v[80:83], v[104:107]
    v_mfma_f32_16x16x32_bf16 v[108:111], v[120:123], v[80:83], v[108:111]
    ds_read_b128 v[80:83], v4 offset:2048
    s_waitcnt lgkmcnt(7)
    v_mfma_f32_16x16x32_bf16 v[108:111], a[216:219], v[84:87], v[108:111]
    ds_read_b128 v[84:87], v4 offset:2560
    s_waitcnt lgkmcnt(7)
    v_mfma_f32_16x16x32_bf16 v[108:111], a[184:187], v[88:91], v[108:111]
    ds_read_b128 v[88:91], v4 offset:3072
    s_waitcnt lgkmcnt(7)
    v_mfma_f32_16x16x32_bf16 v[108:111], a[152:155], v[92:95], v[108:111]
    ds_read_b128 v[92:95], v4 offset:3584
    s_waitcnt lgkmcnt(7)
    v_mfma_f32_16x16x32_bf16 v[104:107], v[156:159], v[64:67], v[104:107]
    v_mfma_f32_16x16x32_bf16 v[108:111], v[252:255], v[64:67], v[108:111]
    s_waitcnt lgkmcnt(6)
    v_mfma_f32_16x16x32_bf16 v[104:107], v[124:127], v[68:71], v[104:107]
    v_mfma_f32_16x16x32_bf16 v[108:111], v[220:223], v[68:71], v[108:111]
    s_waitcnt lgkmcnt(5)
    v_mfma_f32_16x16x32_bf16 v[104:107], a[220:223], v[72:75], v[104:107]
    v_mfma_f32_16x16x32_bf16 v[108:111], v[188:191], v[72:75], v[108:111]
    s_waitcnt lgkmcnt(4)
    v_mfma_f32_16x16x32_bf16 v[104:107], a[188:191], v[76:79], v[104:107]
    v_mfma_f32_16x16x32_bf16 v[108:111], v[156:159], v[76:79], v[108:111]
    s_waitcnt lgkmcnt(3)
    v_mfma_f32_16x16x32_bf16 v[104:107], a[156:159], v[80:83], v[104:107]
    v_mfma_f32_16x16x32_bf16 v[108:111], v[124:127], v[80:83], v[108:111]
    s_waitcnt lgkmcnt(2)
    v_mfma_f32_16x16x32_bf16 v[108:111], a[220:223], v[84:87], v[108:111]
    s_waitcnt lgkmcnt(1)
    v_mfma_f32_16x16x32_bf16 v[108:111], a[188:191], v[88:91], v[108:111]
    s_waitcnt lgkmcnt(0)
    v_mfma_f32_16x16x32_bf16 v[108:111], a[156:159], v[92:95], v[108:111]
    s_branch LhsE_42
LhsB_41:
    ds_read_b128 v[64:67], v4 offset:448
    ds_read_b128 v[68:71], v4 offset:960
    ds_read_b128 v[72:75], v4 offset:1472
    s_waitcnt lgkmcnt(2)
    v_mfma_f32_16x16x32_bf16 v[96:99], a[160:163], v[64:67], 0
    v_mfma_f32_16x16x32_bf16 v[100:103], a[192:195], v[64:67], 0
    ds_read_b128 v[64:67], v4 offset:384
    s_waitcnt lgkmcnt(2)
    v_mfma_f32_16x16x32_bf16 v[96:99], a[128:131], v[68:71], v[96:99]
    v_mfma_f32_16x16x32_bf16 v[100:103], a[160:163], v[68:71], v[100:103]
    ds_read_b128 v[68:71], v4 offset:896
    s_waitcnt lgkmcnt(2)
    v_mfma_f32_16x16x32_bf16 v[100:103], a[128:131], v[72:75], v[100:103]
    ds_read_b128 v[72:75], v4 offset:1408
    s_waitcnt lgkmcnt(2)
    v_mfma_f32_16x16x32_bf16 v[96:99], a[164:167], v[64:67], v[96:99]
    v_mfma_f32_16x16x32_bf16 v[100:103], a[196:199], v[64:67], v[100:103]
    ds_read_b128 v[64:67], v4 offset:320
    s_waitcnt lgkmcnt(2)
    v_mfma_f32_16x16x32_bf16 v[96:99], a[132:135], v[68:71], v[96:99]
    v_mfma_f32_16x16x32_bf16 v[100:103], a[164:167], v[68:71], v[100:103]
    ds_read_b128 v[68:71], v4 offset:832
    s_waitcnt lgkmcnt(2)
    v_mfma_f32_16x16x32_bf16 v[100:103], a[132:135], v[72:75], v[100:103]
    ds_read_b128 v[72:75], v4 offset:1344
    s_waitcnt lgkmcnt(2)
    v_mfma_f32_16x16x32_bf16 v[96:99], a[168:171], v[64:67], v[96:99]
    v_mfma_f32_16x16x32_bf16 v[100:103], a[200:203], v[64:67], v[100:103]
    ds_read_b128 v[64:67], v4 offset:256
    s_waitcnt lgkmcnt(2)
    v_mfma_f32_16x16x32_bf16 v[96:99], a[136:139], v[68:71], v[96:99]
    v_mfma_f32_16x16x32_bf16 v[100:103], a[168:171], v[68:71], v[100:103]
    ds_read_b128 v[68:71], v4 offset:768
    s_waitcnt lgkmcnt(2)
    v_mfma_f32_16x16x32_bf16 v[100:103], a[136:139], v[72:75], v[100:103]
    ds_read_b128 v[72:75], v4 offset:1280
    s_waitcnt lgkmcnt(2)
    v_mfma_f32_16x16x32_bf16 v[96:99], a[172:175], v[64:67], v[96:99]
    v_mfma_f32_16x16x32_bf16 v[100:103], a[204:207], v[64:67], v[100:103]
    ds_read_b128 v[64:67], v4 offset:192
    s_waitcnt lgkmcnt(2)
    v_mfma_f32_16x16x32_bf16 v[96:99], a[140:143], v[68:71], v[96:99]
    v_mfma_f32_16x16x32_bf16 v[100:103], a[172:175], v[68:71], v[100:103]
    ds_read_b128 v[68:71], v4 offset:704
    s_waitcnt lgkmcnt(2)
    v_mfma_f32_16x16x32_bf16 v[100:103], a[140:143], v[72:75], v[100:103]
    ds_read_b128 v[72:75], v4 offset:1216
    s_waitcnt lgkmcnt(2)
    v_mfma_f32_16x16x32_bf16 v[96:99], a[176:179], v[64:67], v[96:99]
    v_mfma_f32_16x16x32_bf16 v[100:103], a[208:211], v[64:67], v[100:103]
    ds_read_b128 v[64:67], v4 offset:128
    s_waitcnt lgkmcnt(2)
    v_mfma_f32_16x16x32_bf16 v[96:99], a[144:147], v[68:71], v[96:99]
    v_mfma_f32_16x16x32_bf16 v[100:103], a[176:179], v[68:71], v[100:103]
    ds_read_b128 v[68:71], v4 offset:640
    s_waitcnt lgkmcnt(2)
    v_mfma_f32_16x16x32_bf16 v[100:103], a[144:147], v[72:75], v[100:103]
    ds_read_b128 v[72:75], v4 offset:1152
    s_waitcnt lgkmcnt(2)
    v_mfma_f32_16x16x32_bf16 v[96:99], a[180:183], v[64:67], v[96:99]
    v_mfma_f32_16x16x32_bf16 v[100:103], a[212:215], v[64:67], v[100:103]
    ds_read_b128 v[64:67], v4 offset:64
    s_waitcnt lgkmcnt(2)
    v_mfma_f32_16x16x32_bf16 v[96:99], a[148:151], v[68:71], v[96:99]
    v_mfma_f32_16x16x32_bf16 v[100:103], a[180:183], v[68:71], v[100:103]
    ds_read_b128 v[68:71], v4 offset:576
    s_waitcnt lgkmcnt(2)
    v_mfma_f32_16x16x32_bf16 v[100:103], a[148:151], v[72:75], v[100:103]
    ds_read_b128 v[72:75], v4 offset:1088
    s_waitcnt lgkmcnt(2)
    v_mfma_f32_16x16x32_bf16 v[96:99], a[184:187], v[64:67], v[96:99]
    v_mfma_f32_16x16x32_bf16 v[100:103], a[216:219], v[64:67], v[100:103]
    ds_read_b128 v[64:67], v4 offset:0
    s_waitcnt lgkmcnt(2)
    v_mfma_f32_16x16x32_bf16 v[96:99], a[152:155], v[68:71], v[96:99]
    v_mfma_f32_16x16x32_bf16 v[100:103], a[184:187], v[68:71], v[100:103]
    ds_read_b128 v[68:71], v4 offset:512
    s_waitcnt lgkmcnt(2)
    v_mfma_f32_16x16x32_bf16 v[100:103], a[152:155], v[72:75], v[100:103]
    ds_read_b128 v[72:75], v4 offset:1024
    s_waitcnt lgkmcnt(2)
    v_mfma_f32_16x16x32_bf16 v[96:99], a[188:191], v[64:67], v[96:99]
    v_mfma_f32_16x16x32_bf16 v[100:103], a[220:223], v[64:67], v[100:103]
    s_waitcnt lgkmcnt(1)
    v_mfma_f32_16x16x32_bf16 v[96:99], a[156:159], v[68:71], v[96:99]
    v_mfma_f32_16x16x32_bf16 v[100:103], a[188:191], v[68:71], v[100:103]
    s_waitcnt lgkmcnt(0)
    v_mfma_f32_16x16x32_bf16 v[100:103], a[156:159], v[72:75], v[100:103]
    ds_read_b128 v[64:67], v4 offset:448
    ds_read_b128 v[68:71], v4 offset:960
    ds_read_b128 v[72:75], v4 offset:1472
    ds_read_b128 v[76:79], v4 offset:1984
    ds_read_b128 v[80:83], v4 offset:2496
    ds_read_b128 v[84:87], v4 offset:3008
    ds_read_b128 v[88:91], v4 offset:3520
    v_lshlrev_b32 v44, 16, v32
    v_and_b32 v45, s44, v32
    v_fma_f32 v16, v44, s97, v16
    v_fma_f32 v20, v45, s97, v20
    v_lshlrev_b32 v46, 16, v33
    v_and_b32 v47, s44, v33
    v_fma_f32 v17, v46, s98, v17
    v_fma_f32 v21, v47, s98, v21
    v_lshlrev_b32 v44, 16, v34
    v_and_b32 v45, s44, v34
    v_fma_f32 v18, v44, s99, v18
    v_fma_f32 v22, v45, s99, v22
    v_lshlrev_b32 v46, 16, v35
    v_and_b32 v47, s44, v35
    v_fma_f32 v19, v46, s100, v19
    v_fma_f32 v23, v47, s100, v23
    ds_write_b128 v14, v[96:99] offset:0
    ds_write_b128 v14, v[100:103] offset:1024
    s_waitcnt lgkmcnt(6)
    v_mfma_f32_16x16x32_bf16 v[104:107], v[160:163], v[64:67], 0
    v_mfma_f32_16x16x32_bf16 v[108:111], v[192:195], v[64:67], 0
    ds_read_b128 v[64:67], v4 offset:384
    s_waitcnt lgkmcnt(6)
    v_mfma_f32_16x16x32_bf16 v[104:107], v[128:131], v[68:71], v[104:107]
    v_mfma_f32_16x16x32_bf16 v[108:111], v[160:163], v[68:71], v[108:111]
    ds_read_b128 v[68:71], v4 offset:896
    s_waitcnt lgkmcnt(6)
    v_mfma_f32_16x16x32_bf16 v[104:107], a[224:227], v[72:75], v[104:107]
    v_mfma_f32_16x16x32_bf16 v[108:111], v[128:131], v[72:75], v[108:111]
    ds_read_b128 v[72:75], v4 offset:1408
    s_waitcnt lgkmcnt(6)
    v_mfma_f32_16x16x32_bf16 v[104:107], a[192:195], v[76:79], v[104:107]
    v_mfma_f32_16x16x32_bf16 v[108:111], a[224:227], v[76:79], v[108:111]
    ds_read_b128 v[76:79], v4 offset:1920
    s_waitcnt lgkmcnt(6)
    v_mfma_f32_16x16x32_bf16 v[104:107], a[160:163], v[80:83], v[104:107]
    v_mfma_f32_16x16x32_bf16 v[108:111], a[192:195], v[80:83], v[108:111]
    ds_read_b128 v[80:83], v4 offset:2432
    s_waitcnt lgkmcnt(6)
    v_mfma_f32_16x16x32_bf16 v[104:107], a[128:131], v[84:87], v[104:107]
    v_mfma_f32_16x16x32_bf16 v[108:111], a[160:163], v[84:87], v[108:111]
    ds_read_b128 v[84:87], v4 offset:2944
    s_waitcnt lgkmcnt(6)
    v_mfma_f32_16x16x32_bf16 v[108:111], a[128:131], v[88:91], v[108:111]
    ds_read_b128 v[88:91], v4 offset:3456
    s_barrier
    ds_read_b64 v[44:45], v15 offset:0
    ds_read_b64 v[46:47], v15 offset:4096
    ds_read_b64 v[48:49], v15 offset:8192
    ds_read_b64 v[50:51], v15 offset:12288
    s_waitcnt lgkmcnt(6)
    v_mfma_f32_16x16x32_bf16 v[104:107], v[164:167], v[64:67], v[104:107]
    v_mfma_f32_16x16x32_bf16 v[108:111], v[196:199], v[64:67], v[108:111]
    ds_read_b128 v[64:67], v4 offset:320
    s_waitcnt lgkmcnt(6)
    v_mfma_f32_16x16x32_bf16 v[104:107], v[132:135], v[68:71], v[104:107]
    v_mfma_f32_16x16x32_bf16 v[108:111], v[164:167], v[68:71], v[108:111]
    ds_read_b128 v[68:71], v4 offset:832
    s_waitcnt lgkmcnt(6)
    v_mfma_f32_16x16x32_bf16 v[104:107], a[228:231], v[72:75], v[104:107]
    v_mfma_f32_16x16x32_bf16 v[108:111], v[132:135], v[72:75], v[108:111]
    ds_read_b128 v[72:75], v4 offset:1344
    s_waitcnt lgkmcnt(6)
    v_mfma_f32_16x16x32_bf16 v[104:107], a[196:199], v[76:79], v[104:107]
    v_mfma_f32_16x16x32_bf16 v[108:111], a[228:231], v[76:79], v[108:111]
    ds_read_b128 v[76:79], v4 offset:1856
    s_waitcnt lgkmcnt(6)
    v_mfma_f32_16x16x32_bf16 v[104:107], a[164:167], v[80:83], v[104:107]
    v_mfma_f32_16x16x32_bf16 v[108:111], a[196:199], v[80:83], v[108:111]
    ds_read_b128 v[80:83], v4 offset:2368
    s_waitcnt lgkmcnt(6)
    v_mfma_f32_16x16x32_bf16 v[104:107], a[132:135], v[84:87], v[104:107]
    v_mfma_f32_16x16x32_bf16 v[108:111], a[164:167], v[84:87], v[108:111]
    ds_read_b128 v[84:87], v4 offset:2880
    s_waitcnt lgkmcnt(6)
    v_mfma_f32_16x16x32_bf16 v[108:111], a[132:135], v[88:91], v[108:111]
    ds_read_b128 v[88:91], v4 offset:3392
    s_waitcnt lgkmcnt(6)
    v_mfma_f32_16x16x32_bf16 v[104:107], v[168:171], v[64:67], v[104:107]
    v_mfma_f32_16x16x32_bf16 v[108:111], v[200:203], v[64:67], v[108:111]
    ds_read_b128 v[64:67], v4 offset:256
    s_waitcnt lgkmcnt(6)
    v_mfma_f32_16x16x32_bf16 v[104:107], v[136:139], v[68:71], v[104:107]
    v_mfma_f32_16x16x32_bf16 v[108:111], v[168:171], v[68:71], v[108:111]
    ds_read_b128 v[68:71], v4 offset:768
    s_waitcnt lgkmcnt(6)
    v_mfma_f32_16x16x32_bf16 v[104:107], a[232:235], v[72:75], v[104:107]
    v_mfma_f32_16x16x32_bf16 v[108:111], v[136:139], v[72:75], v[108:111]
    ds_read_b128 v[72:75], v4 offset:1280
    s_waitcnt lgkmcnt(6)
    v_mfma_f32_16x16x32_bf16 v[104:107], a[200:203], v[76:79], v[104:107]
    v_mfma_f32_16x16x32_bf16 v[108:111], a[232:235], v[76:79], v[108:111]
    ds_read_b128 v[76:79], v4 offset:1792
    s_waitcnt lgkmcnt(6)
    v_mfma_f32_16x16x32_bf16 v[104:107], a[168:171], v[80:83], v[104:107]
    v_mfma_f32_16x16x32_bf16 v[108:111], a[200:203], v[80:83], v[108:111]
    ds_read_b128 v[80:83], v4 offset:2304
    s_waitcnt lgkmcnt(6)
    v_mfma_f32_16x16x32_bf16 v[104:107], a[136:139], v[84:87], v[104:107]
    v_mfma_f32_16x16x32_bf16 v[108:111], a[168:171], v[84:87], v[108:111]
    ds_read_b128 v[84:87], v4 offset:2816
    s_waitcnt lgkmcnt(6)
    v_mfma_f32_16x16x32_bf16 v[108:111], a[136:139], v[88:91], v[108:111]
    ds_read_b128 v[88:91], v4 offset:3328
    v_add_f32 v44, v44, v16
    v_add_f32 v45, v45, v20
    v_add_f32 v46, v46, v17
    v_add_f32 v47, v47, v21
    v_add_f32 v48, v48, v18
    v_add_f32 v49, v49, v22
    v_add_f32 v50, v50, v19
    v_add_f32 v51, v51, v23
    s_waitcnt lgkmcnt(6)
    v_mfma_f32_16x16x32_bf16 v[104:107], v[172:175], v[64:67], v[104:107]
    v_mfma_f32_16x16x32_bf16 v[108:111], v[204:207], v[64:67], v[108:111]
    ds_read_b128 v[64:67], v4 offset:192
    s_waitcnt lgkmcnt(6)
    v_mfma_f32_16x16x32_bf16 v[104:107], v[140:143], v[68:71], v[104:107]
    v_mfma_f32_16x16x32_bf16 v[108:111], v[172:175], v[68:71], v[108:111]
    ds_read_b128 v[68:71], v4 offset:704
    s_waitcnt lgkmcnt(6)
    v_mfma_f32_16x16x32_bf16 v[104:107], a[236:239], v[72:75], v[104:107]
    v_mfma_f32_16x16x32_bf16 v[108:111], v[140:143], v[72:75], v[108:111]
    ds_read_b128 v[72:75], v4 offset:1216
    s_waitcnt lgkmcnt(6)
    v_mfma_f32_16x16x32_bf16 v[104:107], a[204:207], v[76:79], v[104:107]
    v_mfma_f32_16x16x32_bf16 v[108:111], a[236:239], v[76:79], v[108:111]
    ds_read_b128 v[76:79], v4 offset:1728
    s_waitcnt lgkmcnt(6)
    v_mfma_f32_16x16x32_bf16 v[104:107], a[172:175], v[80:83], v[104:107]
    v_mfma_f32_16x16x32_bf16 v[108:111], a[204:207], v[80:83], v[108:111]
    ds_read_b128 v[80:83], v4 offset:2240
    s_waitcnt lgkmcnt(6)
    v_mfma_f32_16x16x32_bf16 v[104:107], a[140:143], v[84:87], v[104:107]
    v_mfma_f32_16x16x32_bf16 v[108:111], a[172:175], v[84:87], v[108:111]
    ds_read_b128 v[84:87], v4 offset:2752
    s_waitcnt lgkmcnt(6)
    v_mfma_f32_16x16x32_bf16 v[108:111], a[140:143], v[88:91], v[108:111]
    ds_read_b128 v[88:91], v4 offset:3264
    v_cvt_pk_bf16_f32 v52, v44, v46
    v_cvt_pk_bf16_f32 v53, v48, v50
    v_cvt_pk_bf16_f32 v54, v45, v47
    v_cvt_pk_bf16_f32 v55, v49, v51
    buffer_store_dwordx2 v[52:53], v10, s[24:27], s36 offen
    buffer_store_dwordx2 v[54:55], v10, s[24:27], s36 offen offset:1024
    s_waitcnt lgkmcnt(6)
    v_mfma_f32_16x16x32_bf16 v[104:107], v[176:179], v[64:67], v[104:107]
    v_mfma_f32_16x16x32_bf16 v[108:111], v[208:211], v[64:67], v[108:111]
    ds_read_b128 v[64:67], v4 offset:128
    s_waitcnt lgkmcnt(6)
    v_mfma_f32_16x16x32_bf16 v[104:107], v[144:147], v[68:71], v[104:107]
    v_mfma_f32_16x16x32_bf16 v[108:111], v[176:179], v[68:71], v[108:111]
    ds_read_b128 v[68:71], v4 offset:640
    s_waitcnt lgkmcnt(6)
    v_mfma_f32_16x16x32_bf16 v[104:107], v[112:115], v[72:75], v[104:107]
    v_mfma_f32_16x16x32_bf16 v[108:111], v[144:147], v[72:75], v[108:111]
    ds_read_b128 v[72:75], v4 offset:1152
    s_waitcnt lgkmcnt(6)
    v_mfma_f32_16x16x32_bf16 v[104:107], a[208:211], v[76:79], v[104:107]
    v_mfma_f32_16x16x32_bf16 v[108:111], v[112:115], v[76:79], v[108:111]
    ds_read_b128 v[76:79], v4 offset:1664
    s_waitcnt lgkmcnt(6)
    v_mfma_f32_16x16x32_bf16 v[104:107], a[176:179], v[80:83], v[104:107]
    v_mfma_f32_16x16x32_bf16 v[108:111], a[208:211], v[80:83], v[108:111]
    ds_read_b128 v[80:83], v4 offset:2176
    s_waitcnt lgkmcnt(6)
    v_mfma_f32_16x16x32_bf16 v[104:107], a[144:147], v[84:87], v[104:107]
    v_mfma_f32_16x16x32_bf16 v[108:111], a[176:179], v[84:87], v[108:111]
    ds_read_b128 v[84:87], v4 offset:2688
    s_waitcnt lgkmcnt(6)
    v_mfma_f32_16x16x32_bf16 v[108:111], a[144:147], v[88:91], v[108:111]
    ds_read_b128 v[88:91], v4 offset:3200
    s_waitcnt lgkmcnt(6)
    v_mfma_f32_16x16x32_bf16 v[104:107], v[180:183], v[64:67], v[104:107]
    v_mfma_f32_16x16x32_bf16 v[108:111], v[212:215], v[64:67], v[108:111]
    ds_read_b128 v[64:67], v4 offset:64
    s_waitcnt lgkmcnt(6)
    v_mfma_f32_16x16x32_bf16 v[104:107], v[148:151], v[68:71], v[104:107]
    v_mfma_f32_16x16x32_bf16 v[108:111], v[180:183], v[68:71], v[108:111]
    ds_read_b128 v[68:71], v4 offset:576
    s_waitcnt lgkmcnt(6)
    v_mfma_f32_16x16x32_bf16 v[104:107], v[116:119], v[72:75], v[104:107]
    v_mfma_f32_16x16x32_bf16 v[108:111], v[148:151], v[72:75], v[108:111]
    ds_read_b128 v[72:75], v4 offset:1088
    s_waitcnt lgkmcnt(6)
    v_mfma_f32_16x16x32_bf16 v[104:107], a[212:215], v[76:79], v[104:107]
    v_mfma_f32_16x16x32_bf16 v[108:111], v[116:119], v[76:79], v[108:111]
    ds_read_b128 v[76:79], v4 offset:1600
    s_waitcnt lgkmcnt(6)
    v_mfma_f32_16x16x32_bf16 v[104:107], a[180:183], v[80:83], v[104:107]
    v_mfma_f32_16x16x32_bf16 v[108:111], a[212:215], v[80:83], v[108:111]
    ds_read_b128 v[80:83], v4 offset:2112
    s_waitcnt lgkmcnt(6)
    v_mfma_f32_16x16x32_bf16 v[104:107], a[148:151], v[84:87], v[104:107]
    v_mfma_f32_16x16x32_bf16 v[108:111], a[180:183], v[84:87], v[108:111]
    ds_read_b128 v[84:87], v4 offset:2624
    s_waitcnt lgkmcnt(6)
    v_mfma_f32_16x16x32_bf16 v[108:111], a[148:151], v[88:91], v[108:111]
    ds_read_b128 v[88:91], v4 offset:3136
    s_waitcnt lgkmcnt(6)
    v_mfma_f32_16x16x32_bf16 v[104:107], v[184:187], v[64:67], v[104:107]
    v_mfma_f32_16x16x32_bf16 v[108:111], v[216:219], v[64:67], v[108:111]
    ds_read_b128 v[64:67], v4 offset:0
    s_waitcnt lgkmcnt(6)
    v_mfma_f32_16x16x32_bf16 v[104:107], v[152:155], v[68:71], v[104:107]
    v_mfma_f32_16x16x32_bf16 v[108:111], v[184:187], v[68:71], v[108:111]
    ds_read_b128 v[68:71], v4 offset:512
    s_waitcnt lgkmcnt(6)
    v_mfma_f32_16x16x32_bf16 v[104:107], v[120:123], v[72:75], v[104:107]
    v_mfma_f32_16x16x32_bf16 v[108:111], v[152:155], v[72:75], v[108:111]
    ds_read_b128 v[72:75], v4 offset:1024
    s_waitcnt lgkmcnt(6)
    v_mfma_f32_16x16x32_bf16 v[104:107], a[216:219], v[76:79], v[104:107]
    v_mfma_f32_16x16x32_bf16 v[108:111], v[120:123], v[76:79], v[108:111]
    ds_read_b128 v[76:79], v4 offset:1536
    s_waitcnt lgkmcnt(6)
    v_mfma_f32_16x16x32_bf16 v[104:107], a[184:187], v[80:83], v[104:107]
    v_mfma_f32_16x16x32_bf16 v[108:111], a[216:219], v[80:83], v[108:111]
    ds_read_b128 v[80:83], v4 offset:2048
    s_waitcnt lgkmcnt(6)
    v_mfma_f32_16x16x32_bf16 v[104:107], a[152:155], v[84:87], v[104:107]
    v_mfma_f32_16x16x32_bf16 v[108:111], a[184:187], v[84:87], v[108:111]
    ds_read_b128 v[84:87], v4 offset:2560
    s_waitcnt lgkmcnt(6)
    v_mfma_f32_16x16x32_bf16 v[108:111], a[152:155], v[88:91], v[108:111]
    ds_read_b128 v[88:91], v4 offset:3072
    s_waitcnt lgkmcnt(6)
    v_mfma_f32_16x16x32_bf16 v[104:107], v[188:191], v[64:67], v[104:107]
    v_mfma_f32_16x16x32_bf16 v[108:111], v[220:223], v[64:67], v[108:111]
    s_waitcnt lgkmcnt(5)
    v_mfma_f32_16x16x32_bf16 v[104:107], v[156:159], v[68:71], v[104:107]
    v_mfma_f32_16x16x32_bf16 v[108:111], v[188:191], v[68:71], v[108:111]
    s_waitcnt lgkmcnt(4)
    v_mfma_f32_16x16x32_bf16 v[104:107], v[124:127], v[72:75], v[104:107]
    v_mfma_f32_16x16x32_bf16 v[108:111], v[156:159], v[72:75], v[108:111]
    s_waitcnt lgkmcnt(3)
    v_mfma_f32_16x16x32_bf16 v[104:107], a[220:223], v[76:79], v[104:107]
    v_mfma_f32_16x16x32_bf16 v[108:111], v[124:127], v[76:79], v[108:111]
    s_waitcnt lgkmcnt(2)
    v_mfma_f32_16x16x32_bf16 v[104:107], a[188:191], v[80:83], v[104:107]
    v_mfma_f32_16x16x32_bf16 v[108:111], a[220:223], v[80:83], v[108:111]
    s_waitcnt lgkmcnt(1)
    v_mfma_f32_16x16x32_bf16 v[104:107], a[156:159], v[84:87], v[104:107]
    v_mfma_f32_16x16x32_bf16 v[108:111], a[188:191], v[84:87], v[108:111]
    s_waitcnt lgkmcnt(0)
    v_mfma_f32_16x16x32_bf16 v[108:111], a[156:159], v[88:91], v[108:111]
LhsE_42:
    s_nop 3
    s_nop 0
    ds_write_b128 v14, v[104:107] offset:2048
    s_nop 1
    ds_write_b128 v14, v[108:111] offset:3072
    v_lshlrev_b32 v44, 16, v36
    v_and_b32 v45, s44, v36
    v_fma_f32 v24, v44, s97, v24
    v_fma_f32 v28, v45, s97, v28
    v_lshlrev_b32 v46, 16, v37
    v_and_b32 v47, s44, v37
    v_fma_f32 v25, v46, s98, v25
    v_fma_f32 v29, v47, s98, v29
    v_lshlrev_b32 v44, 16, v38
    v_and_b32 v45, s44, v38
    v_fma_f32 v26, v44, s99, v26
    v_fma_f32 v30, v45, s99, v30
    v_lshlrev_b32 v46, 16, v39
    v_and_b32 v47, s44, v39
    v_fma_f32 v27, v46, s100, v27
    v_fma_f32 v31, v47, s100, v31
    s_waitcnt lgkmcnt(0)
    s_barrier
    ds_read_b64 v[44:45], v15 offset:2048
    ds_read_b64 v[46:47], v15 offset:6144
    ds_read_b64 v[48:49], v15 offset:10240
    ds_read_b64 v[50:51], v15 offset:14336
    s_waitcnt lgkmcnt(0)
    v_add_f32 v44, v44, v24
    v_add_f32 v45, v45, v28
    v_add_f32 v46, v46, v25
    v_add_f32 v47, v47, v29
    v_add_f32 v48, v48, v26
    v_add_f32 v49, v49, v30
    v_add_f32 v50, v50, v27
    v_add_f32 v51, v51, v31
    v_cvt_pk_bf16_f32 v52, v44, v46
    v_cvt_pk_bf16_f32 v53, v48, v50
    v_cvt_pk_bf16_f32 v54, v45, v47
    v_cvt_pk_bf16_f32 v55, v49, v51
    buffer_store_dwordx2 v[52:53], v10, s[24:27], s37 offen
    buffer_store_dwordx2 v[54:55], v10, s[24:27], s37 offen offset:1024
    s_waitcnt vmcnt(0)
    s_waitcnt vmcnt(0)
Lend:
    s_endpgm
.section .rodata,"a"
.p2align 6
.amdhsa_kernel interleave_layers__linear_kernel_hedgehog__ssm_conv_s4d__prompt_kernel
  .amdhsa_next_free_vgpr 512
  .amdhsa_next_free_sgpr 102
  .amdhsa_accum_offset 256
  .amdhsa_group_segment_fixed_size 0
  .amdhsa_kernarg_size 112
  .amdhsa_user_sgpr_count 2
  .amdhsa_user_sgpr_kernarg_segment_ptr 1
  .amdhsa_system_sgpr_workgroup_id_x 1
.end_amdhsa_kernel
```
